```python
import torch

def _softmax(x, axis=-1):
    return torch.softmax(x, dim=axis)

def _gelu(x):
    return torch.nn.functional.gelu(x, approximate='tanh')

def _silu(x):
    return torch.nn.functional.silu(x)

def _sigmoid(x):
    return torch.sigmoid(x)

def _layernorm(x, axis=-1, eps=1e-05):
    m = x.mean(dim=axis, keepdim=True)
    v = x.var(dim=axis, keepdim=True, unbiased=False)
    return (x - m) / torch.sqrt(v + eps)

def _scatter_add(tgt, idx, src, axis=0):
    return tgt.clone().index_add_(axis, idx, src)

def _segment_sum(src, seg, n):
    out = torch.zeros((n,) + src.shape[1:], dtype=src.dtype)
    return out.index_add_(0, seg, src)

def _pad(x, pw):
    flat = tuple((v for pair in reversed(pw) for v in pair))
    return torch.nn.functional.pad(x, flat)
kernel_name = 'recurrent_scan__sliding_block_cached__mixer_gmlp__prompt'

def setup_inputs():

    _w = lambda a: (lambda t: t.to(torch.bfloat16) if t.is_floating_point() else t)(torch.as_tensor(a))

    def _A_setup():
        B, Sq, D = (1, 2048, 512)
        Hq, Hkv, Sk, Dh = (32, 32, 2048, 128)
        assert Hq % Hkv == 0, (Hq, Hkv)
        return {'x': _w((lambda *s: torch.randn(*s, dtype=torch.bfloat16) * 0.05)(B, Sq, D)), 'k_cache': _w((lambda *s: torch.randn(*s, dtype=torch.bfloat16) * 0.8)(B, Hkv, Sk, Dh)), 'v_cache': _w((lambda *s: torch.randn(*s, dtype=torch.bfloat16) * 0.2)(B, Hkv, Sk, Dh)), 'wq': _w((lambda *s: torch.randn(*s, dtype=torch.bfloat16) * 0.8)(D, Hq * Dh) * D ** (-0.5)), 'wo': _w((lambda *s: torch.randn(*s, dtype=torch.bfloat16) * 0.2)(Hq * Dh, D) * (Hq * Dh) ** (-0.5))}
    _A_in = _A_setup()

    def _B_setup():
        B, S, D, F = (1, 2048, 512, 1376)
        Fh = F // 2
        return {'x': _w((lambda *s: torch.randn(*s, dtype=torch.bfloat16) * 0.05)(B, S, D)), 'w_in': _w((lambda *s: torch.randn(*s, dtype=torch.bfloat16) * 0.4)(D, 2 * Fh)), 'w_sp': _w(0.01 * (lambda *s: torch.randn(*s, dtype=torch.bfloat16) * 0.4)(S, S)), 'b_sp': _w(1.0 + 0.01 * (lambda *s: torch.randn(*s, dtype=torch.bfloat16) * 0.1)(S)), 'w_out': _w((lambda *s: torch.randn(*s, dtype=torch.bfloat16) * 0.1)(Fh, D))}
    _B_in = _B_setup()
    return {'A_x': _A_in['x'], 'A_k_cache': _A_in['k_cache'], 'A_v_cache': _A_in['v_cache'], 'A_wq': _A_in['wq'], 'A_wo': _A_in['wo'], 'B_x': _B_in['x'], 'B_w_in': _B_in['w_in'], 'B_w_sp': _B_in['w_sp'], 'B_b_sp': _B_in['b_sp'], 'B_w_out': _B_in['w_out']}

def reference(A_x, A_k_cache, A_v_cache, A_wq, A_wo, B_x, B_w_in, B_w_sp, B_b_sp, B_w_out):

    def _A_ref(x, k_cache, v_cache, wq, wo):
        B, Sq, D = x.shape
        Hq, Dh = (32, 128)
        Hkv, Sk = (k_cache.shape[1], k_cache.shape[2])
        W = min(4096, max(256, Sk // 4))
        rep = Hq // Hkv
        q = (lambda x, *d: x.permute(*d))((x @ wq).reshape(B, Sq, Hq, Dh), 0, 2, 1, 3)
        k = (lambda x, n, axis: torch.repeat_interleave(x, n, dim=axis))(k_cache[:, :, Sk - W:, :], rep, axis=1)
        v = (lambda x, n, axis: torch.repeat_interleave(x, n, dim=axis))(v_cache[:, :, Sk - W:, :], rep, axis=1)
        scores = torch.einsum('bhqd,bhkd->bhqk', q, k) * Dh ** (-0.5)
        p = _softmax(scores, axis=-1)
        o = torch.einsum('bhqk,bhkd->bhqd', p, v)
        return (lambda x, *d: x.permute(*d))(o, 0, 2, 1, 3).reshape(B, Sq, Hq * Dh) @ wo

    def _B_ref(x, w_in, w_sp, b_sp, w_out):
        B, S, D = x.shape
        F = w_in.shape[-1]
        Fh = F // 2
        z = _gelu(torch.einsum('bsd,df->bsf', x, w_in))
        z1 = z[..., :Fh].clone()
        z2 = _layernorm(z[..., Fh:], axis=-1)
        g = torch.einsum('ts,bsf->btf', w_sp, z2) + b_sp[None, :, None]
        return torch.einsum('bsf,fd->bsd', z1 * g, w_out)
    x = A_x
    xn = _layernorm(x, axis=-1)
    s = _A_ref(xn, A_k_cache, A_v_cache, A_wq, A_wo)
    g = _silu(_B_ref(xn, B_w_in, B_w_sp, B_b_sp, B_w_out))
    return x + s * g
```

```asm
; @launch grid=(256,1,1) block=(256,1,1) lds=163840
.amdgcn_target "amdgcn-amd-amdhsa--gfx950"
.text
.globl recurrent_scan__sliding_block_cached__mixer_gmlp__prompt_kernel
.p2align 8
.type recurrent_scan__sliding_block_cached__mixer_gmlp__prompt_kernel,@function
recurrent_scan__sliding_block_cached__mixer_gmlp__prompt_kernel:
    s_cmp_ge_u32 s2, 0x100
    s_cbranch_scc1 L_end
    s_and_b32 s63, s2, 7
    s_lshr_b32 s64, s2, 3
    v_lshrrev_b32 v1, 6, v0
    s_and_b32 s67, s64, 3
    s_lshl_b32 s65, s63, 2
    s_load_dwordx16 s[36:51], s[0:1], 0
    s_load_dwordx8 s[52:59], s[0:1], 64
    s_load_dwordx2 s[60:61], s[0:1], 0x60
    v_and_b32 v0, 63, v0
    v_readfirstlane_b32 s62, v1
    s_add_u32 s65, s65, s67
    s_lshr_b32 s66, s64, 2
    s_getpc_b64 s[76:77]
L_pc_here:
    s_and_b32 s77, s77, 0xffff
    s_mov_b32 s78, L_code_end - L_pc_here
    s_mov_b32 s79, 0x20000
    s_lshl_b32 s80, s64, 2
    s_add_u32 s80, s80, s62
    s_lshl_b32 s80, s80, 9
    v_lshlrev_b32 v2, 4, v0
    buffer_load_dwordx4 a[248:251], v2, s[76:79], s80 offen
    v_lshrrev_b32 v150, 3, v0
    v_and_b32 v151, 7, v0
    s_lshl_b32 s68, s62, 16
    v_lshlrev_b32 v152, 10, v150
    v_add_u32 v152, s68, v152
    v_lshrrev_b32 v150, 1, v150
    v_xor_b32 v153, v151, v150
    v_lshl_add_u32 v2, v153, 4, v152
    v_or_b32 v150, 4, v150
    v_xor_b32 v153, v151, v150
    v_lshl_add_u32 v3, v153, 4, v152
    v_add_u32 v3, 0x1c00, v3
    s_mul_i32 s74, s62, 0x6000
    s_mov_b32 s79, 0x3800
    s_mov_b32 s80, 0x8000
    s_mov_b32 s81, 0xb800
    s_lshl_b32 s67, s66, 18
    s_waitcnt lgkmcnt(0)
    s_add_u32 s12, s36, s67
    s_addc_u32 s13, s37, 0
    s_and_b32 s13, s13, 0xffff
    s_mov_b32 s14, 0x40000
    s_mov_b32 s15, 0x20000
    s_add_u32 m0, s74, 0
    s_nop 0
    buffer_load_dwordx4 v2, s[12:15], 0 offen lds
    buffer_load_dwordx4 v3, s[12:15], 0 offen offset:1024 lds
    buffer_load_dwordx4 v2, s[12:15], s79 offen offset:2048 lds
    buffer_load_dwordx4 v3, s[12:15], s79 offen offset:3072 lds
    s_add_u32 m0, s74, 0x1000
    s_nop 0
    buffer_load_dwordx4 v2, s[12:15], s80 offen lds
    buffer_load_dwordx4 v3, s[12:15], s80 offen offset:1024 lds
    buffer_load_dwordx4 v2, s[12:15], s81 offen offset:2048 lds
    buffer_load_dwordx4 v3, s[12:15], s81 offen offset:3072 lds
    v_add_u32 v2, 0x80, v2
    v_add_u32 v3, 0x80, v3
    v_and_b32 v137, 15, v0
    v_lshrrev_b32 v136, 4, v0
    v_mov_b32 v142, s62
    v_lshrrev_b32 v140, 2, v137
    v_xor_b32 v140, v140, v136
    v_lshlrev_b32 v140, 6, v140
    v_and_b32 v141, 3, v137
    v_lshl_add_u32 v140, v141, 4, v140
    s_sub_u32 s71, s65, 10
    s_cmp_ge_u32 s65, 10
    s_cselect_b32 s85, s71, 0x63
    s_mov_b32 s84, s65
    s_lshl_b32 s71, s84, 6
    s_add_u32 s71, s71, 0x560
    s_lshl_b32 s72, s85, 6
    v_lshrrev_b32 v138, 3, v0
    v_and_b32 v139, 7, v0
    s_cmp_lt_u32 s84, 22
    s_cselect_b32 s82, s71, 0x7f000000
    s_cmp_lt_u32 s85, 22
    s_cselect_b32 s83, s72, 0x7f000000
    s_mov_b32 s72, 0xac0
    v_mov_b32 v141, s82
    s_lshl_b32 s69, s65, 8
    s_add_u32 s16, s42, s69
    s_addc_u32 s17, s43, 0
    s_sub_u32 s20, s48, 0x800
    s_subb_u32 s21, s49, 0
    s_mul_i32 s75, s62, 0xc00
    s_add_u32 s75, s75, 0x18000
    s_and_b32 s17, s17, 0xffff
    s_mov_b32 s18, 0x3fe100
    s_mov_b32 s19, 0x20000
    s_and_b32 s21, s21, 0xffff
    s_mov_b32 s22, 0x158800
    s_mov_b32 s23, 0x20000
    s_mov_b32 s77, 0
    s_mov_b32 s78, 0
    s_add_u32 m0, s75, 0
    s_memrealtime s[100:101]
    v_lshlrev_b32 v23, 5, v0
    s_cmp_eq_u32 s62, 0
    s_cselect_b32 s71, 0, 0x7ffffff0
    s_mov_b32 s8, s58
    s_and_b32 s9, s59, 0xffff
    s_mov_b32 s10, 0x100
    s_mov_b32 s11, 0x20000
    s_lshl_b32 s92, s66, 8
    s_lshl_b32 s67, s65, 3
    s_add_u32 s92, s92, s67
    s_lshl_b32 s67, s62, 1
    s_add_u32 s92, s92, s67
    s_mov_b32 s32, s36
    s_and_b32 s33, s37, 0xffff
    s_mov_b32 s34, 0x200000
    s_mov_b32 s35, 0x20000
    s_lshl_b32 s68, s92, 10
    v_lshlrev_b32 v46, 4, v0
    buffer_load_dwordx4 v[48:51], v46, s[32:35], s68 offen
    buffer_load_dwordx4 v[52:55], v46, s[32:35], s68 offen offset:1024
    v_and_b32 v132, 3, v0
    v_and_b32 v133, 1, v132
    v_lshlrev_b32 v133, 1, v133
    v_lshrrev_b32 v134, 1, v132
    v_or_b32 v133, v133, v134
    v_bfe_u32 v130, v0, 4, 1
    v_lshlrev_b32 v133, 3, v133
    v_lshl_add_u32 v135, v130, 5, v133
    v_lshlrev_b32 v133, 3, v142
    v_add_u32 v133, v133, v136
    v_lshlrev_b32 v134, 13, v133
    v_add_u32 v4, v134, v140
    v_add_u32 v5, 0x7c00, v4
    buffer_load_dwordx4 v4, s[16:19], s77 offen lds
    buffer_load_dwordx4 v5, s[16:19], s77 offen offset:1024 lds
    s_add_u32 s77, s77, 0x40000
    v_and_b32 v134, 15, v133
    v_xor_b32 v134, v137, v134
    v_lshlrev_b32 v134, 4, v134
    v_lshl_add_u32 v22, v133, 8, v140
    v_bfe_u32 v140, v138, 1, 1
    v_lshl_add_u32 v20, v133, 8, v134
    v_add_u32 v133, 4, v133
    v_and_b32 v134, 15, v133
    v_xor_b32 v134, v137, v134
    v_lshlrev_b32 v134, 4, v134
    v_lshl_add_u32 v21, v133, 8, v134
    v_lshrrev_b32 v134, 2, v139
    v_lshlrev_b32 v133, 3, v142
    v_xor_b32 v134, v134, v140
    v_add_u32 v133, v133, v138
    v_cmp_eq_u32 vcc, 0, v134
    v_mov_b32 v140, s83
    v_mul_lo_u32 v133, v133, s72
    v_cndmask_b32 v140, v140, v141
    v_add_u32 v133, v133, v140
    v_and_b32 v141, 3, v139
    v_lshl_add_u32 v6, v141, 4, v133
    buffer_load_dwordx4 v6, s[20:23], s78 offen offset:2048 lds
    s_waitcnt lgkmcnt(0)
    s_or_b32 s100, s100, 1
    v_mov_b32 v1, s100
    s_add_u32 s78, s78, 0x15800
    s_add_u32 m0, s75, 0x3000
    v_and_b32 v128, 31, v0
    buffer_load_dwordx4 v4, s[16:19], s77 offen lds
    buffer_load_dwordx4 v5, s[16:19], s77 offen offset:1024 lds
    buffer_load_dwordx4 v6, s[20:23], s78 offen offset:2048 lds
    s_add_u32 m0, s74, 0x2000
    s_add_u32 s77, s77, 0x40000
    buffer_load_dwordx4 v2, s[12:15], 0 offen lds
    buffer_load_dwordx4 v3, s[12:15], 0 offen offset:1024 lds
    buffer_load_dwordx4 v2, s[12:15], s79 offen offset:2048 lds
    buffer_load_dwordx4 v3, s[12:15], s79 offen offset:3072 lds
    s_add_u32 m0, s74, 0x3000
    s_add_u32 s78, s78, 0x15800
    buffer_load_dwordx4 v2, s[12:15], s80 offen lds
    buffer_load_dwordx4 v3, s[12:15], s80 offen offset:1024 lds
    buffer_load_dwordx4 v2, s[12:15], s81 offen offset:2048 lds
    buffer_load_dwordx4 v3, s[12:15], s81 offen offset:3072 lds
    s_add_u32 m0, s75, 0x6000
    v_add_u32 v2, 0x80, v2
    buffer_load_dwordx4 v4, s[16:19], s77 offen lds
    buffer_load_dwordx4 v5, s[16:19], s77 offen offset:1024 lds
    buffer_load_dwordx4 v6, s[20:23], s78 offen offset:2048 lds
    v_add_u32 v3, 0x80, v3
    s_add_u32 m0, s74, 0x4000
    v_lshrrev_b32 v129, 5, v0
    buffer_load_dwordx4 v2, s[12:15], 0 offen lds
    buffer_load_dwordx4 v3, s[12:15], 0 offen offset:1024 lds
    buffer_load_dwordx4 v2, s[12:15], s79 offen offset:2048 lds
    buffer_load_dwordx4 v3, s[12:15], s79 offen offset:3072 lds
    s_add_u32 m0, s74, 0x5000
    v_bfe_u32 v133, v128, 1, 3
    buffer_load_dwordx4 v2, s[12:15], s80 offen lds
    buffer_load_dwordx4 v3, s[12:15], s80 offen offset:1024 lds
    buffer_load_dwordx4 v2, s[12:15], s81 offen offset:2048 lds
    buffer_load_dwordx4 v3, s[12:15], s81 offen offset:3072 lds
    v_xor_b32 v133, v133, v129
    v_lshlrev_b32 v133, 4, v133
    v_lshl_add_u32 v133, v128, 7, v133
    v_add_u32 v133, s74, v133
    v_xor_b32 v8, 0, v133
    v_xor_b32 v9, 32, v133
    v_xor_b32 v10, 64, v133
    v_xor_b32 v11, 0x60, v133
    s_mov_b32 s72, 0xc00
    v_mul_lo_u32 v133, v129, s72
    v_add_u32 v133, 0x18000, v133
    v_bfe_u32 v131, v0, 2, 2
    v_add_u32 v133, v133, v135
    v_lshl_add_u32 v134, v131, 8, v133
    v_xor_b32 v140, 0, v131
    v_lshl_add_u32 v12, v140, 6, v134
    v_xor_b32 v140, 1, v131
    v_lshl_add_u32 v13, v140, 6, v134
    v_xor_b32 v140, 2, v131
    v_lshl_add_u32 v14, v140, 6, v134
    v_xor_b32 v140, 3, v131
    v_lshl_add_u32 v15, v140, 6, v134
    v_xor_b32 v140, v142, v131
    v_lshl_add_u32 v18, v140, 6, v134
    v_lshl_add_u32 v134, v131, 7, v133
    v_lshrrev_b32 v141, 1, v131
    v_add_u32 v134, 0x800, v134
    v_xor_b32 v140, 0, v141
    v_lshl_add_u32 v16, v140, 6, v134
    v_xor_b32 v140, 1, v141
    v_lshl_add_u32 v17, v140, 6, v134
    v_and_b32 v140, 1, v142
    v_xor_b32 v140, v140, v141
    v_lshl_add_u32 v19, v140, 6, v134
    v_and_b32 v133, 19, v128
    v_bfe_u32 v134, v128, 2, 1
    v_lshl_or_b32 v133, v134, 3, v133
    v_bfe_u32 v134, v128, 3, 1
    v_lshl_or_b32 v133, v134, 2, v133
    v_and_b32 v134, 15, v133
    v_xor_b32 v134, v134, v129
    v_lshlrev_b32 v134, 4, v134
    v_lshl_add_u32 v134, v133, 8, v134
    v_lshrrev_b32 v140, 1, v142
    s_mov_b32 s72, 0x1800
    v_lshl_add_u32 v133, v129, 3, v131
    v_mul_lo_u32 v140, v140, s72
    s_cmp_eq_u32 s2, 0
    s_cselect_b32 s72, 0, 0x7ffffff0
    v_lshlrev_b32 v133, 8, v133
    v_add_u32 v19, v19, v140
    v_add_u32 v133, v133, v135
    v_add_u32 v133, 0x10000, v133
    v_xor_b32 v140, 0, v131
    v_lshl_add_u32 v32, v140, 6, v133
    v_xor_b32 v140, 1, v131
    v_lshl_add_u32 v33, v140, 6, v133
    v_xor_b32 v140, 2, v131
    v_lshl_add_u32 v34, v140, 6, v133
    v_xor_b32 v140, 3, v131
    v_xor_b32 v24, 0, v134
    v_xor_b32 v25, 32, v134
    v_xor_b32 v26, 64, v134
    v_xor_b32 v27, 0x60, v134
    v_xor_b32 v28, 0x80, v134
    v_xor_b32 v29, 0xa0, v134
    v_xor_b32 v30, 0xc0, v134
    v_xor_b32 v31, 0xe0, v134
    v_lshl_add_u32 v35, v140, 6, v133
    v_cmp_eq_u32 vcc, 0, v0
    v_mov_b32 v133, 0x7ffffff0
    v_mov_b32 v134, 0
    v_cndmask_b32 v7, v133, v134
    v_cmp_gt_u32 vcc, 8, v0
    v_mov_b32 v134, 0x7ffffff0
    s_lshl_b32 s70, s65, 19
    v_cndmask_b32 v23, v134, v23
    v_or_b32 v23, s72, v23
    v_or_b32 v23, s71, v23
    buffer_store_dword v1, v23, s[8:11], 0 offen sc1
    s_add_u32 s70, s70, 0x60000
    v_and_b32 v60, 31, v0
    s_add_u32 s24, s38, s70
    s_addc_u32 s25, s39, 0
    s_add_u32 s28, s40, s70
    s_addc_u32 s29, s41, 0
    v_min_u32 v61, 23, v60
    v_lshlrev_b32 v60, 2, v60
    v_lshlrev_b32 v61, 2, v61
    s_cmp_eq_u32 s62, 0
    s_cselect_b32 s99, 0, 1
    v_mov_b32 v42, 0x3f803f80
    s_mov_b32 s4, s60
    s_and_b32 s5, s61, 0xffff
    s_mov_b32 s6, 0x10000000
    s_mov_b32 s7, 0x20000
    s_and_b32 s25, s25, 0xffff
    s_mov_b32 s26, 0x20000
    s_mov_b32 s27, 0x20000
    s_and_b32 s29, s29, 0xffff
    s_mov_b32 s30, 0x20000
    s_mov_b32 s31, 0x20000
    s_lshl_b32 s76, s62, 11
    v_subrev_u32 v21, 0x400, v21
    v_mov_b32 v40, v128
    v_mov_b32 v41, v129
    v_or_b32 v58, s71, v7
    v_or_b32 v60, s71, v60
    v_or_b32 v61, s71, v61
    v_mov_b32 v43, 0
    v_accvgpr_write_b32 a224, v42
    v_accvgpr_write_b32 a225, v42
    v_accvgpr_write_b32 a226, v42
    v_accvgpr_write_b32 a227, v42
    s_add_u32 s77, s77, 0x40000
    s_add_u32 s78, s78, 0x15800
    v_add_u32 v2, 0x80, v2
    v_add_u32 v3, 0x80, v3
    s_mov_b32 s32, s56
    s_and_b32 s33, s57, 0xffff
    s_mov_b32 s34, 0x200000
    s_mov_b32 s35, 0x20000
    v_lshlrev_b32 v1, 15, v0
    buffer_load_dword a253, v1, s[32:35], 0 offen
    s_add_u32 m0, s75, 0x9000
    s_cmp_eq_u32 s62, 0
    s_cselect_b32 s90, 0, 0x7ffffff0
    s_and_b32 s89, s2, 7
    v_mov_b32 v39, s90
    s_lshl_b32 s89, s89, 5
    s_lshl_b32 s90, s66, 7
    s_add_u32 s90, s90, 0x80000
    v_lshlrev_b32 v23, 3, v40
    s_mov_b32 s86, 0
    s_mov_b32 s87, 0
    s_lshl_b32 s83, s65, 2
    s_lshl_b32 s82, s66, 7
    s_add_u32 s82, s82, 0x80800
    s_lshr_b32 s93, s64, 2
    s_and_b32 s46, s64, 3
    s_lshl_b32 s0, s63, 2
    s_lshl_b32 s1, s62, 10
    s_add_u32 s46, s46, s0
    s_lshl_b32 s0, s46, 18
    s_mul_i32 s48, s62, 0x6000
    s_mov_b32 s49, 0xf800
    s_lshr_b32 s47, s64, 2
    s_mul_i32 s59, s47, 3
    s_add_u32 s59, s59, 0
    s_lshl_b32 s3, s59, 7
    s_lshl_b32 s58, s62, 5
    s_add_u32 s3, s3, s58
    s_lshl_b32 s3, s3, 10
    s_add_u32 s3, s3, 0x700000
    s_lshl_b32 s58, s62, 5
    s_mul_i32 s72, s99, 0x7ffffff0
    s_mul_i32 s60, s62, 3
    s_add_u32 s60, s60, 0
    s_waitcnt vmcnt(21)
    s_barrier
    buffer_load_dwordx4 v4, s[16:19], s77 offen lds
    ds_read_b64_tr_b16 v[64:65], v18
    v_lshlrev_b32 v56, 16, v48
    ds_read_b64_tr_b16 v[66:67], v18 offset:1024
    v_and_b32 v57, 0xffff0000, v48
    ds_read_b128 a[192:195], v8
    v_add_f32 v44, v56, v57
    v_lshlrev_b32 v56, 16, v49
    v_and_b32 v57, 0xffff0000, v49
    ds_read_b64_tr_b16 v[80:81], v12
    v_add_f32 v44, v44, v56
    ds_read_b64_tr_b16 v[82:83], v12 offset:1024
    v_add_f32 v44, v44, v57
    ds_read_b128 a[196:199], v8 offset:4096
    v_lshlrev_b32 v56, 16, v50
    v_and_b32 v57, 0xffff0000, v50
    buffer_load_dwordx4 v5, s[16:19], s77 offen offset:1024 lds
    s_add_u32 s77, s77, 0x40000
    ds_read_b64_tr_b16 v[84:85], v13
    v_add_f32 v44, v44, v56
    ds_read_b64_tr_b16 v[86:87], v13 offset:1024
    v_add_f32 v44, v44, v57
    ds_read_b64_tr_b16 v[88:89], v14
    v_lshlrev_b32 v56, 16, v51
    ds_read_b64_tr_b16 v[90:91], v14 offset:1024
    v_and_b32 v57, 0xffff0000, v51
    ds_read_b64_tr_b16 v[92:93], v15
    v_add_f32 v44, v44, v56
    ds_read_b64_tr_b16 v[94:95], v15 offset:1024
    v_add_f32 v44, v44, v57
    ds_read_b64_tr_b16 v[96:97], v16
    v_and_b32 v57, 0xffff0000, v48
    buffer_load_dwordx4 v6, s[20:23], s78 offen offset:2048 lds
    s_add_u32 s78, s78, 0x15800
    s_add_u32 m0, s75, 0xc000
    ds_read_b64_tr_b16 v[98:99], v16 offset:512
    v_add_f32_dpp v44, v44, v44 row_ror:8 row_mask:0xf bank_mask:0xf
    s_waitcnt lgkmcnt(12)
    v_mfma_f32_32x32x16_bf16 a[228:243], v[64:67], a[224:227], 0
    ds_read_b64_tr_b16 v[100:101], v17
    v_add_f32_dpp v44, v44, v44 row_ror:4 row_mask:0xf bank_mask:0xf
    ds_read_b64_tr_b16 v[102:103], v17 offset:512
    s_lshl_b32 s88, s92, 3
    s_lshl_b32 s92, s93, 7
    s_waitcnt lgkmcnt(11)
    v_mfma_f32_32x32x16_bf16 v[128:143], v[80:83], a[192:195], 0
    buffer_load_dwordx4 v4, s[16:19], s77 offen lds
    s_add_u32 s92, s92, 0x81000
    ds_read_b64_tr_b16 v[72:73], v18 offset:6144
    v_add_f32_dpp v44, v44, v44 row_ror:2 row_mask:0xf bank_mask:0xf
    ds_read_b64_tr_b16 v[74:75], v18 offset:7168
    s_waitcnt lgkmcnt(12)
    v_mfma_f32_32x32x16_bf16 v[192:207], v[80:83], a[196:199], 0
    ds_read_b128 a[200:203], v9
    v_add_f32_dpp v44, v44, v44 row_ror:1 row_mask:0xf bank_mask:0xf
    v_mov_b32 v56, v44
    s_add_u32 s91, s88, 0x10000
    ds_read_b64_tr_b16 v[104:105], v12 offset:6144
    s_waitcnt lgkmcnt(12)
    v_mfma_f32_32x32x16_bf16 v[144:159], v[84:87], a[192:195], 0
    buffer_load_dwordx4 v5, s[16:19], s77 offen offset:1024 lds
    s_add_u32 s77, s77, 0x40000
    ds_read_b64_tr_b16 v[106:107], v12 offset:7168
    v_permlane16_swap_b32 v44, v56
    ds_read_b128 a[204:207], v9 offset:4096
    v_add_f32 v44, v44, v56
    v_mfma_f32_32x32x16_bf16 v[208:223], v[84:87], a[196:199], 0
    ds_read_b64_tr_b16 v[108:109], v13 offset:6144
    v_mov_b32 v56, v44
    ds_read_b64_tr_b16 v[110:111], v13 offset:7168
    v_lshlrev_b32 v78, 2, v40
    ds_read_b64_tr_b16 v[112:113], v14 offset:6144
    s_waitcnt lgkmcnt(14)
    v_mfma_f32_32x32x16_bf16 v[160:175], v[88:91], a[192:195], 0
    buffer_load_dwordx4 v6, s[20:23], s78 offen offset:2048 lds
    s_add_u32 s78, s78, 0x15800
    s_add_u32 m0, s75, 0
    ds_read_b64_tr_b16 v[114:115], v14 offset:7168
    v_permlane32_swap_b32 v44, v56
    ds_read_b64_tr_b16 v[116:117], v15 offset:6144
    v_mfma_f32_32x32x16_bf16 v[224:239], v[88:91], a[196:199], 0
    ds_read_b64_tr_b16 v[118:119], v15 offset:7168
    v_add_f32 v44, v44, v56
    ds_read_b64_tr_b16 v[120:121], v16 offset:6144
    v_mul_f32 v45, 0x3b000000, v44
    ds_read_b64_tr_b16 v[122:123], v16 offset:6656
    s_waitcnt lgkmcnt(14)
    v_mfma_f32_32x32x16_bf16 v[176:191], v[92:95], a[192:195], 0
    ds_read_b64_tr_b16 v[124:125], v17 offset:6144
    v_lshlrev_b32 v56, 16, v48
    ds_read_b64_tr_b16 v[126:127], v17 offset:6656
    v_sub_f32 v56, v56, v45
    ds_read_b64_tr_b16 v[64:65], v18 offset:12288
    v_sub_f32 v57, v57, v45
    v_mfma_f32_32x32x16_bf16 v[240:255], v[92:95], a[196:199], 0
    ds_read_b64_tr_b16 v[66:67], v18 offset:13312
    v_mul_f32 v44, v56, v56
    ds_read_b128 a[208:211], v10
    v_fmac_f32 v44, v57, v57
    v_lshlrev_b32 v56, 16, v49
    v_and_b32 v57, 0xffff0000, v49
    v_mfma_f32_32x32x16_bf16 a[128:143], v[96:99], a[192:195], 0
    ds_read_b64_tr_b16 v[80:81], v12 offset:12288
    v_sub_f32 v56, v56, v45
    ds_read_b64_tr_b16 v[82:83], v12 offset:13312
    v_sub_f32 v57, v57, v45
    ds_read_b128 a[212:215], v10 offset:4096
    v_fmac_f32 v44, v56, v56
    v_mfma_f32_32x32x16_bf16 a[144:159], v[96:99], a[196:199], 0
    ds_read_b64_tr_b16 v[84:85], v13 offset:12288
    v_fmac_f32 v44, v57, v57
    ds_read_b64_tr_b16 v[86:87], v13 offset:13312
    v_lshlrev_b32 v56, 16, v50
    ds_read_b64_tr_b16 v[88:89], v14 offset:12288
    v_and_b32 v57, 0xffff0000, v50
    v_mfma_f32_32x32x16_bf16 a[160:175], v[100:103], a[192:195], 0
    ds_read_b64_tr_b16 v[90:91], v14 offset:13312
    v_sub_f32 v56, v56, v45
    ds_read_b64_tr_b16 v[92:93], v15 offset:12288
    v_sub_f32 v57, v57, v45
    ds_read_b64_tr_b16 v[94:95], v15 offset:13312
    v_fmac_f32 v44, v56, v56
    v_mfma_f32_32x32x16_bf16 a[176:191], v[100:103], a[196:199], 0
    ds_read_b64_tr_b16 v[96:97], v16 offset:12288
    v_fmac_f32 v44, v57, v57
    ds_read_b64_tr_b16 v[98:99], v16 offset:12800
    v_lshlrev_b32 v56, 16, v51
    ds_read_b64_tr_b16 v[100:101], v17 offset:12288
    s_waitcnt lgkmcnt(15)
    v_mfma_f32_32x32x16_bf16 a[228:243], v[72:75], a[224:227], a[228:243]
    ds_read_b64_tr_b16 v[102:103], v17 offset:12800
    v_and_b32 v57, 0xffff0000, v51
    ds_read_b64_tr_b16 v[72:73], v18 offset:18432
    v_sub_f32 v56, v56, v45
    ds_read_b64_tr_b16 v[74:75], v18 offset:19456
    v_sub_f32 v57, v57, v45
    v_mfma_f32_32x32x16_bf16 v[128:143], v[104:107], a[200:203], v[128:143]
    ds_read_b128 a[216:219], v11
    v_fmac_f32 v44, v56, v56
    v_fmac_f32 v44, v57, v57
    v_and_b32 v57, 0xffff0000, v52
    ds_read_b128 a[220:223], v11 offset:4096
    v_add_f32_dpp v44, v44, v44 row_ror:8 row_mask:0xf bank_mask:0xf
    v_mfma_f32_32x32x16_bf16 v[192:207], v[104:107], a[204:207], v[192:207]
    ds_read_b64_tr_b16 v[104:105], v12 offset:18432
    v_add_f32_dpp v44, v44, v44 row_ror:4 row_mask:0xf bank_mask:0xf
    ds_read_b64_tr_b16 v[106:107], v12 offset:19456
    v_cvt_pk_bf16_f32 v48, v45, v45
    ds_read_b64_tr_b16 v[68:69], v19
    v_add_f32_dpp v44, v44, v44 row_ror:2 row_mask:0xf bank_mask:0xf
    v_mfma_f32_32x32x16_bf16 v[144:159], v[108:111], a[200:203], v[144:159]
    ds_read_b64_tr_b16 v[70:71], v19 offset:512
    v_add_f32_dpp v44, v44, v44 row_ror:1 row_mask:0xf bank_mask:0xf
    s_waitcnt vmcnt(23)
    ds_read_b128 a[192:195], v8 offset:8192
    v_mov_b32 v56, v44
    v_and_b32 v48, 0xffff0000, v48
    s_lshl_b32 s67, s62, 7
    v_mfma_f32_32x32x16_bf16 v[208:223], v[108:111], a[204:207], v[208:223]
    ds_read_b64_tr_b16 v[108:109], v13 offset:18432
    v_permlane16_swap_b32 v44, v56
    ds_read_b64_tr_b16 v[110:111], v13 offset:19456
    v_add_f32 v44, v44, v56
    s_waitcnt vmcnt(19)
    ds_read_b128 a[196:199], v8 offset:12288
    v_mov_b32 v56, v44
    v_mfma_f32_32x32x16_bf16 v[160:175], v[112:115], a[200:203], v[160:175]
    v_add_u32 v78, 0x27000, v78
    v_permlane32_swap_b32 v44, v56
    v_add_f32 v44, v44, v56
    v_mul_f32 v44, 0x3b000000, v44
    v_cvt_pk_bf16_f32 v44, v44, v44
    v_and_b32 v44, 0xffff0000, v44
    v_mfma_f32_32x32x16_bf16 v[224:239], v[112:115], a[204:207], v[224:239]
    ds_read_b64_tr_b16 v[112:113], v14 offset:18432
    v_add_f32 v44, 0x3727c5ac, v44
    ds_read_b64_tr_b16 v[114:115], v14 offset:19456
    v_cvt_pk_bf16_f32 v44, v44, v44
    v_and_b32 v44, 0xffff0000, v44
    v_lshlrev_b32 v56, 16, v52
    v_mfma_f32_32x32x16_bf16 v[176:191], v[116:119], a[200:203], v[176:191]
    s_waitcnt lgkmcnt(7)
    v_lshlrev_b32 v76, 16, v68
    v_add_f32 v43, v43, v76
    v_and_b32 v77, 0xffff0000, v68
    v_add_f32 v43, v43, v77
    v_lshlrev_b32 v76, 16, v69
    v_mfma_f32_32x32x16_bf16 v[240:255], v[116:119], a[204:207], v[240:255]
    ds_read_b64_tr_b16 v[116:117], v15 offset:18432
    v_add_f32 v43, v43, v76
    ds_read_b64_tr_b16 v[118:119], v15 offset:19456
    v_and_b32 v77, 0xffff0000, v69
    v_add_f32 v43, v43, v77
    ds_read_b64_tr_b16 v[68:69], v19 offset:12288
    v_mfma_f32_32x32x16_bf16 a[128:143], v[120:123], a[200:203], a[128:143]
    s_waitcnt lgkmcnt(9)
    v_lshlrev_b32 v76, 16, v70
    v_add_f32 v43, v43, v76
    v_and_b32 v77, 0xffff0000, v70
    v_add_f32 v43, v43, v77
    v_lshlrev_b32 v76, 16, v71
    v_mfma_f32_32x32x16_bf16 a[144:159], v[120:123], a[204:207], a[144:159]
    v_and_b32 v77, 0xffff0000, v71
    ds_read_b64_tr_b16 v[70:71], v19 offset:12800
    v_sqrt_f32 v44, v44
    ds_read_b64_tr_b16 v[120:121], v16 offset:18432
    v_cvt_pk_bf16_f32 v44, v44, v44
    v_mfma_f32_32x32x16_bf16 a[160:175], v[124:127], a[200:203], a[160:175]
    ds_read_b64_tr_b16 v[122:123], v16 offset:18944
    v_and_b32 v44, 0xffff0000, v44
    ds_read_b128 a[200:203], v9 offset:8192
    v_rcp_f32 v36, v44
    v_add_f32 v44, v56, v57
    v_mfma_f32_32x32x16_bf16 a[176:191], v[124:127], a[204:207], a[176:191]
    ds_read_b64_tr_b16 v[124:125], v17 offset:18432
    v_lshlrev_b32 v56, 16, v53
    ds_read_b64_tr_b16 v[126:127], v17 offset:18944
    v_and_b32 v57, 0xffff0000, v53
    ds_read_b128 a[204:207], v9 offset:12288
    v_add_f32 v44, v44, v56
    v_mfma_f32_32x32x16_bf16 a[228:243], v[64:67], a[224:227], a[228:243]
    v_add_f32 v44, v44, v57
    v_lshlrev_b32 v56, 16, v54
    v_and_b32 v57, 0xffff0000, v54
    v_add_f32 v44, v44, v56
    v_add_f32 v44, v44, v57
    v_lshlrev_b32 v56, 16, v55
    v_mfma_f32_32x32x16_bf16 v[128:143], v[80:83], a[208:211], v[128:143]
    v_and_b32 v57, 0xffff0000, v55
    v_add_f32 v44, v44, v56
    v_add_f32 v44, v44, v57
    v_and_b32 v57, 0xffff0000, v52
    v_mov_b32 v49, v36
    v_add_f32_dpp v44, v44, v44 row_ror:8 row_mask:0xf bank_mask:0xf
    v_mfma_f32_32x32x16_bf16 v[192:207], v[80:83], a[212:215], v[192:207]
    v_add_f32 v43, v43, v76
    v_add_f32_dpp v44, v44, v44 row_ror:4 row_mask:0xf bank_mask:0xf
    v_add_f32 v43, v43, v77
    s_waitcnt lgkmcnt(7)
    v_lshlrev_b32 v76, 16, v68
    v_add_f32_dpp v44, v44, v44 row_ror:2 row_mask:0xf bank_mask:0xf
    v_mfma_f32_32x32x16_bf16 v[144:159], v[84:87], a[208:211], v[144:159]
    v_add_f32 v43, v43, v76
    v_add_f32_dpp v44, v44, v44 row_ror:1 row_mask:0xf bank_mask:0xf
    v_mov_b32 v56, v44
    v_and_b32 v77, 0xffff0000, v68
    v_add_f32 v43, v43, v77
    v_permlane16_swap_b32 v44, v56
    v_mfma_f32_32x32x16_bf16 v[208:223], v[84:87], a[212:215], v[208:223]
    v_add_f32 v44, v44, v56
    v_mov_b32 v56, v44
    v_lshlrev_b32 v76, 16, v69
    v_add_f32 v43, v43, v76
    v_permlane32_swap_b32 v44, v56
    v_add_f32 v44, v44, v56
    v_mfma_f32_32x32x16_bf16 v[160:175], v[88:91], a[208:211], v[160:175]
    v_mul_f32 v47, 0x3b000000, v44
    v_lshlrev_b32 v56, 16, v52
    v_sub_f32 v56, v56, v47
    v_sub_f32 v57, v57, v47
    v_mul_f32 v44, v56, v56
    v_fmac_f32 v44, v57, v57
    v_mfma_f32_32x32x16_bf16 v[224:239], v[88:91], a[212:215], v[224:239]
    v_lshlrev_b32 v56, 16, v53
    v_and_b32 v57, 0xffff0000, v53
    v_sub_f32 v56, v56, v47
    v_sub_f32 v57, v57, v47
    v_fmac_f32 v44, v56, v56
    v_fmac_f32 v44, v57, v57
    v_mfma_f32_32x32x16_bf16 v[176:191], v[92:95], a[208:211], v[176:191]
    v_lshlrev_b32 v56, 16, v54
    v_and_b32 v57, 0xffff0000, v54
    v_sub_f32 v56, v56, v47
    v_sub_f32 v57, v57, v47
    v_fmac_f32 v44, v56, v56
    v_fmac_f32 v44, v57, v57
    v_mfma_f32_32x32x16_bf16 v[240:255], v[92:95], a[212:215], v[240:255]
    v_lshlrev_b32 v56, 16, v55
    v_and_b32 v57, 0xffff0000, v55
    v_sub_f32 v56, v56, v47
    v_sub_f32 v57, v57, v47
    v_fmac_f32 v44, v56, v56
    v_fmac_f32 v44, v57, v57
    v_mfma_f32_32x32x16_bf16 a[128:143], v[96:99], a[208:211], a[128:143]
    v_cvt_pk_bf16_f32 v50, v47, v47
    v_lshlrev_b32 v47, 3, v40
    v_add_f32_dpp v44, v44, v44 row_ror:8 row_mask:0xf bank_mask:0xf
    v_and_b32 v50, 0xffff0000, v50
    v_and_b32 v77, 0xffff0000, v69
    v_add_f32_dpp v44, v44, v44 row_ror:4 row_mask:0xf bank_mask:0xf
    v_mfma_f32_32x32x16_bf16 a[144:159], v[96:99], a[212:215], a[144:159]
    v_add_f32 v43, v43, v77
    v_add_f32_dpp v44, v44, v44 row_ror:2 row_mask:0xf bank_mask:0xf
    s_waitcnt lgkmcnt(0)
    v_lshlrev_b32 v76, 16, v70
    v_add_f32_dpp v44, v44, v44 row_ror:1 row_mask:0xf bank_mask:0xf
    v_mov_b32 v56, v44
    v_mfma_f32_32x32x16_bf16 a[160:175], v[100:103], a[208:211], a[160:175]
    ds_read_b128 a[208:211], v10 offset:8192
    v_permlane16_swap_b32 v44, v56
    v_add_f32 v44, v44, v56
    v_mov_b32 v56, v44
    v_add_f32 v43, v43, v76
    v_and_b32 v77, 0xffff0000, v70
    v_mfma_f32_32x32x16_bf16 a[176:191], v[100:103], a[212:215], a[176:191]
    ds_read_b128 a[212:215], v10 offset:12288
    v_permlane32_swap_b32 v44, v56
    v_add_f32 v44, v44, v56
    v_mul_f32 v44, 0x3b000000, v44
    v_cvt_pk_bf16_f32 v44, v44, v44
    v_and_b32 v44, 0xffff0000, v44
    v_mfma_f32_32x32x16_bf16 a[228:243], v[72:75], a[224:227], a[228:243]
    v_add_f32 v44, 0x3727c5ac, v44
    v_cvt_pk_bf16_f32 v44, v44, v44
    v_and_b32 v44, 0xffff0000, v44
    v_sqrt_f32 v44, v44
    v_add_f32 v43, v43, v77
    v_mfma_f32_32x32x16_bf16 v[128:143], v[104:107], a[216:219], v[128:143]
    v_cvt_pk_bf16_f32 v44, v44, v44
    v_and_b32 v44, 0xffff0000, v44
    v_rcp_f32 v37, v44
    v_lshlrev_b32 v76, 16, v71
    v_mov_b32 v51, v37
    v_mfma_f32_32x32x16_bf16 v[192:207], v[104:107], a[220:223], v[192:207]
    buffer_store_dwordx4 v[48:51], v7, s[4:7], s88 offen sc1
    v_and_b32 v77, 0xffff0000, v71
    v_add_f32 v43, v43, v76
    v_add_f32 v43, v43, v77
    v_mov_b32 v52, 0
    v_mov_b32 v53, 0
    v_mfma_f32_32x32x16_bf16 v[144:159], v[108:111], a[216:219], v[144:159]
    v_mov_b32 v54, 0
    v_mov_b32 v55, 0
    s_add_u32 s68, s67, 0x27000
    v_add_u32 v79, s67, v78
    s_lshl_b32 s67, s62, 6
    v_mov_b32 v44, 0xbdd2d3e8
    v_mfma_f32_32x32x16_bf16 v[208:223], v[108:111], a[220:223], v[208:223]
    s_waitcnt vmcnt(4)
    s_barrier
    buffer_load_dword v59, v39, s[8:11], s89 offen sc1
    v_mfma_f32_32x32x16_bf16 v[160:175], v[112:115], a[216:219], v[160:175]
    ds_read_b64_tr_b16 v[64:65], v18 offset:24576
    buffer_load_dwordx4 v4, s[16:19], s77 offen lds
    ds_read_b64_tr_b16 v[66:67], v18 offset:25600
    v_mov_b32 v48, 0
    ds_read_b64_tr_b16 v[80:81], v12 offset:24576
    v_mov_b32 v49, 0
    v_mfma_f32_32x32x16_bf16 v[224:239], v[112:115], a[220:223], v[224:239]
    ds_read_b64_tr_b16 v[82:83], v12 offset:25600
    v_mov_b32 v50, 0
    ds_read_b64_tr_b16 v[84:85], v13 offset:24576
    v_mov_b32 v51, 0
    ds_read_b64_tr_b16 v[86:87], v13 offset:25600
    v_mov_b32 v57, 0x41000000
    v_mfma_f32_32x32x16_bf16 v[176:191], v[116:119], a[216:219], v[176:191]
    ds_read_b64_tr_b16 v[88:89], v14 offset:24576
    buffer_load_dwordx4 v5, s[16:19], s77 offen offset:1024 lds
    s_add_u32 s77, s77, 0x40000
    ds_read_b64_tr_b16 v[90:91], v14 offset:25600
    s_lshl_b32 s69, s62, 12
    ds_read_b64_tr_b16 v[92:93], v15 offset:24576
    v_mfma_f32_32x32x16_bf16 v[240:255], v[116:119], a[220:223], v[240:255]
    ds_read_b64_tr_b16 v[94:95], v15 offset:25600
    s_add_u32 s69, s69, 0x20000
    ds_read_b64_tr_b16 v[96:97], v16 offset:24576
    s_lshl_b32 s70, s84, 7
    ds_read_b64_tr_b16 v[98:99], v16 offset:25088
    s_lshl_b32 s73, s64, 2
    v_mfma_f32_32x32x16_bf16 a[128:143], v[120:123], a[216:219], a[128:143]
    ds_read_b64_tr_b16 v[100:101], v17 offset:24576
    buffer_load_dwordx4 v6, s[20:23], s78 offen offset:2048 lds
    s_add_u32 s78, s78, 0x15800
    s_add_u32 m0, s75, 0x3000
    ds_read_b64_tr_b16 v[102:103], v17 offset:25088
    s_add_u32 s73, s73, s62
    v_mfma_f32_32x32x16_bf16 a[144:159], v[120:123], a[220:223], a[144:159]
    ds_read_b64_tr_b16 v[72:73], v18 offset:30720
    s_lshl_b32 s73, s73, 13
    ds_read_b64_tr_b16 v[74:75], v18 offset:31744
    s_lshl_b32 s61, s63, 20
    ds_read_b64_tr_b16 v[104:105], v12 offset:30720
    s_add_u32 s73, s73, s61
    v_mfma_f32_32x32x16_bf16 a[160:175], v[124:127], a[216:219], a[160:175]
    ds_read_b64_tr_b16 v[106:107], v12 offset:31744
    buffer_load_dwordx4 v4, s[16:19], s77 offen lds
    ds_read_b64_tr_b16 v[108:109], v13 offset:30720
    s_mov_b32 s32, s50
    ds_read_b64_tr_b16 v[110:111], v13 offset:31744
    s_and_b32 s33, s51, 0xffff
    v_mfma_f32_32x32x16_bf16 a[176:191], v[124:127], a[220:223], a[176:191]
    ds_read_b64_tr_b16 v[112:113], v14 offset:30720
    s_mov_b32 s34, 0x800000
    ds_read_b64_tr_b16 v[114:115], v14 offset:31744
    s_mov_b32 s35, 0x20000
    ds_read_b64_tr_b16 v[116:117], v15 offset:30720
    s_waitcnt lgkmcnt(15)
    v_mfma_f32_32x32x16_bf16 a[228:243], v[64:67], a[224:227], a[228:243]
    ds_read_b64_tr_b16 v[118:119], v15 offset:31744
    buffer_load_dwordx4 v5, s[16:19], s77 offen offset:1024 lds
    s_add_u32 s77, s77, 0x40000
    ds_read_b64_tr_b16 v[120:121], v16 offset:30720
    s_add_u32 s73, s73, 0
    ds_read_b64_tr_b16 v[122:123], v16 offset:31232
    v_mfma_f32_32x32x16_bf16 v[128:143], v[80:83], a[192:195], v[128:143]
    ds_read_b64_tr_b16 v[124:125], v17 offset:30720
    s_lshl_b32 s61, s63, 20
    ds_read_b64_tr_b16 v[126:127], v17 offset:31232
    ds_read_b64_tr_b16 v[64:65], v18 offset:36864
    v_mfma_f32_32x32x16_bf16 v[192:207], v[80:83], a[196:199], v[192:207]
    ds_read_b64_tr_b16 v[66:67], v18 offset:37888
    buffer_load_dwordx4 v6, s[20:23], s78 offen offset:2048 lds
    s_add_u32 m0, s74, 0
    s_add_u32 s78, s78, 0x15800
    ds_read_b64_tr_b16 v[80:81], v12 offset:36864
    v_mfma_f32_32x32x16_bf16 v[144:159], v[84:87], a[192:195], v[144:159]
    ds_read_b64_tr_b16 v[82:83], v12 offset:37888
    ds_read_b128 a[216:219], v11 offset:8192
    v_mfma_f32_32x32x16_bf16 v[208:223], v[84:87], a[196:199], v[208:223]
    ds_read_b64_tr_b16 v[84:85], v13 offset:36864
    buffer_load_dwordx4 v2, s[12:15], 0 offen lds
    ds_read_b64_tr_b16 v[86:87], v13 offset:37888
    ds_read_b128 a[220:223], v11 offset:12288
    v_mfma_f32_32x32x16_bf16 v[160:175], v[88:91], a[192:195], v[160:175]
    ds_read_b64_tr_b16 v[68:69], v19 offset:24576
    ds_read_b64_tr_b16 v[70:71], v19 offset:25088
    v_mfma_f32_32x32x16_bf16 v[224:239], v[88:91], a[196:199], v[224:239]
    ds_read_b64_tr_b16 v[88:89], v14 offset:36864
    buffer_load_dwordx4 v3, s[12:15], 0 offen offset:1024 lds
    ds_read_b64_tr_b16 v[90:91], v14 offset:37888
    s_waitcnt lgkmcnt(15)
    v_mfma_f32_32x32x16_bf16 v[176:191], v[92:95], a[192:195], v[176:191]
    v_mfma_f32_32x32x16_bf16 v[240:255], v[92:95], a[196:199], v[240:255]
    buffer_load_dwordx4 v2, s[12:15], s79 offen offset:2048 lds
    ds_read_b64_tr_b16 v[92:93], v15 offset:36864
    ds_read_b64_tr_b16 v[94:95], v15 offset:37888
    v_mfma_f32_32x32x16_bf16 a[128:143], v[96:99], a[192:195], a[128:143]
    s_waitcnt lgkmcnt(5)
    v_lshlrev_b32 v76, 16, v68
    v_add_f32 v43, v43, v76
    v_and_b32 v77, 0xffff0000, v68
    v_mfma_f32_32x32x16_bf16 a[144:159], v[96:99], a[196:199], a[144:159]
    buffer_load_dwordx4 v3, s[12:15], s79 offen offset:3072 lds
    s_add_u32 m0, s74, 0x1000
    ds_read_b64_tr_b16 v[96:97], v16 offset:36864
    v_add_f32 v43, v43, v77
    ds_read_b64_tr_b16 v[98:99], v16 offset:37376
    v_lshlrev_b32 v76, 16, v69
    v_mfma_f32_32x32x16_bf16 a[160:175], v[100:103], a[192:195], a[160:175]
    v_add_f32 v43, v43, v76
    v_and_b32 v77, 0xffff0000, v69
    v_add_f32 v43, v43, v77
    s_waitcnt lgkmcnt(6)
    v_lshlrev_b32 v76, 16, v70
    v_add_f32 v43, v43, v76
    v_mfma_f32_32x32x16_bf16 a[176:191], v[100:103], a[196:199], a[176:191]
    buffer_load_dwordx4 v2, s[12:15], s80 offen lds
    ds_read_b64_tr_b16 v[100:101], v17 offset:36864
    v_and_b32 v77, 0xffff0000, v70
    ds_read_b64_tr_b16 v[102:103], v17 offset:37376
    v_add_f32 v43, v43, v77
    v_lshlrev_b32 v76, 16, v71
    v_mfma_f32_32x32x16_bf16 a[228:243], v[72:75], a[224:227], a[228:243]
    ds_read_b64_tr_b16 v[72:73], v18 offset:43008
    v_and_b32 v77, 0xffff0000, v71
    ds_read_b64_tr_b16 v[74:75], v18 offset:44032
    v_add_f32 v43, v43, v76
    ds_read_b64_tr_b16 v[68:69], v19 offset:36864
    v_add_f32 v43, v43, v77
    v_mfma_f32_32x32x16_bf16 v[128:143], v[104:107], a[200:203], v[128:143]
    buffer_load_dwordx4 v3, s[12:15], s80 offen offset:1024 lds
    ds_read_b64_tr_b16 v[70:71], v19 offset:37376
    ds_read_b128 a[192:195], v8 offset:16384
    v_mfma_f32_32x32x16_bf16 v[192:207], v[104:107], a[204:207], v[192:207]
    ds_read_b64_tr_b16 v[104:105], v12 offset:43008
    ds_read_b64_tr_b16 v[106:107], v12 offset:44032
    ds_read_b128 a[196:199], v8 offset:20480
    v_mfma_f32_32x32x16_bf16 v[144:159], v[108:111], a[200:203], v[144:159]
    buffer_load_dwordx4 v2, s[12:15], s81 offen offset:2048 lds
    v_add_u32 v2, 0x80, v2
    v_mfma_f32_32x32x16_bf16 v[208:223], v[108:111], a[204:207], v[208:223]
    ds_read_b64_tr_b16 v[108:109], v13 offset:43008
    ds_read_b64_tr_b16 v[110:111], v13 offset:44032
    v_mfma_f32_32x32x16_bf16 v[160:175], v[112:115], a[200:203], v[160:175]
    buffer_load_dwordx4 v3, s[12:15], s81 offen offset:3072 lds
    s_add_u32 m0, s75, 0x6000
    v_add_u32 v3, 0x80, v3
    s_waitcnt lgkmcnt(7)
    v_lshlrev_b32 v76, 16, v68
    v_add_f32 v43, v43, v76
    v_mfma_f32_32x32x16_bf16 v[224:239], v[112:115], a[204:207], v[224:239]
    ds_read_b64_tr_b16 v[112:113], v14 offset:43008
    v_and_b32 v77, 0xffff0000, v68
    ds_read_b64_tr_b16 v[114:115], v14 offset:44032
    v_add_f32 v43, v43, v77
    v_lshlrev_b32 v76, 16, v69
    v_add_f32 v43, v43, v76
    v_mfma_f32_32x32x16_bf16 v[176:191], v[116:119], a[200:203], v[176:191]
    buffer_store_dwordx4 v[52:55], v7, s[4:7], s91 offen sc1
    s_lshl_b32 s88, s65, 2
    s_lshl_b32 s91, s66, 8
    v_and_b32 v77, 0xffff0000, v69
    v_add_f32 v43, v43, v77
    v_mfma_f32_32x32x16_bf16 v[240:255], v[116:119], a[204:207], v[240:255]
    ds_read_b64_tr_b16 v[116:117], v15 offset:43008
    s_waitcnt lgkmcnt(8)
    v_lshlrev_b32 v76, 16, v70
    ds_read_b64_tr_b16 v[118:119], v15 offset:44032
    v_add_f32 v43, v43, v76
    v_and_b32 v77, 0xffff0000, v70
    v_mfma_f32_32x32x16_bf16 a[128:143], v[120:123], a[200:203], a[128:143]
    v_add_f32 v43, v43, v77
    v_lshlrev_b32 v76, 16, v71
    v_and_b32 v77, 0xffff0000, v71
    v_add_f32 v43, v43, v76
    v_add_f32 v43, v43, v77
    v_mfma_f32_32x32x16_bf16 a[144:159], v[120:123], a[204:207], a[144:159]
    ds_read_b64_tr_b16 v[120:121], v16 offset:43008
    ds_read_b64_tr_b16 v[122:123], v16 offset:43520
    v_mfma_f32_32x32x16_bf16 a[160:175], v[124:127], a[200:203], a[160:175]
    ds_read_b128 a[200:203], v9 offset:16384
    v_mfma_f32_32x32x16_bf16 a[176:191], v[124:127], a[204:207], a[176:191]
    ds_read_b64_tr_b16 v[124:125], v17 offset:43008
    ds_read_b64_tr_b16 v[126:127], v17 offset:43520
    ds_read_b128 a[204:207], v9 offset:20480
    v_mfma_f32_32x32x16_bf16 a[228:243], v[64:67], a[224:227], a[228:243]
    v_mfma_f32_32x32x16_bf16 v[128:143], v[80:83], a[208:211], v[128:143]
    v_mfma_f32_32x32x16_bf16 v[192:207], v[80:83], a[212:215], v[192:207]
    v_mfma_f32_32x32x16_bf16 v[144:159], v[84:87], a[208:211], v[144:159]
    v_mfma_f32_32x32x16_bf16 v[208:223], v[84:87], a[212:215], v[208:223]
    v_mfma_f32_32x32x16_bf16 v[160:175], v[88:91], a[208:211], v[160:175]
    v_mfma_f32_32x32x16_bf16 v[224:239], v[88:91], a[212:215], v[224:239]
    v_mfma_f32_32x32x16_bf16 v[176:191], v[92:95], a[208:211], v[176:191]
    v_mfma_f32_32x32x16_bf16 v[240:255], v[92:95], a[212:215], v[240:255]
    v_mfma_f32_32x32x16_bf16 a[128:143], v[96:99], a[208:211], a[128:143]
    v_mfma_f32_32x32x16_bf16 a[144:159], v[96:99], a[212:215], a[144:159]
    v_mfma_f32_32x32x16_bf16 a[160:175], v[100:103], a[208:211], a[160:175]
    ds_read_b128 a[208:211], v10 offset:16384
    v_mfma_f32_32x32x16_bf16 a[176:191], v[100:103], a[212:215], a[176:191]
    ds_read_b128 a[212:215], v10 offset:20480
    s_waitcnt vmcnt(15)
    v_cmp_eq_u32 vcc, s99, v59
    v_mfma_f32_32x32x16_bf16 a[228:243], v[72:75], a[224:227], a[228:243]
    s_cbranch_vccnz L_slow_nonce
L_ret_nonce:
    s_lshl_b32 s89, s66, 7
    s_add_u32 s89, s89, s88
    s_add_u32 s89, s89, 0x80000
    s_lshl_b32 s88, s62, 6
    s_waitcnt lgkmcnt(2)
    v_mfma_f32_32x32x16_bf16 v[128:143], v[104:107], a[216:219], v[128:143]
    s_add_u32 s91, s91, s88
    s_lshl_b32 s91, s91, 3
    v_mfma_f32_32x32x16_bf16 v[192:207], v[104:107], a[220:223], v[192:207]
    s_waitcnt vmcnt(12)
    s_barrier
    buffer_load_dwordx4 v4, s[16:19], s77 offen lds
    v_mfma_f32_32x32x16_bf16 v[144:159], v[108:111], a[216:219], v[144:159]
    ds_read_b64_tr_b16 v[64:65], v18 offset:49152
    ds_read_b64_tr_b16 v[66:67], v18 offset:50176
    ds_read_b64_tr_b16 v[80:81], v12 offset:49152
    v_mfma_f32_32x32x16_bf16 v[208:223], v[108:111], a[220:223], v[208:223]
    ds_read_b64_tr_b16 v[82:83], v12 offset:50176
    ds_read_b64_tr_b16 v[84:85], v13 offset:49152
    ds_read_b64_tr_b16 v[86:87], v13 offset:50176
    buffer_load_dwordx4 v5, s[16:19], s77 offen offset:1024 lds
    v_mfma_f32_32x32x16_bf16 v[160:175], v[112:115], a[216:219], v[160:175]
    s_add_u32 s77, s77, 0x40000
    ds_read_b64_tr_b16 v[88:89], v14 offset:49152
    ds_read_b64_tr_b16 v[90:91], v14 offset:50176
    ds_read_b64_tr_b16 v[92:93], v15 offset:49152
    v_mfma_f32_32x32x16_bf16 v[224:239], v[112:115], a[220:223], v[224:239]
    ds_read_b64_tr_b16 v[94:95], v15 offset:50176
    ds_read_b64_tr_b16 v[96:97], v16 offset:49152
    ds_read_b64_tr_b16 v[98:99], v16 offset:49664
    buffer_load_dwordx4 v6, s[20:23], s78 offen offset:2048 lds
    v_mfma_f32_32x32x16_bf16 v[176:191], v[116:119], a[216:219], v[176:191]
    s_add_u32 s78, s78, 0x15800
    s_add_u32 m0, s75, 0x9000
    ds_read_b64_tr_b16 v[100:101], v17 offset:49152
    ds_read_b64_tr_b16 v[102:103], v17 offset:49664
    v_mfma_f32_32x32x16_bf16 v[240:255], v[116:119], a[220:223], v[240:255]
    ds_read_b64_tr_b16 v[72:73], v18 offset:55296
    ds_read_b64_tr_b16 v[74:75], v18 offset:56320
    ds_read_b64_tr_b16 v[104:105], v12 offset:55296
    buffer_load_dwordx4 v4, s[16:19], s77 offen lds
    v_mfma_f32_32x32x16_bf16 a[128:143], v[120:123], a[216:219], a[128:143]
    ds_read_b64_tr_b16 v[106:107], v12 offset:56320
    ds_read_b64_tr_b16 v[108:109], v13 offset:55296
    ds_read_b64_tr_b16 v[110:111], v13 offset:56320
    v_mfma_f32_32x32x16_bf16 a[144:159], v[120:123], a[220:223], a[144:159]
    ds_read_b64_tr_b16 v[112:113], v14 offset:55296
    ds_read_b64_tr_b16 v[114:115], v14 offset:56320
    ds_read_b64_tr_b16 v[116:117], v15 offset:55296
    buffer_load_dwordx4 v5, s[16:19], s77 offen offset:1024 lds
    v_mfma_f32_32x32x16_bf16 a[160:175], v[124:127], a[216:219], a[160:175]
    s_add_u32 s77, s77, 0x40000
    ds_read_b64_tr_b16 v[118:119], v15 offset:56320
    ds_read_b64_tr_b16 v[120:121], v16 offset:55296
    ds_read_b64_tr_b16 v[122:123], v16 offset:55808
    v_mfma_f32_32x32x16_bf16 a[176:191], v[124:127], a[220:223], a[176:191]
    ds_read_b64_tr_b16 v[124:125], v17 offset:55296
    ds_read_b64_tr_b16 v[126:127], v17 offset:55808
    ds_read_b128 a[216:219], v11 offset:16384
    s_waitcnt lgkmcnt(15)
    v_mfma_f32_32x32x16_bf16 a[228:243], v[64:67], a[224:227], a[228:243]
    buffer_load_dwordx4 v6, s[20:23], s78 offen offset:2048 lds
    s_add_u32 m0, s74, 0x2000
    s_add_u32 s78, s78, 0x15800
    ds_read_b64_tr_b16 v[64:65], v18
    ds_read_b64_tr_b16 v[66:67], v18 offset:1024
    v_mfma_f32_32x32x16_bf16 v[128:143], v[80:83], a[192:195], v[128:143]
    ds_read_b128 a[220:223], v11 offset:20480
    ds_read_b64_tr_b16 v[68:69], v19 offset:49152
    v_mfma_f32_32x32x16_bf16 v[192:207], v[80:83], a[196:199], v[192:207]
    buffer_load_dwordx4 v2, s[12:15], 0 offen lds
    ds_read_b64_tr_b16 v[80:81], v12
    ds_read_b64_tr_b16 v[82:83], v12 offset:1024
    ds_read_b64_tr_b16 v[70:71], v19 offset:49664
    v_mfma_f32_32x32x16_bf16 v[144:159], v[84:87], a[192:195], v[144:159]
    v_mfma_f32_32x32x16_bf16 v[208:223], v[84:87], a[196:199], v[208:223]
    buffer_load_dwordx4 v3, s[12:15], 0 offen offset:1024 lds
    ds_read_b64_tr_b16 v[84:85], v13
    ds_read_b64_tr_b16 v[86:87], v13 offset:1024
    v_mfma_f32_32x32x16_bf16 v[160:175], v[88:91], a[192:195], v[160:175]
    v_mfma_f32_32x32x16_bf16 v[224:239], v[88:91], a[196:199], v[224:239]
    buffer_load_dwordx4 v2, s[12:15], s79 offen offset:2048 lds
    ds_read_b64_tr_b16 v[88:89], v14
    s_waitcnt lgkmcnt(6)
    v_lshlrev_b32 v76, 16, v68
    ds_read_b64_tr_b16 v[90:91], v14 offset:1024
    v_add_f32 v43, v43, v76
    v_mfma_f32_32x32x16_bf16 v[176:191], v[92:95], a[192:195], v[176:191]
    v_and_b32 v77, 0xffff0000, v68
    v_add_f32 v43, v43, v77
    v_lshlrev_b32 v76, 16, v69
    v_add_f32 v43, v43, v76
    v_and_b32 v77, 0xffff0000, v69
    v_add_f32 v43, v43, v77
    v_mfma_f32_32x32x16_bf16 v[240:255], v[92:95], a[196:199], v[240:255]
    buffer_load_dwordx4 v3, s[12:15], s79 offen offset:3072 lds
    s_add_u32 m0, s74, 0x3000
    ds_read_b64_tr_b16 v[92:93], v15
    s_waitcnt lgkmcnt(5)
    v_lshlrev_b32 v76, 16, v70
    ds_read_b64_tr_b16 v[94:95], v15 offset:1024
    v_mfma_f32_32x32x16_bf16 a[128:143], v[96:99], a[192:195], a[128:143]
    v_add_f32 v43, v43, v76
    v_and_b32 v77, 0xffff0000, v70
    v_add_f32 v43, v43, v77
    v_lshlrev_b32 v76, 16, v71
    v_and_b32 v77, 0xffff0000, v71
    ds_read_b64_tr_b16 v[68:69], v19
    v_mfma_f32_32x32x16_bf16 a[144:159], v[96:99], a[196:199], a[144:159]
    buffer_load_dwordx4 v2, s[12:15], s80 offen lds
    ds_read_b64_tr_b16 v[96:97], v16
    v_add_f32 v43, v43, v76
    ds_read_b64_tr_b16 v[98:99], v16 offset:512
    v_add_f32 v43, v43, v77
    ds_read_b64_tr_b16 v[70:71], v19 offset:512
    v_mfma_f32_32x32x16_bf16 a[160:175], v[100:103], a[192:195], a[160:175]
    s_waitcnt vmcnt(16)
    ds_read_b128 a[192:195], v8
    v_mfma_f32_32x32x16_bf16 a[176:191], v[100:103], a[196:199], a[176:191]
    buffer_load_dwordx4 v3, s[12:15], s80 offen offset:1024 lds
    ds_read_b64_tr_b16 v[100:101], v17
    ds_read_b64_tr_b16 v[102:103], v17 offset:512
    v_mfma_f32_32x32x16_bf16 a[228:243], v[72:75], a[224:227], a[228:243]
    ds_read_b64_tr_b16 v[72:73], v18 offset:6144
    ds_read_b64_tr_b16 v[74:75], v18 offset:7168
    s_waitcnt vmcnt(13)
    ds_read_b128 a[196:199], v8 offset:4096
    v_mfma_f32_32x32x16_bf16 v[128:143], v[104:107], a[200:203], v[128:143]
    buffer_load_dwordx4 v2, s[12:15], s81 offen offset:2048 lds
    v_add_u32 v2, 0x80, v2
    s_waitcnt lgkmcnt(9)
    v_lshlrev_b32 v76, 16, v68
    v_add_f32 v43, v43, v76
    v_and_b32 v77, 0xffff0000, v68
    v_mfma_f32_32x32x16_bf16 v[192:207], v[104:107], a[204:207], v[192:207]
    ds_read_b64_tr_b16 v[104:105], v12 offset:6144
    v_add_f32 v43, v43, v77
    ds_read_b64_tr_b16 v[106:107], v12 offset:7168
    v_lshlrev_b32 v76, 16, v69
    v_add_f32 v43, v43, v76
    v_and_b32 v77, 0xffff0000, v69
    v_mfma_f32_32x32x16_bf16 v[144:159], v[108:111], a[200:203], v[144:159]
    buffer_load_dwordx4 v3, s[12:15], s81 offen offset:3072 lds
    s_add_u32 m0, s75, 0xc000
    v_add_u32 v3, 0x80, v3
    v_add_f32 v43, v43, v77
    s_waitcnt lgkmcnt(8)
    v_lshlrev_b32 v76, 16, v70
    v_mfma_f32_32x32x16_bf16 v[208:223], v[108:111], a[204:207], v[208:223]
    ds_read_b64_tr_b16 v[108:109], v13 offset:6144
    v_add_f32 v43, v43, v76
    ds_read_b64_tr_b16 v[110:111], v13 offset:7168
    v_and_b32 v77, 0xffff0000, v70
    v_add_f32 v43, v43, v77
    v_lshlrev_b32 v76, 16, v71
    v_mfma_f32_32x32x16_bf16 v[160:175], v[112:115], a[200:203], v[160:175]
    v_and_b32 v77, 0xffff0000, v71
    v_add_f32 v43, v43, v76
    v_add_f32 v43, v43, v77
    v_mfma_f32_32x32x16_bf16 v[224:239], v[112:115], a[204:207], v[224:239]
    ds_read_b64_tr_b16 v[112:113], v14 offset:6144
    ds_read_b64_tr_b16 v[114:115], v14 offset:7168
    v_mfma_f32_32x32x16_bf16 v[176:191], v[116:119], a[200:203], v[176:191]
    v_mfma_f32_32x32x16_bf16 v[240:255], v[116:119], a[204:207], v[240:255]
    ds_read_b64_tr_b16 v[116:117], v15 offset:6144
    ds_read_b64_tr_b16 v[118:119], v15 offset:7168
    v_mfma_f32_32x32x16_bf16 a[128:143], v[120:123], a[200:203], a[128:143]
    v_mfma_f32_32x32x16_bf16 a[144:159], v[120:123], a[204:207], a[144:159]
    ds_read_b64_tr_b16 v[120:121], v16 offset:6144
    ds_read_b64_tr_b16 v[122:123], v16 offset:6656
    v_mfma_f32_32x32x16_bf16 a[160:175], v[124:127], a[200:203], a[160:175]
    ds_read_b128 a[200:203], v9
    v_mfma_f32_32x32x16_bf16 a[176:191], v[124:127], a[204:207], a[176:191]
    ds_read_b64_tr_b16 v[124:125], v17 offset:6144
    ds_read_b64_tr_b16 v[126:127], v17 offset:6656
    ds_read_b128 a[204:207], v9 offset:4096
    v_mfma_f32_32x32x16_bf16 a[228:243], v[64:67], a[224:227], a[228:243]
    v_mfma_f32_32x32x16_bf16 v[128:143], v[80:83], a[208:211], v[128:143]
    v_mfma_f32_32x32x16_bf16 v[192:207], v[80:83], a[212:215], v[192:207]
    v_mfma_f32_32x32x16_bf16 v[144:159], v[84:87], a[208:211], v[144:159]
    v_mfma_f32_32x32x16_bf16 v[208:223], v[84:87], a[212:215], v[208:223]
    v_mfma_f32_32x32x16_bf16 v[160:175], v[88:91], a[208:211], v[160:175]
    v_mfma_f32_32x32x16_bf16 v[224:239], v[88:91], a[212:215], v[224:239]
    v_mfma_f32_32x32x16_bf16 v[176:191], v[92:95], a[208:211], v[176:191]
    v_mfma_f32_32x32x16_bf16 v[240:255], v[92:95], a[212:215], v[240:255]
    v_mfma_f32_32x32x16_bf16 a[128:143], v[96:99], a[208:211], a[128:143]
    v_mfma_f32_32x32x16_bf16 a[144:159], v[96:99], a[212:215], a[144:159]
    s_waitcnt lgkmcnt(0)
    v_mfma_f32_32x32x16_bf16 a[160:175], v[100:103], a[208:211], a[160:175]
    ds_read_b128 a[208:211], v10
    v_mfma_f32_32x32x16_bf16 a[176:191], v[100:103], a[212:215], a[176:191]
    s_waitcnt vmcnt(11)
    s_barrier
    buffer_store_dword v59, v58, s[4:7], s89 offen sc1
    v_mfma_f32_32x32x16_bf16 a[228:243], v[72:75], a[224:227], a[228:243]
    ds_read_b64_tr_b16 v[64:65], v18 offset:12288
    buffer_load_dwordx4 v4, s[16:19], s77 offen lds
    ds_read_b64_tr_b16 v[66:67], v18 offset:13312
    ds_read_b64_tr_b16 v[80:81], v12 offset:12288
    v_mfma_f32_32x32x16_bf16 v[128:143], v[104:107], a[216:219], v[128:143]
    ds_read_b64_tr_b16 v[82:83], v12 offset:13312
    ds_read_b64_tr_b16 v[84:85], v13 offset:12288
    ds_read_b64_tr_b16 v[86:87], v13 offset:13312
    v_mfma_f32_32x32x16_bf16 v[192:207], v[104:107], a[220:223], v[192:207]
    ds_read_b64_tr_b16 v[88:89], v14 offset:12288
    buffer_load_dwordx4 v5, s[16:19], s77 offen offset:1024 lds
    s_add_u32 s77, s77, 0x40000
    ds_read_b64_tr_b16 v[90:91], v14 offset:13312
    ds_read_b64_tr_b16 v[92:93], v15 offset:12288
    v_mfma_f32_32x32x16_bf16 v[144:159], v[108:111], a[216:219], v[144:159]
    ds_read_b64_tr_b16 v[94:95], v15 offset:13312
    ds_read_b64_tr_b16 v[96:97], v16 offset:12288
    ds_read_b64_tr_b16 v[98:99], v16 offset:12800
    v_mfma_f32_32x32x16_bf16 v[208:223], v[108:111], a[220:223], v[208:223]
    ds_read_b64_tr_b16 v[100:101], v17 offset:12288
    buffer_load_dwordx4 v6, s[20:23], s78 offen offset:2048 lds
    s_add_u32 s78, s78, 0x15800
    s_add_u32 m0, s75, 0
    ds_read_b64_tr_b16 v[102:103], v17 offset:12800
    v_mfma_f32_32x32x16_bf16 v[160:175], v[112:115], a[216:219], v[160:175]
    ds_read_b64_tr_b16 v[72:73], v18 offset:18432
    ds_read_b64_tr_b16 v[74:75], v18 offset:19456
    ds_read_b64_tr_b16 v[104:105], v12 offset:18432
    v_mfma_f32_32x32x16_bf16 v[224:239], v[112:115], a[220:223], v[224:239]
    ds_read_b64_tr_b16 v[106:107], v12 offset:19456
    buffer_load_dwordx4 v4, s[16:19], s77 offen lds
    ds_read_b64_tr_b16 v[108:109], v13 offset:18432
    ds_read_b64_tr_b16 v[110:111], v13 offset:19456
    v_mfma_f32_32x32x16_bf16 v[176:191], v[116:119], a[216:219], v[176:191]
    ds_read_b64_tr_b16 v[112:113], v14 offset:18432
    ds_read_b64_tr_b16 v[114:115], v14 offset:19456
    ds_read_b128 a[212:215], v10 offset:4096
    v_mfma_f32_32x32x16_bf16 v[240:255], v[116:119], a[220:223], v[240:255]
    ds_read_b64_tr_b16 v[116:117], v15 offset:18432
    buffer_load_dwordx4 v5, s[16:19], s77 offen offset:1024 lds
    s_add_u32 s77, s77, 0x40000
    ds_read_b64_tr_b16 v[118:119], v15 offset:19456
    ds_read_b64_tr_b16 v[68:69], v19 offset:12288
    v_mfma_f32_32x32x16_bf16 a[128:143], v[120:123], a[216:219], a[128:143]
    ds_read_b64_tr_b16 v[70:71], v19 offset:12800
    v_mfma_f32_32x32x16_bf16 a[144:159], v[120:123], a[220:223], a[144:159]
    ds_read_b64_tr_b16 v[120:121], v16 offset:18432
    buffer_load_dwordx4 v6, s[20:23], s78 offen offset:2048 lds
    s_add_u32 m0, s74, 0x4000
    s_add_u32 s78, s78, 0x15800
    ds_read_b64_tr_b16 v[122:123], v16 offset:18944
    v_mfma_f32_32x32x16_bf16 a[160:175], v[124:127], a[216:219], a[160:175]
    ds_read_b128 a[216:219], v11
    v_mfma_f32_32x32x16_bf16 a[176:191], v[124:127], a[220:223], a[176:191]
    ds_read_b64_tr_b16 v[124:125], v17 offset:18432
    buffer_load_dwordx4 v2, s[12:15], 0 offen lds
    ds_read_b64_tr_b16 v[126:127], v17 offset:18944
    ds_read_b128 a[220:223], v11 offset:4096
    s_waitcnt lgkmcnt(14)
    v_mfma_f32_32x32x16_bf16 a[228:243], v[64:67], a[224:227], a[228:243]
    ds_read_b64_tr_b16 v[64:65], v18 offset:24576
    s_waitcnt lgkmcnt(8)
    v_lshlrev_b32 v76, 16, v68
    ds_read_b64_tr_b16 v[66:67], v18 offset:25600
    v_add_f32 v43, v43, v76
    v_and_b32 v77, 0xffff0000, v68
    v_mfma_f32_32x32x16_bf16 v[128:143], v[80:83], a[192:195], v[128:143]
    v_add_f32 v43, v43, v77
    buffer_load_dwordx4 v3, s[12:15], 0 offen offset:1024 lds
    v_lshlrev_b32 v76, 16, v69
    v_add_f32 v43, v43, v76
    v_and_b32 v77, 0xffff0000, v69
    v_add_f32 v43, v43, v77
    v_mfma_f32_32x32x16_bf16 v[192:207], v[80:83], a[196:199], v[192:207]
    ds_read_b64_tr_b16 v[80:81], v12 offset:24576
    s_waitcnt lgkmcnt(9)
    v_lshlrev_b32 v76, 16, v70
    ds_read_b64_tr_b16 v[82:83], v12 offset:25600
    v_add_f32 v43, v43, v76
    v_and_b32 v77, 0xffff0000, v70
    v_mfma_f32_32x32x16_bf16 v[144:159], v[84:87], a[192:195], v[144:159]
    v_add_f32 v43, v43, v77
    buffer_load_dwordx4 v2, s[12:15], s79 offen offset:2048 lds
    v_lshlrev_b32 v76, 16, v71
    v_and_b32 v77, 0xffff0000, v71
    ds_read_b64_tr_b16 v[68:69], v19 offset:24576
    v_add_f32 v43, v43, v76
    v_mfma_f32_32x32x16_bf16 v[208:223], v[84:87], a[196:199], v[208:223]
    ds_read_b64_tr_b16 v[84:85], v13 offset:24576
    v_add_f32 v43, v43, v77
    ds_read_b64_tr_b16 v[86:87], v13 offset:25600
    ds_read_b64_tr_b16 v[70:71], v19 offset:25088
    v_mfma_f32_32x32x16_bf16 v[160:175], v[88:91], a[192:195], v[160:175]
    buffer_load_dwordx4 v3, s[12:15], s79 offen offset:3072 lds
    s_add_u32 m0, s74, 0x5000
    v_mfma_f32_32x32x16_bf16 v[224:239], v[88:91], a[196:199], v[224:239]
    ds_read_b64_tr_b16 v[88:89], v14 offset:24576
    ds_read_b64_tr_b16 v[90:91], v14 offset:25600
    v_mfma_f32_32x32x16_bf16 v[176:191], v[92:95], a[192:195], v[176:191]
    buffer_load_dwordx4 v2, s[12:15], s80 offen lds
    v_mfma_f32_32x32x16_bf16 v[240:255], v[92:95], a[196:199], v[240:255]
    ds_read_b64_tr_b16 v[92:93], v15 offset:24576
    s_waitcnt lgkmcnt(6)
    v_lshlrev_b32 v76, 16, v68
    ds_read_b64_tr_b16 v[94:95], v15 offset:25600
    v_add_f32 v43, v43, v76
    v_and_b32 v77, 0xffff0000, v68
    v_mfma_f32_32x32x16_bf16 a[128:143], v[96:99], a[192:195], a[128:143]
    v_add_f32 v43, v43, v77
    buffer_load_dwordx4 v3, s[12:15], s80 offen offset:1024 lds
    v_lshlrev_b32 v76, 16, v69
    v_add_f32 v43, v43, v76
    v_and_b32 v77, 0xffff0000, v69
    v_add_f32 v43, v43, v77
    v_mfma_f32_32x32x16_bf16 a[144:159], v[96:99], a[196:199], a[144:159]
    ds_read_b64_tr_b16 v[96:97], v16 offset:24576
    s_waitcnt lgkmcnt(5)
    v_lshlrev_b32 v76, 16, v70
    ds_read_b64_tr_b16 v[98:99], v16 offset:25088
    v_add_f32 v43, v43, v76
    v_and_b32 v77, 0xffff0000, v70
    v_mfma_f32_32x32x16_bf16 a[160:175], v[100:103], a[192:195], a[160:175]
    s_waitcnt vmcnt(17)
    ds_read_b128 a[192:195], v8 offset:8192
    buffer_load_dwordx4 v2, s[12:15], s81 offen offset:2048 lds
    v_add_u32 v2, 0x80, v2
    v_add_f32 v43, v43, v77
    v_lshlrev_b32 v76, 16, v71
    v_mfma_f32_32x32x16_bf16 a[176:191], v[100:103], a[196:199], a[176:191]
    ds_read_b64_tr_b16 v[100:101], v17 offset:24576
    v_and_b32 v77, 0xffff0000, v71
    ds_read_b64_tr_b16 v[102:103], v17 offset:25088
    v_add_f32 v43, v43, v76
    s_waitcnt vmcnt(14)
    ds_read_b128 a[196:199], v8 offset:12288
    v_mfma_f32_32x32x16_bf16 a[228:243], v[72:75], a[224:227], a[228:243]
    v_add_f32 v43, v43, v77
    ds_read_b64_tr_b16 v[72:73], v18 offset:30720
    buffer_load_dwordx4 v3, s[12:15], s81 offen offset:3072 lds
    s_add_u32 m0, s75, 0x3000
    v_add_u32 v3, 0x80, v3
    ds_read_b64_tr_b16 v[74:75], v18 offset:31744
    v_mfma_f32_32x32x16_bf16 v[128:143], v[104:107], a[200:203], v[128:143]
    v_mfma_f32_32x32x16_bf16 v[192:207], v[104:107], a[204:207], v[192:207]
    ds_read_b64_tr_b16 v[104:105], v12 offset:30720
    ds_read_b64_tr_b16 v[106:107], v12 offset:31744
    v_mfma_f32_32x32x16_bf16 v[144:159], v[108:111], a[200:203], v[144:159]
    v_mfma_f32_32x32x16_bf16 v[208:223], v[108:111], a[204:207], v[208:223]
    ds_read_b64_tr_b16 v[108:109], v13 offset:30720
    ds_read_b64_tr_b16 v[110:111], v13 offset:31744
    v_mfma_f32_32x32x16_bf16 v[160:175], v[112:115], a[200:203], v[160:175]
    v_mfma_f32_32x32x16_bf16 v[224:239], v[112:115], a[204:207], v[224:239]
    ds_read_b64_tr_b16 v[112:113], v14 offset:30720
    ds_read_b64_tr_b16 v[114:115], v14 offset:31744
    v_mfma_f32_32x32x16_bf16 v[176:191], v[116:119], a[200:203], v[176:191]
    v_mfma_f32_32x32x16_bf16 v[240:255], v[116:119], a[204:207], v[240:255]
    ds_read_b64_tr_b16 v[116:117], v15 offset:30720
    ds_read_b64_tr_b16 v[118:119], v15 offset:31744
    v_mfma_f32_32x32x16_bf16 a[128:143], v[120:123], a[200:203], a[128:143]
    v_mfma_f32_32x32x16_bf16 a[144:159], v[120:123], a[204:207], a[144:159]
    ds_read_b64_tr_b16 v[120:121], v16 offset:30720
    ds_read_b64_tr_b16 v[122:123], v16 offset:31232
    v_mfma_f32_32x32x16_bf16 a[160:175], v[124:127], a[200:203], a[160:175]
    ds_read_b128 a[200:203], v9 offset:8192
    v_mfma_f32_32x32x16_bf16 a[176:191], v[124:127], a[204:207], a[176:191]
    ds_read_b64_tr_b16 v[124:125], v17 offset:30720
    ds_read_b64_tr_b16 v[126:127], v17 offset:31232
    ds_read_b128 a[204:207], v9 offset:12288
    v_mfma_f32_32x32x16_bf16 a[228:243], v[64:67], a[224:227], a[228:243]
    v_mfma_f32_32x32x16_bf16 v[128:143], v[80:83], a[208:211], v[128:143]
    v_mfma_f32_32x32x16_bf16 v[192:207], v[80:83], a[212:215], v[192:207]
    v_mfma_f32_32x32x16_bf16 v[144:159], v[84:87], a[208:211], v[144:159]
    v_mfma_f32_32x32x16_bf16 v[208:223], v[84:87], a[212:215], v[208:223]
    s_waitcnt lgkmcnt(3)
    v_mfma_f32_32x32x16_bf16 v[160:175], v[88:91], a[208:211], v[160:175]
    v_mfma_f32_32x32x16_bf16 v[224:239], v[88:91], a[212:215], v[224:239]
    v_mfma_f32_32x32x16_bf16 v[176:191], v[92:95], a[208:211], v[176:191]
    v_mfma_f32_32x32x16_bf16 v[240:255], v[92:95], a[212:215], v[240:255]
    v_mfma_f32_32x32x16_bf16 a[128:143], v[96:99], a[208:211], a[128:143]
    v_mfma_f32_32x32x16_bf16 a[144:159], v[96:99], a[212:215], a[144:159]
    s_waitcnt vmcnt(11) lgkmcnt(0)
    s_barrier
    buffer_load_dwordx4 v4, s[16:19], s77 offen lds
    v_mfma_f32_32x32x16_bf16 a[160:175], v[100:103], a[208:211], a[160:175]
    ds_read_b64_tr_b16 v[64:65], v18 offset:36864
    ds_read_b64_tr_b16 v[66:67], v18 offset:37888
    ds_read_b64_tr_b16 v[80:81], v12 offset:36864
    v_mfma_f32_32x32x16_bf16 a[176:191], v[100:103], a[212:215], a[176:191]
    ds_read_b64_tr_b16 v[82:83], v12 offset:37888
    ds_read_b64_tr_b16 v[84:85], v13 offset:36864
    ds_read_b64_tr_b16 v[86:87], v13 offset:37888
    buffer_load_dwordx4 v5, s[16:19], s77 offen offset:1024 lds
    v_mfma_f32_32x32x16_bf16 a[228:243], v[72:75], a[224:227], a[228:243]
    s_add_u32 s77, s77, 0x40000
    ds_read_b64_tr_b16 v[88:89], v14 offset:36864
    ds_read_b64_tr_b16 v[90:91], v14 offset:37888
    ds_read_b64_tr_b16 v[92:93], v15 offset:36864
    v_mfma_f32_32x32x16_bf16 v[128:143], v[104:107], a[216:219], v[128:143]
    ds_read_b64_tr_b16 v[94:95], v15 offset:37888
    ds_read_b64_tr_b16 v[96:97], v16 offset:36864
    ds_read_b64_tr_b16 v[98:99], v16 offset:37376
    buffer_load_dwordx4 v6, s[20:23], s78 offen offset:2048 lds
    v_mfma_f32_32x32x16_bf16 v[192:207], v[104:107], a[220:223], v[192:207]
    s_add_u32 s78, s78, 0x15800
    s_add_u32 m0, s75, 0x6000
    ds_read_b64_tr_b16 v[100:101], v17 offset:36864
    ds_read_b64_tr_b16 v[102:103], v17 offset:37376
    v_mfma_f32_32x32x16_bf16 v[144:159], v[108:111], a[216:219], v[144:159]
    ds_read_b64_tr_b16 v[72:73], v18 offset:43008
    ds_read_b64_tr_b16 v[74:75], v18 offset:44032
    ds_read_b64_tr_b16 v[104:105], v12 offset:43008
    buffer_load_dwordx4 v4, s[16:19], s77 offen lds
    v_mfma_f32_32x32x16_bf16 v[208:223], v[108:111], a[220:223], v[208:223]
    ds_read_b64_tr_b16 v[106:107], v12 offset:44032
    ds_read_b64_tr_b16 v[108:109], v13 offset:43008
    ds_read_b64_tr_b16 v[110:111], v13 offset:44032
    v_mfma_f32_32x32x16_bf16 v[160:175], v[112:115], a[216:219], v[160:175]
    ds_read_b128 a[208:211], v10 offset:8192
    ds_read_b128 a[212:215], v10 offset:12288
    buffer_load_dwordx4 v5, s[16:19], s77 offen offset:1024 lds
    v_mfma_f32_32x32x16_bf16 v[224:239], v[112:115], a[220:223], v[224:239]
    s_add_u32 s77, s77, 0x40000
    ds_read_b64_tr_b16 v[112:113], v14 offset:43008
    ds_read_b64_tr_b16 v[114:115], v14 offset:44032
    ds_read_b64_tr_b16 v[68:69], v19 offset:36864
    v_mfma_f32_32x32x16_bf16 v[176:191], v[116:119], a[216:219], v[176:191]
    ds_read_b64_tr_b16 v[70:71], v19 offset:37376
    buffer_load_dwordx4 v6, s[20:23], s78 offen offset:2048 lds
    v_mfma_f32_32x32x16_bf16 v[240:255], v[116:119], a[220:223], v[240:255]
    s_add_u32 m0, s74, 0
    s_add_u32 s78, s78, 0x15800
    ds_read_b64_tr_b16 v[116:117], v15 offset:43008
    ds_read_b64_tr_b16 v[118:119], v15 offset:44032
    v_mfma_f32_32x32x16_bf16 a[128:143], v[120:123], a[216:219], a[128:143]
    buffer_load_dwordx4 v2, s[12:15], 0 offen lds
    v_mfma_f32_32x32x16_bf16 a[144:159], v[120:123], a[220:223], a[144:159]
    ds_read_b64_tr_b16 v[120:121], v16 offset:43008
    ds_read_b64_tr_b16 v[122:123], v16 offset:43520
    v_mfma_f32_32x32x16_bf16 a[160:175], v[124:127], a[216:219], a[160:175]
    ds_read_b128 a[216:219], v11 offset:8192
    s_waitcnt lgkmcnt(6)
    v_lshlrev_b32 v76, 16, v68
    v_add_f32 v43, v43, v76
    v_and_b32 v77, 0xffff0000, v68
    buffer_load_dwordx4 v3, s[12:15], 0 offen offset:1024 lds
    v_mfma_f32_32x32x16_bf16 a[176:191], v[124:127], a[220:223], a[176:191]
    ds_read_b64_tr_b16 v[124:125], v17 offset:43008
    v_add_f32 v43, v43, v77
    ds_read_b64_tr_b16 v[126:127], v17 offset:43520
    v_lshlrev_b32 v76, 16, v69
    ds_read_b128 a[220:223], v11 offset:12288
    v_add_f32 v43, v43, v76
    v_mfma_f32_32x32x16_bf16 a[228:243], v[64:67], a[224:227], a[228:243]
    ds_read_b64_tr_b16 v[64:65], v18 offset:49152
    v_and_b32 v77, 0xffff0000, v69
    ds_read_b64_tr_b16 v[66:67], v18 offset:50176
    v_add_f32 v43, v43, v77
    s_waitcnt lgkmcnt(10)
    v_lshlrev_b32 v76, 16, v70
    v_mfma_f32_32x32x16_bf16 v[128:143], v[80:83], a[192:195], v[128:143]
    buffer_load_dwordx4 v2, s[12:15], s79 offen offset:2048 lds
    v_add_f32 v43, v43, v76
    v_and_b32 v77, 0xffff0000, v70
    v_add_f32 v43, v43, v77
    v_lshlrev_b32 v76, 16, v71
    v_and_b32 v77, 0xffff0000, v71
    v_mfma_f32_32x32x16_bf16 v[192:207], v[80:83], a[196:199], v[192:207]
    ds_read_b64_tr_b16 v[80:81], v12 offset:49152
    v_add_f32 v43, v43, v76
    ds_read_b64_tr_b16 v[82:83], v12 offset:50176
    v_add_f32 v43, v43, v77
    ds_read_b64_tr_b16 v[68:69], v19 offset:49152
    v_mfma_f32_32x32x16_bf16 v[144:159], v[84:87], a[192:195], v[144:159]
    buffer_load_dwordx4 v3, s[12:15], s79 offen offset:3072 lds
    s_add_u32 m0, s74, 0x1000
    ds_read_b64_tr_b16 v[70:71], v19 offset:49664
    v_mfma_f32_32x32x16_bf16 v[208:223], v[84:87], a[196:199], v[208:223]
    ds_read_b64_tr_b16 v[84:85], v13 offset:49152
    ds_read_b64_tr_b16 v[86:87], v13 offset:50176
    v_mfma_f32_32x32x16_bf16 v[160:175], v[88:91], a[192:195], v[160:175]
    buffer_load_dwordx4 v2, s[12:15], s80 offen lds
    v_mfma_f32_32x32x16_bf16 v[224:239], v[88:91], a[196:199], v[224:239]
    ds_read_b64_tr_b16 v[88:89], v14 offset:49152
    ds_read_b64_tr_b16 v[90:91], v14 offset:50176
    v_mfma_f32_32x32x16_bf16 v[176:191], v[92:95], a[192:195], v[176:191]
    buffer_load_dwordx4 v3, s[12:15], s80 offen offset:1024 lds
    s_waitcnt lgkmcnt(5)
    v_lshlrev_b32 v76, 16, v68
    v_add_f32 v43, v43, v76
    v_and_b32 v77, 0xffff0000, v68
    v_add_f32 v43, v43, v77
    v_mfma_f32_32x32x16_bf16 v[240:255], v[92:95], a[196:199], v[240:255]
    ds_read_b64_tr_b16 v[92:93], v15 offset:49152
    v_lshlrev_b32 v76, 16, v69
    ds_read_b64_tr_b16 v[94:95], v15 offset:50176
    v_add_f32 v43, v43, v76
    v_and_b32 v77, 0xffff0000, v69
    v_add_f32 v43, v43, v77
    v_mfma_f32_32x32x16_bf16 a[128:143], v[96:99], a[192:195], a[128:143]
    buffer_load_dwordx4 v2, s[12:15], s81 offen offset:2048 lds
    v_add_u32 v2, 0x80, v2
    s_waitcnt lgkmcnt(6)
    v_lshlrev_b32 v76, 16, v70
    v_add_f32 v43, v43, v76
    v_and_b32 v77, 0xffff0000, v70
    v_mfma_f32_32x32x16_bf16 a[144:159], v[96:99], a[196:199], a[144:159]
    ds_read_b64_tr_b16 v[96:97], v16 offset:49152
    v_add_f32 v43, v43, v77
    ds_read_b64_tr_b16 v[98:99], v16 offset:49664
    v_lshlrev_b32 v76, 16, v71
    v_and_b32 v77, 0xffff0000, v71
    v_add_f32 v43, v43, v76
    v_mfma_f32_32x32x16_bf16 a[160:175], v[100:103], a[192:195], a[160:175]
    buffer_load_dwordx4 v3, s[12:15], s81 offen offset:3072 lds
    s_add_u32 m0, s75, 0x9000
    v_add_u32 v3, 0x80, v3
    s_waitcnt vmcnt(18)
    ds_read_b128 a[192:195], v8 offset:16384
    v_add_f32 v43, v43, v77
    v_mfma_f32_32x32x16_bf16 a[176:191], v[100:103], a[196:199], a[176:191]
    ds_read_b64_tr_b16 v[100:101], v17 offset:49152
    ds_read_b64_tr_b16 v[102:103], v17 offset:49664
    s_waitcnt vmcnt(14)
    ds_read_b128 a[196:199], v8 offset:20480
    v_mfma_f32_32x32x16_bf16 a[228:243], v[72:75], a[224:227], a[228:243]
    ds_read_b64_tr_b16 v[72:73], v18 offset:55296
    ds_read_b64_tr_b16 v[74:75], v18 offset:56320
    v_mfma_f32_32x32x16_bf16 v[128:143], v[104:107], a[200:203], v[128:143]
    v_mfma_f32_32x32x16_bf16 v[192:207], v[104:107], a[204:207], v[192:207]
    ds_read_b64_tr_b16 v[104:105], v12 offset:55296
    ds_read_b64_tr_b16 v[106:107], v12 offset:56320
    v_mfma_f32_32x32x16_bf16 v[144:159], v[108:111], a[200:203], v[144:159]
    v_mfma_f32_32x32x16_bf16 v[208:223], v[108:111], a[204:207], v[208:223]
    ds_read_b64_tr_b16 v[108:109], v13 offset:55296
    ds_read_b64_tr_b16 v[110:111], v13 offset:56320
    v_mfma_f32_32x32x16_bf16 v[160:175], v[112:115], a[200:203], v[160:175]
    v_mfma_f32_32x32x16_bf16 v[224:239], v[112:115], a[204:207], v[224:239]
    ds_read_b64_tr_b16 v[112:113], v14 offset:55296
    ds_read_b64_tr_b16 v[114:115], v14 offset:56320
    v_mfma_f32_32x32x16_bf16 v[176:191], v[116:119], a[200:203], v[176:191]
    v_mfma_f32_32x32x16_bf16 v[240:255], v[116:119], a[204:207], v[240:255]
    ds_read_b64_tr_b16 v[116:117], v15 offset:55296
    ds_read_b64_tr_b16 v[118:119], v15 offset:56320
    v_mfma_f32_32x32x16_bf16 a[128:143], v[120:123], a[200:203], a[128:143]
    v_mfma_f32_32x32x16_bf16 a[144:159], v[120:123], a[204:207], a[144:159]
    ds_read_b64_tr_b16 v[120:121], v16 offset:55296
    ds_read_b64_tr_b16 v[122:123], v16 offset:55808
    v_mfma_f32_32x32x16_bf16 a[160:175], v[124:127], a[200:203], a[160:175]
    ds_read_b128 a[200:203], v9 offset:16384
    v_mfma_f32_32x32x16_bf16 a[176:191], v[124:127], a[204:207], a[176:191]
    ds_read_b64_tr_b16 v[124:125], v17 offset:55296
    ds_read_b64_tr_b16 v[126:127], v17 offset:55808
    ds_read_b128 a[204:207], v9 offset:20480
    v_mfma_f32_32x32x16_bf16 a[228:243], v[64:67], a[224:227], a[228:243]
    v_mfma_f32_32x32x16_bf16 v[128:143], v[80:83], a[208:211], v[128:143]
    v_mfma_f32_32x32x16_bf16 v[192:207], v[80:83], a[212:215], v[192:207]
    s_waitcnt lgkmcnt(6)
    v_mfma_f32_32x32x16_bf16 v[144:159], v[84:87], a[208:211], v[144:159]
    v_mfma_f32_32x32x16_bf16 v[208:223], v[84:87], a[212:215], v[208:223]
    v_mfma_f32_32x32x16_bf16 v[160:175], v[88:91], a[208:211], v[160:175]
    v_mfma_f32_32x32x16_bf16 v[224:239], v[88:91], a[212:215], v[224:239]
    v_mfma_f32_32x32x16_bf16 v[176:191], v[92:95], a[208:211], v[176:191]
    v_mfma_f32_32x32x16_bf16 v[240:255], v[92:95], a[212:215], v[240:255]
    v_mfma_f32_32x32x16_bf16 a[128:143], v[96:99], a[208:211], a[128:143]
    v_mfma_f32_32x32x16_bf16 a[144:159], v[96:99], a[212:215], a[144:159]
    s_waitcnt vmcnt(11) lgkmcnt(0)
    s_barrier
    buffer_load_dword v1, v60, s[4:7], s90 offen sc1
    v_mfma_f32_32x32x16_bf16 a[160:175], v[100:103], a[208:211], a[160:175]
    ds_read_b64_tr_b16 v[64:65], v18
    buffer_load_dwordx4 v4, s[16:19], s77 offen lds
    ds_read_b64_tr_b16 v[66:67], v18 offset:1024
    ds_read_b64_tr_b16 v[80:81], v12
    v_mfma_f32_32x32x16_bf16 a[176:191], v[100:103], a[212:215], a[176:191]
    ds_read_b64_tr_b16 v[82:83], v12 offset:1024
    ds_read_b64_tr_b16 v[84:85], v13
    ds_read_b64_tr_b16 v[86:87], v13 offset:1024
    v_mfma_f32_32x32x16_bf16 a[228:243], v[72:75], a[224:227], a[228:243]
    ds_read_b64_tr_b16 v[88:89], v14
    buffer_load_dwordx4 v5, s[16:19], s77 offen offset:1024 lds
    s_add_u32 s77, s77, 0x40000
    ds_read_b64_tr_b16 v[90:91], v14 offset:1024
    ds_read_b64_tr_b16 v[92:93], v15
    v_mfma_f32_32x32x16_bf16 v[128:143], v[104:107], a[216:219], v[128:143]
    ds_read_b64_tr_b16 v[94:95], v15 offset:1024
    ds_read_b64_tr_b16 v[96:97], v16
    ds_read_b64_tr_b16 v[98:99], v16 offset:512
    v_mfma_f32_32x32x16_bf16 v[192:207], v[104:107], a[220:223], v[192:207]
    ds_read_b64_tr_b16 v[100:101], v17
    buffer_load_dwordx4 v6, s[20:23], s78 offen offset:2048 lds
    s_add_u32 s78, s78, 0x15800
    s_add_u32 m0, s75, 0xc000
    ds_read_b64_tr_b16 v[102:103], v17 offset:512
    v_mfma_f32_32x32x16_bf16 v[144:159], v[108:111], a[216:219], v[144:159]
    ds_read_b64_tr_b16 v[72:73], v18 offset:6144
    ds_read_b64_tr_b16 v[74:75], v18 offset:7168
    ds_read_b64_tr_b16 v[104:105], v12 offset:6144
    v_mfma_f32_32x32x16_bf16 v[208:223], v[108:111], a[220:223], v[208:223]
    ds_read_b64_tr_b16 v[106:107], v12 offset:7168
    buffer_load_dwordx4 v4, s[16:19], s77 offen lds
    ds_read_b64_tr_b16 v[108:109], v13 offset:6144
    ds_read_b64_tr_b16 v[110:111], v13 offset:7168
    v_mfma_f32_32x32x16_bf16 v[160:175], v[112:115], a[216:219], v[160:175]
    ds_read_b128 a[208:211], v10 offset:16384
    ds_read_b128 a[212:215], v10 offset:20480
    v_mfma_f32_32x32x16_bf16 v[224:239], v[112:115], a[220:223], v[224:239]
    ds_read_b64_tr_b16 v[112:113], v14 offset:6144
    buffer_load_dwordx4 v5, s[16:19], s77 offen offset:1024 lds
    s_add_u32 s77, s77, 0x40000
    ds_read_b64_tr_b16 v[114:115], v14 offset:7168
    ds_read_b64_tr_b16 v[68:69], v19
    v_mfma_f32_32x32x16_bf16 v[176:191], v[116:119], a[216:219], v[176:191]
    ds_read_b64_tr_b16 v[70:71], v19 offset:512
    v_mfma_f32_32x32x16_bf16 v[240:255], v[116:119], a[220:223], v[240:255]
    ds_read_b64_tr_b16 v[116:117], v15 offset:6144
    buffer_load_dwordx4 v6, s[20:23], s78 offen offset:2048 lds
    s_add_u32 m0, s74, 0x2000
    s_add_u32 s78, s78, 0x15800
    ds_read_b64_tr_b16 v[118:119], v15 offset:7168
    v_mfma_f32_32x32x16_bf16 a[128:143], v[120:123], a[216:219], a[128:143]
    v_mfma_f32_32x32x16_bf16 a[144:159], v[120:123], a[220:223], a[144:159]
    ds_read_b64_tr_b16 v[120:121], v16 offset:6144
    buffer_load_dwordx4 v2, s[12:15], 0 offen lds
    ds_read_b64_tr_b16 v[122:123], v16 offset:6656
    v_mfma_f32_32x32x16_bf16 a[160:175], v[124:127], a[216:219], a[160:175]
    ds_read_b128 a[216:219], v11 offset:16384
    s_waitcnt lgkmcnt(6)
    v_lshlrev_b32 v76, 16, v68
    v_add_f32 v43, v43, v76
    v_and_b32 v77, 0xffff0000, v68
    v_add_f32 v43, v43, v77
    v_mfma_f32_32x32x16_bf16 a[176:191], v[124:127], a[220:223], a[176:191]
    ds_read_b64_tr_b16 v[124:125], v17 offset:6144
    buffer_load_dwordx4 v3, s[12:15], 0 offen offset:1024 lds
    ds_read_b64_tr_b16 v[126:127], v17 offset:6656
    v_lshlrev_b32 v76, 16, v69
    ds_read_b128 a[220:223], v11 offset:20480
    v_add_f32 v43, v43, v76
    v_mfma_f32_32x32x16_bf16 a[228:243], v[64:67], a[224:227], a[228:243]
    ds_read_b64_tr_b16 v[64:65], v18 offset:12288
    v_and_b32 v77, 0xffff0000, v69
    ds_read_b64_tr_b16 v[66:67], v18 offset:13312
    v_add_f32 v43, v43, v77
    s_waitcnt lgkmcnt(10)
    v_lshlrev_b32 v76, 16, v70
    v_mfma_f32_32x32x16_bf16 v[128:143], v[80:83], a[192:195], v[128:143]
    v_add_f32 v43, v43, v76
    buffer_load_dwordx4 v2, s[12:15], s79 offen offset:2048 lds
    v_and_b32 v77, 0xffff0000, v70
    v_add_f32 v43, v43, v77
    v_lshlrev_b32 v76, 16, v71
    v_and_b32 v77, 0xffff0000, v71
    v_mfma_f32_32x32x16_bf16 v[192:207], v[80:83], a[196:199], v[192:207]
    ds_read_b64_tr_b16 v[80:81], v12 offset:12288
    v_add_f32 v43, v43, v76
    ds_read_b64_tr_b16 v[82:83], v12 offset:13312
    v_add_f32 v43, v43, v77
    ds_read_b64_tr_b16 v[68:69], v19 offset:12288
    v_mfma_f32_32x32x16_bf16 v[144:159], v[84:87], a[192:195], v[144:159]
    ds_read_b64_tr_b16 v[70:71], v19 offset:12800
    buffer_load_dwordx4 v3, s[12:15], s79 offen offset:3072 lds
    s_add_u32 m0, s74, 0x3000
    s_cmp_lt_u32 s59, 22
    s_cselect_b32 s74, s3, 0x10000000
    s_mul_i32 s59, s47, 3
    v_mfma_f32_32x32x16_bf16 v[208:223], v[84:87], a[196:199], v[208:223]
    s_add_u32 s59, s59, 1
    s_lshl_b32 s3, s59, 7
    s_add_u32 s3, s3, s58
    s_lshl_b32 s3, s3, 10
    s_add_u32 s3, s3, 0x700000
    s_lshl_b32 s58, s62, 5
    v_mfma_f32_32x32x16_bf16 v[160:175], v[88:91], a[192:195], v[160:175]
    ds_read_b64_tr_b16 v[84:85], v13 offset:12288
    buffer_load_dwordx4 v2, s[12:15], s80 offen lds
    ds_read_b64_tr_b16 v[86:87], v13 offset:13312
    s_cmp_eq_u32 s84, 21
    s_cselect_b32 s79, 0, 1.0
    v_mfma_f32_32x32x16_bf16 v[224:239], v[88:91], a[196:199], v[224:239]
    ds_read_b64_tr_b16 v[88:89], v14 offset:12288
    ds_read_b64_tr_b16 v[90:91], v14 offset:13312
    v_mfma_f32_32x32x16_bf16 v[176:191], v[92:95], a[192:195], v[176:191]
    s_waitcnt lgkmcnt(5)
    v_lshlrev_b32 v76, 16, v68
    buffer_load_dwordx4 v3, s[12:15], s80 offen offset:1024 lds
    s_lshl_b32 s80, s66, 8
    s_add_u32 s80, s80, s67
    s_lshr_b32 s67, s80, 5
    v_mfma_f32_32x32x16_bf16 v[240:255], v[92:95], a[196:199], v[240:255]
    s_mul_i32 s67, s67, 0xb000
    ds_read_b64_tr_b16 v[92:93], v15 offset:12288
    v_add_f32 v43, v43, v76
    ds_read_b64_tr_b16 v[94:95], v15 offset:13312
    v_and_b32 v77, 0xffff0000, v68
    v_add_f32 v43, v43, v77
    v_mfma_f32_32x32x16_bf16 a[128:143], v[96:99], a[192:195], a[128:143]
    v_lshlrev_b32 v76, 16, v69
    v_add_f32 v43, v43, v76
    buffer_load_dwordx4 v2, s[12:15], s81 offen offset:2048 lds
    v_and_b32 v77, 0xffff0000, v69
    v_add_f32 v43, v43, v77
    s_lshr_b32 s71, s80, 4
    v_mfma_f32_32x32x16_bf16 a[144:159], v[96:99], a[196:199], a[144:159]
    ds_read_b64_tr_b16 v[96:97], v16 offset:12288
    s_waitcnt lgkmcnt(7)
    v_lshlrev_b32 v76, 16, v70
    ds_read_b64_tr_b16 v[98:99], v16 offset:12800
    v_add_f32 v43, v43, v76
    v_and_b32 v77, 0xffff0000, v70
    v_mfma_f32_32x32x16_bf16 a[160:175], v[100:103], a[192:195], a[160:175]
    s_waitcnt vmcnt(18)
    ds_read_b128 a[192:195], v8
    buffer_load_dwordx4 v3, s[12:15], s81 offen offset:3072 lds
    s_add_u32 m0, s75, 0
    s_lshl_b32 s81, s66, 7
    s_add_u32 s81, s81, s83
    v_mfma_f32_32x32x16_bf16 a[176:191], v[100:103], a[196:199], a[176:191]
    s_add_u32 s81, s81, 0x80800
    s_add_u32 s12, s50, s0
    s_addc_u32 s13, s51, 0
    s_and_b32 s13, s13, 0xffff
    s_mov_b32 s14, 0x40000
    s_mov_b32 s15, 0x20000
    v_mfma_f32_32x32x16_bf16 a[228:243], v[72:75], a[224:227], a[228:243]
    s_cmp_lt_u32 s59, 22
    s_cselect_b32 s75, s3, 0x10000000
    s_mul_i32 s59, s47, 3
    s_add_u32 s59, s59, 2
    s_lshl_b32 s3, s59, 7
    s_add_u32 s3, s3, s58
    v_mfma_f32_32x32x16_bf16 v[128:143], v[104:107], a[200:203], v[128:143]
    s_lshl_b32 s3, s3, 10
    s_add_u32 s3, s3, 0x700000
    s_lshr_b32 s0, s60, 2
    s_and_b32 s58, s60, 1
    ds_read_b64_tr_b16 v[100:101], v17 offset:12288
    v_add_f32 v43, v43, v77
    v_mfma_f32_32x32x16_bf16 v[192:207], v[104:107], a[204:207], v[192:207]
    ds_read_b64_tr_b16 v[102:103], v17 offset:12800
    v_lshlrev_b32 v76, 16, v71
    ds_read_b64_tr_b16 v[72:73], v18 offset:18432
    v_and_b32 v77, 0xffff0000, v71
    ds_read_b64_tr_b16 v[74:75], v18 offset:19456
    v_add_f32 v43, v43, v76
    v_mfma_f32_32x32x16_bf16 v[144:159], v[108:111], a[200:203], v[144:159]
    ds_read_b64_tr_b16 v[104:105], v12 offset:18432
    v_add_f32 v43, v43, v77
    ds_read_b64_tr_b16 v[106:107], v12 offset:19456
    s_add_u32 s70, s70, s71
    s_waitcnt vmcnt(15)
    ds_read_b128 a[196:199], v8 offset:4096
    v_mfma_f32_32x32x16_bf16 v[208:223], v[108:111], a[204:207], v[208:223]
    s_lshl_b32 s70, s70, 10
    ds_read_b64_tr_b16 v[108:109], v13 offset:18432
    s_add_u32 s70, s70, 0x700000
    ds_read_b64_tr_b16 v[110:111], v13 offset:19456
    s_cmp_lt_u32 s84, 22
    s_cselect_b32 s70, s70, 0x10000000
    v_mfma_f32_32x32x16_bf16 v[160:175], v[112:115], a[200:203], v[160:175]
    s_lshl_b32 s71, s62, 14
    v_mfma_f32_32x32x16_bf16 v[224:239], v[112:115], a[204:207], v[224:239]
    ds_read_b64_tr_b16 v[112:113], v14 offset:18432
    ds_read_b64_tr_b16 v[114:115], v14 offset:19456
    v_mfma_f32_32x32x16_bf16 v[176:191], v[116:119], a[200:203], v[176:191]
    v_mfma_f32_32x32x16_bf16 v[240:255], v[116:119], a[204:207], v[240:255]
    ds_read_b64_tr_b16 v[116:117], v15 offset:18432
    ds_read_b64_tr_b16 v[118:119], v15 offset:19456
    v_mfma_f32_32x32x16_bf16 a[128:143], v[120:123], a[200:203], a[128:143]
    v_mfma_f32_32x32x16_bf16 a[144:159], v[120:123], a[204:207], a[144:159]
    ds_read_b64_tr_b16 v[120:121], v16 offset:18432
    ds_read_b64_tr_b16 v[122:123], v16 offset:18944
    v_mfma_f32_32x32x16_bf16 a[160:175], v[124:127], a[200:203], a[160:175]
    ds_read_b128 a[200:203], v9
    v_mfma_f32_32x32x16_bf16 a[176:191], v[124:127], a[204:207], a[176:191]
    ds_read_b64_tr_b16 v[124:125], v17 offset:18432
    ds_read_b64_tr_b16 v[126:127], v17 offset:18944
    ds_read_b128 a[204:207], v9 offset:4096
    v_mfma_f32_32x32x16_bf16 a[228:243], v[64:67], a[224:227], a[228:243]
    v_mfma_f32_32x32x16_bf16 v[128:143], v[80:83], a[208:211], v[128:143]
    v_mfma_f32_32x32x16_bf16 v[192:207], v[80:83], a[212:215], v[192:207]
    s_waitcnt lgkmcnt(6)
    v_mfma_f32_32x32x16_bf16 v[144:159], v[84:87], a[208:211], v[144:159]
    v_mfma_f32_32x32x16_bf16 v[208:223], v[84:87], a[212:215], v[208:223]
    v_mfma_f32_32x32x16_bf16 v[160:175], v[88:91], a[208:211], v[160:175]
    s_waitcnt vmcnt(14)
    v_cmp_ne_u32 vcc, v59, v1
    v_mfma_f32_32x32x16_bf16 v[224:239], v[88:91], a[212:215], v[224:239]
    s_cbranch_vccnz L_slow_xst
L_ret_xst:
    v_cmp_eq_u32 vcc, 0, v41
    s_add_u32 s90, s70, 0x800
    v_mfma_f32_32x32x16_bf16 v[176:191], v[92:95], a[208:211], v[176:191]
    v_mfma_f32_32x32x16_bf16 v[240:255], v[92:95], a[212:215], v[240:255]
    v_mfma_f32_32x32x16_bf16 a[128:143], v[96:99], a[208:211], a[128:143]
    v_mfma_f32_32x32x16_bf16 a[144:159], v[96:99], a[212:215], a[144:159]
    s_waitcnt vmcnt(11) lgkmcnt(0)
    s_barrier
    buffer_load_dwordx4 v4, s[16:19], s77 offen lds
    v_mfma_f32_32x32x16_bf16 a[160:175], v[100:103], a[208:211], a[160:175]
    ds_read_b64_tr_b16 v[64:65], v18 offset:24576
    ds_read_b64_tr_b16 v[66:67], v18 offset:25600
    ds_read_b64_tr_b16 v[80:81], v12 offset:24576
    v_mfma_f32_32x32x16_bf16 a[176:191], v[100:103], a[212:215], a[176:191]
    ds_read_b64_tr_b16 v[82:83], v12 offset:25600
    ds_read_b64_tr_b16 v[84:85], v13 offset:24576
    ds_read_b64_tr_b16 v[86:87], v13 offset:25600
    buffer_load_dwordx4 v5, s[16:19], s77 offen offset:1024 lds
    v_mfma_f32_32x32x16_bf16 a[228:243], v[72:75], a[224:227], a[228:243]
    s_mov_b32 s16, s52
    s_and_b32 s17, s53, 0xffff
    s_mov_b32 s18, 0x1000
    s_mov_b32 s19, 0x20000
    ds_read_b64_tr_b16 v[88:89], v14 offset:24576
    v_mfma_f32_32x32x16_bf16 v[128:143], v[104:107], a[216:219], v[128:143]
    ds_read_b64_tr_b16 v[90:91], v14 offset:25600
    ds_read_b64_tr_b16 v[92:93], v15 offset:24576
    ds_read_b64_tr_b16 v[94:95], v15 offset:25600
    buffer_load_dwordx4 v6, s[20:23], s78 offen offset:2048 lds
    v_mfma_f32_32x32x16_bf16 v[192:207], v[104:107], a[220:223], v[192:207]
    s_add_u32 m0, s76, 0x4000
    s_mov_b32 s22, 0x10000
    s_mov_b32 s23, 0x20000
    ds_read_b64_tr_b16 v[96:97], v16 offset:24576
    ds_read_b64_tr_b16 v[98:99], v16 offset:25088
    v_mfma_f32_32x32x16_bf16 v[144:159], v[108:111], a[216:219], v[144:159]
    ds_read_b64_tr_b16 v[100:101], v17 offset:24576
    ds_read_b64_tr_b16 v[102:103], v17 offset:25088
    ds_read_b64_tr_b16 v[72:73], v18 offset:30720
    buffer_load_dwordx4 v20, s[24:27], s86 offen lds
    v_mfma_f32_32x32x16_bf16 v[208:223], v[108:111], a[220:223], v[208:223]
    ds_read_b64_tr_b16 v[74:75], v18 offset:31744
    ds_read_b64_tr_b16 v[104:105], v12 offset:30720
    ds_read_b64_tr_b16 v[106:107], v12 offset:31744
    v_mfma_f32_32x32x16_bf16 v[160:175], v[112:115], a[216:219], v[160:175]
    ds_read_b64_tr_b16 v[108:109], v13 offset:30720
    ds_read_b64_tr_b16 v[110:111], v13 offset:31744
    ds_read_b128 a[208:211], v10
    buffer_load_dwordx4 v21, s[24:27], s86 offen offset:1024 lds
    v_mfma_f32_32x32x16_bf16 v[224:239], v[112:115], a[220:223], v[224:239]
    s_add_u32 m0, s76, 0xa000
    s_mov_b32 s86, 0x2000
    ds_read_b64_tr_b16 v[112:113], v14 offset:30720
    ds_read_b64_tr_b16 v[114:115], v14 offset:31744
    v_mfma_f32_32x32x16_bf16 v[176:191], v[116:119], a[216:219], v[176:191]
    ds_read_b128 a[212:215], v10 offset:4096
    ds_read_b64_tr_b16 v[68:69], v19 offset:24576
    buffer_load_dwordx4 v20, s[24:27], s86 offen lds
    v_mfma_f32_32x32x16_bf16 v[240:255], v[116:119], a[220:223], v[240:255]
    ds_read_b64_tr_b16 v[116:117], v15 offset:30720
    ds_read_b64_tr_b16 v[118:119], v15 offset:31744
    ds_read_b64_tr_b16 v[70:71], v19 offset:25088
    v_mfma_f32_32x32x16_bf16 a[128:143], v[120:123], a[216:219], a[128:143]
    buffer_load_dwordx4 v21, s[24:27], s86 offen offset:1024 lds
    v_mfma_f32_32x32x16_bf16 a[144:159], v[120:123], a[220:223], a[144:159]
    s_add_u32 m0, s76, 0x10000
    s_mov_b32 s86, 0x4000
    ds_read_b64_tr_b16 v[120:121], v16 offset:30720
    ds_read_b64_tr_b16 v[122:123], v16 offset:31232
    v_mfma_f32_32x32x16_bf16 a[160:175], v[124:127], a[216:219], a[160:175]
    ds_read_b128 a[216:219], v11
    buffer_load_dwordx4 v22, s[28:31], s87 offen lds
    v_mfma_f32_32x32x16_bf16 a[176:191], v[124:127], a[220:223], a[176:191]
    ds_read_b64_tr_b16 v[124:125], v17 offset:30720
    s_waitcnt lgkmcnt(7)
    v_lshlrev_b32 v76, 16, v68
    ds_read_b64_tr_b16 v[126:127], v17 offset:31232
    v_add_f32 v43, v43, v76
    v_and_b32 v77, 0xffff0000, v68
    v_mfma_f32_32x32x16_bf16 a[228:243], v[64:67], a[224:227], a[228:243]
    ds_read_b64_tr_b16 v[64:65], v18 offset:36864
    v_add_f32 v43, v43, v77
    ds_read_b64_tr_b16 v[66:67], v18 offset:37888
    v_lshlrev_b32 v76, 16, v69
    v_add_f32 v43, v43, v76
    buffer_load_dwordx4 v22, s[28:31], s87 offen offset:1024 lds
    v_mfma_f32_32x32x16_bf16 v[128:143], v[80:83], a[192:195], v[128:143]
    s_add_u32 m0, s76, 0x16000
    s_mov_b32 s87, 0x2000
    v_and_b32 v77, 0xffff0000, v69
    v_add_f32 v43, v43, v77
    s_waitcnt lgkmcnt(7)
    v_lshlrev_b32 v76, 16, v70
    v_mfma_f32_32x32x16_bf16 v[192:207], v[80:83], a[196:199], v[192:207]
    ds_read_b64_tr_b16 v[80:81], v12 offset:36864
    v_add_f32 v43, v43, v76
    ds_read_b64_tr_b16 v[82:83], v12 offset:37888
    v_and_b32 v77, 0xffff0000, v70
    v_add_f32 v43, v43, v77
    buffer_load_dwordx4 v22, s[28:31], s87 offen lds
    v_mfma_f32_32x32x16_bf16 v[144:159], v[84:87], a[192:195], v[144:159]
    v_lshlrev_b32 v76, 16, v71
    v_and_b32 v77, 0xffff0000, v71
    ds_read_b64_tr_b16 v[68:69], v19 offset:36864
    v_add_f32 v43, v43, v76
    ds_read_b64_tr_b16 v[70:71], v19 offset:37376
    v_add_f32 v43, v43, v77
    v_mfma_f32_32x32x16_bf16 v[208:223], v[84:87], a[196:199], v[208:223]
    ds_read_b64_tr_b16 v[84:85], v13 offset:36864
    ds_read_b64_tr_b16 v[86:87], v13 offset:37888
    ds_read_b128 a[220:223], v11 offset:4096
    buffer_load_dwordx4 v22, s[28:31], s87 offen offset:1024 lds
    v_mfma_f32_32x32x16_bf16 v[160:175], v[88:91], a[192:195], v[160:175]
    s_add_u32 m0, s76, 0x1c000
    s_mov_b32 s87, 0x4000
    v_mfma_f32_32x32x16_bf16 v[224:239], v[88:91], a[196:199], v[224:239]
    ds_read_b64_tr_b16 v[88:89], v14 offset:36864
    ds_read_b64_tr_b16 v[90:91], v14 offset:37888
    buffer_load_dwordx4 v22, s[28:31], s87 offen lds
    v_mfma_f32_32x32x16_bf16 v[176:191], v[92:95], a[192:195], v[176:191]
    v_mfma_f32_32x32x16_bf16 v[240:255], v[92:95], a[196:199], v[240:255]
    ds_read_b64_tr_b16 v[92:93], v15 offset:36864
    s_waitcnt lgkmcnt(7)
    v_lshlrev_b32 v76, 16, v68
    ds_read_b64_tr_b16 v[94:95], v15 offset:37888
    v_add_f32 v43, v43, v76
    buffer_load_dwordx4 v22, s[28:31], s87 offen offset:1024 lds
    v_mfma_f32_32x32x16_bf16 a[128:143], v[96:99], a[192:195], a[128:143]
    s_add_u32 m0, s76, 0
    s_mov_b32 s87, 0x6000
    v_and_b32 v77, 0xffff0000, v68
    v_add_f32 v43, v43, v77
    v_lshlrev_b32 v76, 16, v69
    v_add_f32 v43, v43, v76
    v_mfma_f32_32x32x16_bf16 a[144:159], v[96:99], a[196:199], a[144:159]
    ds_read_b64_tr_b16 v[96:97], v16 offset:36864
    v_and_b32 v77, 0xffff0000, v69
    ds_read_b64_tr_b16 v[98:99], v16 offset:37376
    v_add_f32 v43, v43, v77
    s_waitcnt lgkmcnt(7)
    v_lshlrev_b32 v76, 16, v70
    v_mfma_f32_32x32x16_bf16 a[160:175], v[100:103], a[192:195], a[160:175]
    s_waitcnt vmcnt(17)
    ds_read_b128 a[192:195], v8 offset:8192
    v_add_f32 v43, v43, v76
    v_and_b32 v77, 0xffff0000, v70
    v_add_f32 v43, v43, v77
    v_lshlrev_b32 v76, 16, v71
    v_mfma_f32_32x32x16_bf16 a[176:191], v[100:103], a[196:199], a[176:191]
    ds_read_b64_tr_b16 v[100:101], v17 offset:36864
    v_and_b32 v77, 0xffff0000, v71
    ds_read_b64_tr_b16 v[102:103], v17 offset:37376
    v_add_f32 v43, v43, v76
    s_waitcnt vmcnt(13)
    ds_read_b128 a[196:199], v8 offset:12288
    v_mfma_f32_32x32x16_bf16 a[228:243], v[72:75], a[224:227], a[228:243]
    v_add_f32 v43, v43, v77
    ds_read_b64_tr_b16 v[72:73], v18 offset:43008
    ds_read_b64_tr_b16 v[74:75], v18 offset:44032
    v_mfma_f32_32x32x16_bf16 v[128:143], v[104:107], a[200:203], v[128:143]
    v_mfma_f32_32x32x16_bf16 v[192:207], v[104:107], a[204:207], v[192:207]
    ds_read_b64_tr_b16 v[104:105], v12 offset:43008
    ds_read_b64_tr_b16 v[106:107], v12 offset:44032
    v_mfma_f32_32x32x16_bf16 v[144:159], v[108:111], a[200:203], v[144:159]
    v_mfma_f32_32x32x16_bf16 v[208:223], v[108:111], a[204:207], v[208:223]
    ds_read_b64_tr_b16 v[108:109], v13 offset:43008
    ds_read_b64_tr_b16 v[110:111], v13 offset:44032
    v_mfma_f32_32x32x16_bf16 v[160:175], v[112:115], a[200:203], v[160:175]
    v_mfma_f32_32x32x16_bf16 v[224:239], v[112:115], a[204:207], v[224:239]
    ds_read_b64_tr_b16 v[112:113], v14 offset:43008
    ds_read_b64_tr_b16 v[114:115], v14 offset:44032
    v_mfma_f32_32x32x16_bf16 v[176:191], v[116:119], a[200:203], v[176:191]
    v_mfma_f32_32x32x16_bf16 v[240:255], v[116:119], a[204:207], v[240:255]
    ds_read_b64_tr_b16 v[116:117], v15 offset:43008
    ds_read_b64_tr_b16 v[118:119], v15 offset:44032
    v_mfma_f32_32x32x16_bf16 a[128:143], v[120:123], a[200:203], a[128:143]
    v_mfma_f32_32x32x16_bf16 a[144:159], v[120:123], a[204:207], a[144:159]
    ds_read_b64_tr_b16 v[120:121], v16 offset:43008
    ds_read_b64_tr_b16 v[122:123], v16 offset:43520
    v_mfma_f32_32x32x16_bf16 a[160:175], v[124:127], a[200:203], a[160:175]
    ds_read_b128 a[200:203], v9 offset:8192
    v_mfma_f32_32x32x16_bf16 a[176:191], v[124:127], a[204:207], a[176:191]
    ds_read_b64_tr_b16 v[124:125], v17 offset:43008
    ds_read_b64_tr_b16 v[126:127], v17 offset:43520
    ds_read_b128 a[204:207], v9 offset:12288
    v_mfma_f32_32x32x16_bf16 a[228:243], v[64:67], a[224:227], a[228:243]
    v_mfma_f32_32x32x16_bf16 v[128:143], v[80:83], a[208:211], v[128:143]
    v_mfma_f32_32x32x16_bf16 v[192:207], v[80:83], a[212:215], v[192:207]
    v_mfma_f32_32x32x16_bf16 v[144:159], v[84:87], a[208:211], v[144:159]
    v_mfma_f32_32x32x16_bf16 v[208:223], v[84:87], a[212:215], v[208:223]
    s_waitcnt lgkmcnt(3)
    v_mfma_f32_32x32x16_bf16 v[160:175], v[88:91], a[208:211], v[160:175]
    v_mfma_f32_32x32x16_bf16 v[224:239], v[88:91], a[212:215], v[224:239]
    v_mfma_f32_32x32x16_bf16 v[176:191], v[92:95], a[208:211], v[176:191]
    s_waitcnt vmcnt(10) lgkmcnt(0)
    s_barrier
    buffer_load_dwordx2 v[36:37], v23, s[4:7], s91 offen sc1
    v_mfma_f32_32x32x16_bf16 v[240:255], v[92:95], a[212:215], v[240:255]
    ds_read_b64_tr_b16 v[64:65], v18 offset:49152
    ds_read_b64_tr_b16 v[66:67], v18 offset:50176
    ds_read_b64_tr_b16 v[80:81], v12 offset:49152
    buffer_load_dwordx2 v[38:39], v23, s[4:7], s91 offen offset:256 sc1
    v_mfma_f32_32x32x16_bf16 a[128:143], v[96:99], a[208:211], a[128:143]
    ds_read_b64_tr_b16 v[82:83], v12 offset:50176
    s_add_u32 s91, s70, 0xc00
    ds_read_b64_tr_b16 v[84:85], v13 offset:49152
    ds_read_b64_tr_b16 v[86:87], v13 offset:50176
    buffer_load_dwordx4 v20, s[24:27], s86 offen lds
    v_mfma_f32_32x32x16_bf16 a[144:159], v[96:99], a[212:215], a[144:159]
    ds_read_b64_tr_b16 v[88:89], v14 offset:49152
    ds_read_b64_tr_b16 v[90:91], v14 offset:50176
    ds_read_b64_tr_b16 v[92:93], v15 offset:49152
    v_mfma_f32_32x32x16_bf16 a[160:175], v[100:103], a[208:211], a[160:175]
    ds_read_b64_tr_b16 v[94:95], v15 offset:50176
    ds_read_b64_tr_b16 v[96:97], v16 offset:49152
    ds_read_b64_tr_b16 v[98:99], v16 offset:49664
    buffer_load_dwordx4 v21, s[24:27], s86 offen offset:1024 lds
    v_mfma_f32_32x32x16_bf16 a[176:191], v[100:103], a[212:215], a[176:191]
    s_add_u32 m0, s76, 0x6000
    s_mov_b32 s86, 0x6000
    ds_read_b64_tr_b16 v[100:101], v17 offset:49152
    ds_read_b64_tr_b16 v[102:103], v17 offset:49664
    v_mfma_f32_32x32x16_bf16 a[228:243], v[72:75], a[224:227], a[228:243]
    ds_read_b64_tr_b16 v[72:73], v18 offset:55296
    ds_read_b64_tr_b16 v[74:75], v18 offset:56320
    ds_read_b128 a[208:211], v10 offset:8192
    buffer_load_dwordx4 v20, s[24:27], s86 offen lds
    v_mfma_f32_32x32x16_bf16 v[128:143], v[104:107], a[216:219], v[128:143]
    ds_read_b128 a[212:215], v10 offset:12288
    ds_read_b64_tr_b16 v[68:69], v19 offset:49152
    v_mfma_f32_32x32x16_bf16 v[192:207], v[104:107], a[220:223], v[192:207]
    ds_read_b64_tr_b16 v[104:105], v12 offset:55296
    ds_read_b64_tr_b16 v[106:107], v12 offset:56320
    ds_read_b64_tr_b16 v[70:71], v19 offset:49664
    buffer_load_dwordx4 v21, s[24:27], s86 offen offset:1024 lds
    v_mfma_f32_32x32x16_bf16 v[144:159], v[108:111], a[216:219], v[144:159]
    s_add_u32 m0, s76, 0xc000
    s_mov_b32 s86, 0x8000
    v_mfma_f32_32x32x16_bf16 v[208:223], v[108:111], a[220:223], v[208:223]
    ds_read_b64_tr_b16 v[108:109], v13 offset:55296
    ds_read_b64_tr_b16 v[110:111], v13 offset:56320
    buffer_load_dwordx4 v20, s[24:27], s86 offen lds
    v_mfma_f32_32x32x16_bf16 v[160:175], v[112:115], a[216:219], v[160:175]
    v_mfma_f32_32x32x16_bf16 v[224:239], v[112:115], a[220:223], v[224:239]
    ds_read_b64_tr_b16 v[112:113], v14 offset:55296
    s_waitcnt lgkmcnt(6)
    v_lshlrev_b32 v76, 16, v68
    ds_read_b64_tr_b16 v[114:115], v14 offset:56320
    v_add_f32 v43, v43, v76
    buffer_load_dwordx4 v21, s[24:27], s86 offen offset:1024 lds
    v_mfma_f32_32x32x16_bf16 v[176:191], v[116:119], a[216:219], v[176:191]
    s_add_u32 m0, s76, 0x1e000
    s_mov_b32 s86, 0xa000
    v_and_b32 v77, 0xffff0000, v68
    v_add_f32 v43, v43, v77
    v_lshlrev_b32 v76, 16, v69
    v_add_f32 v43, v43, v76
    v_mfma_f32_32x32x16_bf16 v[240:255], v[116:119], a[220:223], v[240:255]
    ds_read_b64_tr_b16 v[116:117], v15 offset:55296
    v_and_b32 v77, 0xffff0000, v69
    ds_read_b64_tr_b16 v[118:119], v15 offset:56320
    v_add_f32 v43, v43, v77
    s_waitcnt lgkmcnt(6)
    v_lshlrev_b32 v76, 16, v70
    v_mfma_f32_32x32x16_bf16 a[128:143], v[120:123], a[216:219], a[128:143]
    buffer_load_dwordx4 v22, s[28:31], s87 offen lds
    ds_read_b64_tr_b16 v[68:69], v19
    v_add_f32 v43, v43, v76
    v_and_b32 v77, 0xffff0000, v70
    v_add_f32 v43, v43, v77
    v_lshlrev_b32 v76, 16, v71
    v_mfma_f32_32x32x16_bf16 a[144:159], v[120:123], a[220:223], a[144:159]
    ds_read_b64_tr_b16 v[120:121], v16 offset:55296
    v_and_b32 v77, 0xffff0000, v71
    ds_read_b64_tr_b16 v[122:123], v16 offset:55808
    v_add_f32 v43, v43, v76
    ds_read_b64_tr_b16 v[70:71], v19 offset:512
    v_add_f32 v43, v43, v77
    v_mfma_f32_32x32x16_bf16 a[160:175], v[124:127], a[216:219], a[160:175]
    buffer_load_dwordx4 v22, s[28:31], s87 offen offset:1024 lds
    s_add_u32 m0, s76, 0x2000
    s_mov_b32 s87, 0x8000
    ds_read_b128 a[216:219], v11 offset:8192
    v_mfma_f32_32x32x16_bf16 a[176:191], v[124:127], a[220:223], a[176:191]
    ds_read_b64_tr_b16 v[124:125], v17 offset:55296
    ds_read_b64_tr_b16 v[126:127], v17 offset:55808
    ds_read_b128 a[220:223], v11 offset:12288
    v_mfma_f32_32x32x16_bf16 a[228:243], v[64:67], a[224:227], a[228:243]
    ds_read_b64_tr_b16 v[64:65], v18
    ds_read_b64_tr_b16 v[66:67], v18 offset:1024
    s_waitcnt lgkmcnt(9)
    v_lshlrev_b32 v76, 16, v68
    v_mfma_f32_32x32x16_bf16 v[128:143], v[80:83], a[192:195], v[128:143]
    v_add_f32 v43, v43, v76
    v_and_b32 v77, 0xffff0000, v68
    v_add_f32 v43, v43, v77
    v_lshlrev_b32 v76, 16, v69
    v_add_f32 v43, v43, v76
    v_and_b32 v77, 0xffff0000, v69
    v_mfma_f32_32x32x16_bf16 v[192:207], v[80:83], a[196:199], v[192:207]
    ds_read_b64_tr_b16 v[80:81], v12
    v_add_f32 v43, v43, v77
    ds_read_b64_tr_b16 v[82:83], v12 offset:1024
    s_waitcnt lgkmcnt(8)
    v_lshlrev_b32 v76, 16, v70
    v_add_f32 v43, v43, v76
    v_mfma_f32_32x32x16_bf16 v[144:159], v[84:87], a[192:195], v[144:159]
    v_and_b32 v77, 0xffff0000, v70
    v_add_f32 v43, v43, v77
    v_lshlrev_b32 v76, 16, v71
    v_add_f32 v43, v43, v76
    v_and_b32 v77, 0xffff0000, v71
    v_add_f32 v43, v43, v77
    v_mfma_f32_32x32x16_bf16 v[208:223], v[84:87], a[196:199], v[208:223]
    ds_read_b64_tr_b16 v[84:85], v13
    v_mov_b32 v77, v43
    ds_read_b64_tr_b16 v[86:87], v13 offset:1024
    v_lshlrev_b32 v76, 4, v41
    v_permlane32_swap_b32 v43, v77
    v_add_f32 v43, v43, v77
    v_mfma_f32_32x32x16_bf16 v[160:175], v[88:91], a[192:195], v[160:175]
    v_add_u32 v76, s68, v76
    s_lshl_b32 s68, s85, 11
    s_add_u32 s67, s67, s68
    s_add_u32 s67, s67, 0x100000
    s_cmp_lt_u32 s85, 22
    s_cselect_b32 s77, s67, 0x10000000
    v_mfma_f32_32x32x16_bf16 v[224:239], v[88:91], a[196:199], v[224:239]
    s_add_u32 s94, s77, 0
    s_add_u32 s95, s77, 0x400
    s_lshr_b32 s67, s80, 5
    s_lshl_b32 s67, s67, 18
    s_mov_b32 s85, 0x2400
    ds_read_b64_tr_b16 v[88:89], v14
    v_mfma_f32_32x32x16_bf16 v[176:191], v[92:95], a[192:195], v[176:191]
    ds_read_b64_tr_b16 v[90:91], v14 offset:1024
    s_lshl_b32 s68, s80, 3
    ds_write_b32 v79, v43 offset:512
    s_add_u32 s68, s68, 0x10000
    s_cmp_lt_u32 s84, 22
    s_cselect_b32 s78, s68, 0x10000000
    v_mfma_f32_32x32x16_bf16 v[240:255], v[92:95], a[196:199], v[240:255]
    s_lshl_b32 s68, s80, 3
    s_add_u32 s68, s68, 0x10000
    s_and_b32 s80, s62, 1
    s_mov_b32 s84, 0x1800
    ds_read_b64_tr_b16 v[92:93], v15
    v_lshl_add_u32 v43, v41, 2, v47
    v_mfma_f32_32x32x16_bf16 a[128:143], v[96:99], a[192:195], a[128:143]
    ds_read_b64_tr_b16 v[94:95], v15 offset:1024
    s_add_u32 s88, s78, 0
    s_add_u32 s89, s78, 0x100
    s_and_b32 s78, s64, 3
    v_mfma_f32_32x32x16_bf16 a[144:159], v[96:99], a[196:199], a[144:159]
    ds_read_b64_tr_b16 v[96:97], v16
    ds_read_b64_tr_b16 v[98:99], v16 offset:512
    v_mfma_f32_32x32x16_bf16 a[160:175], v[100:103], a[192:195], a[160:175]
    v_mfma_f32_32x32x16_bf16 a[176:191], v[100:103], a[196:199], a[176:191]
    ds_read_b64_tr_b16 v[100:101], v17
    ds_read_b64_tr_b16 v[102:103], v17 offset:512
    v_mfma_f32_32x32x16_bf16 a[228:243], v[72:75], a[224:227], a[228:243]
    ds_read_b64_tr_b16 v[72:73], v18 offset:6144
    ds_read_b64_tr_b16 v[74:75], v18 offset:7168
    v_mfma_f32_32x32x16_bf16 v[128:143], v[104:107], a[200:203], v[128:143]
    v_mfma_f32_32x32x16_bf16 v[192:207], v[104:107], a[204:207], v[192:207]
    ds_read_b64_tr_b16 v[104:105], v12 offset:6144
    ds_read_b64_tr_b16 v[106:107], v12 offset:7168
    v_mfma_f32_32x32x16_bf16 v[144:159], v[108:111], a[200:203], v[144:159]
    v_mfma_f32_32x32x16_bf16 v[208:223], v[108:111], a[204:207], v[208:223]
    ds_read_b64_tr_b16 v[108:109], v13 offset:6144
    ds_read_b64_tr_b16 v[110:111], v13 offset:7168
    v_mfma_f32_32x32x16_bf16 v[160:175], v[112:115], a[200:203], v[160:175]
    v_mfma_f32_32x32x16_bf16 v[224:239], v[112:115], a[204:207], v[224:239]
    ds_read_b64_tr_b16 v[112:113], v14 offset:6144
    ds_read_b64_tr_b16 v[114:115], v14 offset:7168
    v_mfma_f32_32x32x16_bf16 v[176:191], v[116:119], a[200:203], v[176:191]
    v_mfma_f32_32x32x16_bf16 v[240:255], v[116:119], a[204:207], v[240:255]
    ds_read_b64_tr_b16 v[116:117], v15 offset:6144
    ds_read_b64_tr_b16 v[118:119], v15 offset:7168
    v_mfma_f32_32x32x16_bf16 a[128:143], v[120:123], a[200:203], a[128:143]
    v_mfma_f32_32x32x16_bf16 a[144:159], v[120:123], a[204:207], a[144:159]
    ds_read_b64_tr_b16 v[120:121], v16 offset:6144
    ds_read_b64_tr_b16 v[122:123], v16 offset:6656
    s_waitcnt lgkmcnt(6)
    v_mfma_f32_32x32x16_bf16 a[160:175], v[124:127], a[200:203], a[160:175]
    v_mfma_f32_32x32x16_bf16 a[176:191], v[124:127], a[204:207], a[176:191]
    ds_read_b64_tr_b16 v[124:125], v17 offset:6144
    ds_read_b64_tr_b16 v[126:127], v17 offset:6656
    v_mfma_f32_32x32x16_bf16 a[228:243], v[64:67], a[224:227], a[228:243]
    v_mfma_f32_32x32x16_bf16 v[128:143], v[80:83], a[208:211], v[128:143]
    v_mfma_f32_32x32x16_bf16 v[192:207], v[80:83], a[212:215], v[192:207]
    v_mov_b32 v81, 0
    v_mov_b32 v82, 0
    v_mov_b32 v83, 0
    v_mfma_f32_32x32x16_bf16 v[144:159], v[84:87], a[208:211], v[144:159]
    v_mfma_f32_32x32x16_bf16 v[208:223], v[84:87], a[212:215], v[208:223]
    v_mov_b32 v85, 0
    v_mov_b32 v86, 0
    v_mov_b32 v87, 0
    v_mfma_f32_32x32x16_bf16 v[160:175], v[88:91], a[208:211], v[160:175]
    v_mfma_f32_32x32x16_bf16 v[224:239], v[88:91], a[212:215], v[224:239]
    v_mov_b32 v89, 0
    v_mov_b32 v90, 0
    v_mov_b32 v91, 0
    v_mfma_f32_32x32x16_bf16 v[176:191], v[92:95], a[208:211], v[176:191]
    v_mfma_f32_32x32x16_bf16 v[240:255], v[92:95], a[212:215], v[240:255]
    v_mov_b32 v93, 0
    v_mov_b32 v94, 0
    v_mov_b32 v95, 0
    v_mfma_f32_32x32x16_bf16 a[128:143], v[96:99], a[208:211], a[128:143]
    v_mfma_f32_32x32x16_bf16 a[144:159], v[96:99], a[212:215], a[144:159]
    v_mov_b32 v97, 0
    v_mov_b32 v98, 0
    v_mov_b32 v99, 0
    v_mfma_f32_32x32x16_bf16 a[160:175], v[100:103], a[208:211], a[160:175]
    v_mfma_f32_32x32x16_bf16 a[176:191], v[100:103], a[212:215], a[176:191]
    v_mov_b32 v101, 0
    v_mov_b32 v102, 0
    v_mov_b32 v103, 0
    v_mfma_f32_32x32x16_bf16 a[228:243], v[72:75], a[224:227], a[228:243]
    v_mfma_f32_32x32x16_bf16 v[128:143], v[104:107], a[216:219], v[128:143]
    v_mfma_f32_32x32x16_bf16 v[192:207], v[104:107], a[220:223], v[192:207]
    v_mov_b32 v105, 0
    v_mov_b32 v106, 0
    v_mov_b32 v107, 0
    v_mfma_f32_32x32x16_bf16 v[144:159], v[108:111], a[216:219], v[144:159]
    v_mfma_f32_32x32x16_bf16 v[208:223], v[108:111], a[220:223], v[208:223]
    v_mov_b32 v109, 0
    v_mov_b32 v110, 0
    v_mov_b32 v111, 0
    s_waitcnt lgkmcnt(0)
    v_mfma_f32_32x32x16_bf16 v[160:175], v[112:115], a[216:219], v[160:175]
    ds_write_b128 v76, a[228:231]
    s_waitcnt vmcnt(9)
    v_mul_f32 v74, 0x3e0293ee, v37
    v_mfma_f32_32x32x16_bf16 v[224:239], v[112:115], a[220:223], v[224:239]
    s_waitcnt vmcnt(8)
    v_mul_f32 v75, 0x3e0293ee, v39
    ds_write_b128 v76, a[232:235] offset:32
    v_mfma_f32_32x32x16_bf16 v[176:191], v[116:119], a[216:219], v[176:191]
    ds_write_b128 v76, a[236:239] offset:64
    v_mfma_f32_32x32x16_bf16 v[240:255], v[116:119], a[220:223], v[240:255]
    v_mfma_f32_32x32x16_bf16 a[128:143], v[120:123], a[216:219], a[128:143]
    ds_write_b128 v76, a[240:243] offset:96
    v_mfma_f32_32x32x16_bf16 a[144:159], v[120:123], a[220:223], a[144:159]
    v_mfma_f32_32x32x16_bf16 a[160:175], v[124:127], a[216:219], a[160:175]
    s_waitcnt lgkmcnt(0)
    s_barrier
    buffer_load_dwordx4 v20, s[24:27], s86 offen lds
    v_mfma_f32_32x32x16_bf16 a[176:191], v[124:127], a[220:223], a[176:191]
    ds_read_b32 v64, v78
    ds_read_b32 v65, v78 offset:128
    ds_read_b32 v66, v78 offset:256
    ds_read_b32 v67, v78 offset:384
    ds_read_b32 v68, v78 offset:512
    ds_read_b32 v70, v78 offset:768
    ds_read_b32 v69, v78 offset:640
    buffer_load_dwordx4 v21, s[24:27], s86 offen offset:1024 lds
    s_add_u32 m0, s76, 0x12000
    s_mov_b32 s86, 0xc000
    ds_read_b32 v71, v78 offset:896
    buffer_load_dwordx4 v22, s[28:31], s87 offen lds
    s_waitcnt lgkmcnt(7)
    v_cvt_pk_bf16_f32 v72, v64, v64
    v_and_b32 v72, 0xffff0000, v72
    v_sub_f32 v73, v64, v72
    v_cvt_pk_bf16_f32 v80, v72, v73
    s_waitcnt lgkmcnt(6)
    v_cvt_pk_bf16_f32 v72, v65, v65
    v_and_b32 v72, 0xffff0000, v72
    v_sub_f32 v73, v65, v72
    v_cvt_pk_bf16_f32 v84, v72, v73
    buffer_load_dwordx4 v22, s[28:31], s87 offen offset:1024 lds
    s_add_u32 m0, s76, 0x8000
    s_mov_b32 s87, 0xa000
    s_waitcnt lgkmcnt(5)
    v_cvt_pk_bf16_f32 v72, v66, v66
    v_and_b32 v72, 0xffff0000, v72
    v_sub_f32 v73, v66, v72
    v_cvt_pk_bf16_f32 v88, v72, v73
    s_waitcnt lgkmcnt(4)
    v_cvt_pk_bf16_f32 v72, v67, v67
    v_and_b32 v72, 0xffff0000, v72
    v_sub_f32 v73, v67, v72
    s_waitcnt lgkmcnt(2)
    v_add_f32 v68, v68, v70
    v_cvt_pk_bf16_f32 v92, v72, v73
    v_cvt_pk_bf16_f32 v72, v68, v68
    buffer_load_dwordx4 v20, s[24:27], s86 offen lds
    v_and_b32 v72, 0xffff0000, v72
    v_sub_f32 v73, v68, v72
    s_waitcnt lgkmcnt(0)
    v_add_f32 v69, v69, v71
    v_cvt_pk_bf16_f32 v96, v72, v73
    v_cvt_pk_bf16_f32 v72, v69, v69
    v_and_b32 v72, 0xffff0000, v72
    v_sub_f32 v73, v69, v72
    v_cvt_pk_bf16_f32 v100, v72, v73
    v_cvt_pk_bf16_f32 v72, v36, v36
    v_xor_b32 v72, 0x80008000, v72
    v_cndmask_b32 v104, 0, v72
    v_cvt_pk_bf16_f32 v72, v38, v38
    v_xor_b32 v72, 0x80008000, v72
    v_mfma_f32_32x32x16_bf16 a[128:143], v[96:99], v[104:107], a[128:143]
    buffer_load_dwordx4 v21, s[24:27], s86 offen offset:1024 lds
    s_add_u32 m0, s76, 0x14000
    s_mov_b32 s86, 0xe000
    v_cndmask_b32 v108, 0, v72
    v_cmp_eq_u32 vcc, 0, v41
    buffer_load_dwordx4 v22, s[28:31], s87 offen lds
    v_mfma_f32_32x32x16_bf16 a[144:159], v[96:99], v[108:111], a[144:159]
    s_barrier
    ds_read_b128 a[192:195], v24 offset:16384
    v_mfma_f32_32x32x16_bf16 a[160:175], v[100:103], v[104:107], a[160:175]
    ds_read_b128 a[196:199], v25 offset:16384
    ds_read_b128 a[200:203], v26 offset:16384
    buffer_load_dwordx4 v22, s[28:31], s87 offen offset:1024 lds
    v_mfma_f32_32x32x16_bf16 a[176:191], v[100:103], v[108:111], a[176:191]
    s_add_u32 m0, s76, 0xe000
    s_mov_b32 s87, 0xc000
    v_accvgpr_read_b32 v2, a128
    v_accvgpr_read_b32 v3, a129
    v_mul_f32 v2, v2, v37
    v_mul_f32 v3, v3, v37
    v_mfma_f32_32x32x16_bf16 v[128:143], v[80:83], v[104:107], v[128:143]
    v_mul_f32 v4, v2, v2
    v_accvgpr_read_b32 v18, a160
    v_accvgpr_read_b32 v19, a161
    v_accvgpr_read_b32 v23, a162
    v_accvgpr_read_b32 v42, a163
    buffer_load_dwordx4 v20, s[24:27], s86 offen lds
    v_mfma_f32_32x32x16_bf16 v[192:207], v[80:83], v[108:111], v[192:207]
    v_mul_f32 v18, v18, v37
    v_mul_f32 v19, v19, v37
    v_mul_f32 v23, v23, v37
    v_mul_f32 v42, v42, v37
    v_mul_f32 v5, v3, v3
    v_accvgpr_read_b32 v6, a130
    v_mfma_f32_32x32x16_bf16 v[144:159], v[84:87], v[104:107], v[144:159]
    v_accvgpr_read_b32 v7, a131
    v_fmaak_f32 v4, v4, v44, 0xc0135761
    v_fmaak_f32 v5, v5, v44, 0xc0135761
    v_mul_f32 v6, v6, v37
    v_mul_f32 v7, v7, v37
    buffer_load_dwordx4 v21, s[24:27], s86 offen offset:1024 lds
    v_mfma_f32_32x32x16_bf16 v[208:223], v[84:87], v[108:111], v[208:223]
    s_add_u32 m0, s76, 0x18000
    s_mov_b32 s86, 0x10000
    v_mul_f32 v4, v4, v2
    v_mul_f32 v5, v5, v3
    v_mul_f32 v8, v6, v6
    v_mul_f32 v9, v7, v7
    v_mfma_f32_32x32x16_bf16 v[160:175], v[88:91], v[104:107], v[160:175]
    v_exp_f32 v4, v4
    v_exp_f32 v5, v5
    v_fmaak_f32 v8, v8, v44, 0xc0135761
    buffer_load_dwordx4 v22, s[28:31], s87 offen lds
    v_mfma_f32_32x32x16_bf16 v[224:239], v[88:91], v[108:111], v[224:239]
    v_fmaak_f32 v9, v9, v44, 0xc0135761
    v_mul_f32 v8, v8, v6
    v_mul_f32 v9, v9, v7
    v_exp_f32 v8, v8
    v_add_f32 v4, 1.0, v4
    v_mfma_f32_32x32x16_bf16 v[176:191], v[92:95], v[104:107], v[176:191]
    v_exp_f32 v9, v9
    v_add_f32 v5, 1.0, v5
    v_rcp_f32 v4, v4
    buffer_load_dwordx4 v22, s[28:31], s87 offen offset:1024 lds
    v_mfma_f32_32x32x16_bf16 v[240:255], v[92:95], v[108:111], v[240:255]
    s_add_u32 m0, s76, 0x1a000
    s_mov_b32 s87, 0xe000
    v_rcp_f32 v5, v5
    v_add_f32 v8, 1.0, v8
    v_add_f32 v9, 1.0, v9
    v_rcp_f32 v8, v8
    v_rcp_f32 v9, v9
    v_mul_f32 v2, v2, v4
    v_mul_f32 v3, v3, v5
    v_add_f32 v10, v2, v3
    buffer_load_dwordx4 v22, s[28:31], s87 offen lds
    v_mul_f32 v11, v2, v2
    v_cvt_pk_bf16_f32 v112, v2, v3
    v_fmac_f32 v11, v3, v3
    v_mul_f32 v6, v6, v8
    v_mul_f32 v7, v7, v9
    v_accvgpr_read_b32 v2, a132
    v_add_f32 v10, v10, v6
    v_fmac_f32 v11, v6, v6
    v_cvt_pk_bf16_f32 v113, v6, v7
    v_accvgpr_read_b32 v3, a133
    v_mul_f32 v2, v2, v37
    v_add_f32 v10, v10, v7
    v_fmac_f32 v11, v7, v7
    v_mul_f32 v3, v3, v37
    v_mul_f32 v4, v2, v2
    buffer_load_dwordx4 v22, s[28:31], s87 offen offset:1024 lds
    s_add_u32 m0, s76, 0
    s_mov_b32 s87, 0x10000
    v_accvgpr_read_b32 v6, a134
    v_fmaak_f32 v4, v4, v44, 0xc0135761
    v_mul_f32 v5, v3, v3
    v_accvgpr_read_b32 v7, a135
    v_mul_f32 v6, v6, v37
    v_mul_f32 v4, v4, v2
    v_fmaak_f32 v5, v5, v44, 0xc0135761
    v_mul_f32 v7, v7, v37
    v_mul_f32 v8, v6, v6
    v_exp_f32 v4, v4
    v_mul_f32 v5, v5, v3
    v_fmaak_f32 v8, v8, v44, 0xc0135761
    v_mul_f32 v9, v7, v7
    v_exp_f32 v5, v5
    v_mul_f32 v8, v8, v6
    v_fmaak_f32 v9, v9, v44, 0xc0135761
    v_exp_f32 v8, v8
    v_mul_f32 v9, v9, v7
    v_add_f32 v4, 1.0, v4
    v_exp_f32 v9, v9
    v_rcp_f32 v4, v4
    v_add_f32 v5, 1.0, v5
    v_rcp_f32 v5, v5
    v_add_f32 v8, 1.0, v8
    v_rcp_f32 v8, v8
    v_add_f32 v9, 1.0, v9
    v_mul_f32 v2, v2, v4
    v_rcp_f32 v9, v9
    v_mul_f32 v3, v3, v5
    v_add_f32 v10, v10, v2
    v_fmac_f32 v11, v2, v2
    v_add_f32 v10, v10, v3
    v_fmac_f32 v11, v3, v3
    v_cvt_pk_bf16_f32 v114, v2, v3
    v_mul_f32 v6, v6, v8
    v_mul_f32 v7, v7, v9
    v_add_f32 v10, v10, v6
    v_fmac_f32 v11, v6, v6
    v_accvgpr_read_b32 v2, a136
    v_accvgpr_read_b32 v3, a137
    v_add_f32 v10, v10, v7
    v_fmac_f32 v11, v7, v7
    v_cvt_pk_bf16_f32 v115, v6, v7
    v_mul_f32 v2, v2, v37
    v_mul_f32 v3, v3, v37
    v_mul_f32 v4, v2, v2
    v_mul_f32 v5, v3, v3
    v_accvgpr_read_b32 v6, a138
    v_accvgpr_read_b32 v7, a139
    v_fmaak_f32 v4, v4, v44, 0xc0135761
    v_fmaak_f32 v5, v5, v44, 0xc0135761
    v_mul_f32 v6, v6, v37
    v_mul_f32 v7, v7, v37
    v_mul_f32 v4, v4, v2
    v_mul_f32 v5, v5, v3
    v_mul_f32 v8, v6, v6
    v_mul_f32 v9, v7, v7
    v_exp_f32 v4, v4
    v_exp_f32 v5, v5
    v_fmaak_f32 v8, v8, v44, 0xc0135761
    v_fmaak_f32 v9, v9, v44, 0xc0135761
    v_mul_f32 v8, v8, v6
    v_mul_f32 v9, v9, v7
    v_exp_f32 v8, v8
    v_exp_f32 v9, v9
    v_add_f32 v4, 1.0, v4
    v_add_f32 v5, 1.0, v5
    v_rcp_f32 v4, v4
    v_rcp_f32 v5, v5
    v_add_f32 v8, 1.0, v8
    v_add_f32 v9, 1.0, v9
    v_rcp_f32 v8, v8
    v_rcp_f32 v9, v9
    v_mul_f32 v2, v2, v4
    v_mul_f32 v3, v3, v5
    v_add_f32 v12, v2, v3
    v_mul_f32 v13, v2, v2
    v_cvt_pk_bf16_f32 v116, v2, v3
    v_fmac_f32 v13, v3, v3
    v_mul_f32 v6, v6, v8
    v_mul_f32 v7, v7, v9
    v_accvgpr_read_b32 v2, a140
    v_add_f32 v12, v12, v6
    v_fmac_f32 v13, v6, v6
    v_cvt_pk_bf16_f32 v117, v6, v7
    v_accvgpr_read_b32 v3, a141
    v_mul_f32 v2, v2, v37
    v_add_f32 v12, v12, v7
    v_fmac_f32 v13, v7, v7
    v_mul_f32 v3, v3, v37
    v_mul_f32 v4, v2, v2
    v_accvgpr_read_b32 v6, a142
    v_fmaak_f32 v4, v4, v44, 0xc0135761
    v_mul_f32 v5, v3, v3
    v_accvgpr_read_b32 v7, a143
    v_mul_f32 v6, v6, v37
    v_mul_f32 v4, v4, v2
    v_fmaak_f32 v5, v5, v44, 0xc0135761
    v_mul_f32 v7, v7, v37
    v_mul_f32 v8, v6, v6
    v_exp_f32 v4, v4
    v_mul_f32 v5, v5, v3
    v_fmaak_f32 v8, v8, v44, 0xc0135761
    v_mul_f32 v9, v7, v7
    v_exp_f32 v5, v5
    v_mul_f32 v8, v8, v6
    v_fmaak_f32 v9, v9, v44, 0xc0135761
    v_exp_f32 v8, v8
    v_mul_f32 v9, v9, v7
    v_add_f32 v4, 1.0, v4
    v_exp_f32 v9, v9
    v_rcp_f32 v4, v4
    v_add_f32 v5, 1.0, v5
    v_rcp_f32 v5, v5
    v_add_f32 v8, 1.0, v8
    v_rcp_f32 v8, v8
    v_add_f32 v9, 1.0, v9
    v_mul_f32 v2, v2, v4
    v_rcp_f32 v9, v9
    v_mul_f32 v3, v3, v5
    v_add_f32 v12, v12, v2
    v_fmac_f32 v13, v2, v2
    v_add_f32 v12, v12, v3
    v_fmac_f32 v13, v3, v3
    v_mul_f32 v6, v6, v8
    v_mul_f32 v7, v7, v9
    v_add_f32 v12, v12, v6
    v_fmac_f32 v13, v6, v6
    v_add_f32 v12, v12, v7
    v_fmac_f32 v13, v7, v7
    v_cvt_pk_bf16_f32 v118, v2, v3
    v_fma_f32 v10, v12, s79, v10
    v_fma_f32 v11, v13, s79, v11
    v_mov_b32 v2, v10
    v_mov_b32 v3, v11
    v_cvt_pk_bf16_f32 v119, v6, v7
    v_permlane32_swap_b32 v10, v2
    v_permlane32_swap_b32 v11, v3
    v_add_f32 v10, v10, v2
    v_add_f32 v11, v11, v3
    v_accvgpr_read_b32 v2, a144
    v_accvgpr_read_b32 v3, a145
    v_mul_f32 v2, v2, v39
    v_mul_f32 v3, v3, v39
    v_mul_f32 v4, v2, v2
    v_mul_f32 v5, v3, v3
    v_accvgpr_read_b32 v6, a146
    v_accvgpr_read_b32 v7, a147
    v_fmaak_f32 v4, v4, v44, 0xc0135761
    v_fmaak_f32 v5, v5, v44, 0xc0135761
    v_mul_f32 v6, v6, v39
    v_mul_f32 v7, v7, v39
    v_mul_f32 v4, v4, v2
    v_mul_f32 v5, v5, v3
    v_mul_f32 v8, v6, v6
    v_mul_f32 v9, v7, v7
    v_exp_f32 v4, v4
    v_exp_f32 v5, v5
    v_fmaak_f32 v8, v8, v44, 0xc0135761
    v_fmaak_f32 v9, v9, v44, 0xc0135761
    v_mul_f32 v8, v8, v6
    v_mul_f32 v9, v9, v7
    v_exp_f32 v8, v8
    v_exp_f32 v9, v9
    v_add_f32 v4, 1.0, v4
    v_add_f32 v5, 1.0, v5
    v_rcp_f32 v4, v4
    v_rcp_f32 v5, v5
    v_add_f32 v8, 1.0, v8
    v_add_f32 v9, 1.0, v9
    v_rcp_f32 v8, v8
    v_rcp_f32 v9, v9
    v_mul_f32 v2, v2, v4
    v_mul_f32 v3, v3, v5
    v_add_f32 v14, v2, v3
    v_mul_f32 v15, v2, v2
    v_cvt_pk_bf16_f32 v120, v2, v3
    v_fmac_f32 v15, v3, v3
    v_mul_f32 v6, v6, v8
    v_mul_f32 v7, v7, v9
    v_accvgpr_read_b32 v2, a148
    v_add_f32 v14, v14, v6
    v_fmac_f32 v15, v6, v6
    v_cvt_pk_bf16_f32 v121, v6, v7
    v_accvgpr_read_b32 v3, a149
    v_mul_f32 v2, v2, v39
    v_add_f32 v14, v14, v7
    v_fmac_f32 v15, v7, v7
    v_mul_f32 v3, v3, v39
    v_mul_f32 v4, v2, v2
    v_accvgpr_read_b32 v6, a150
    v_fmaak_f32 v4, v4, v44, 0xc0135761
    v_mul_f32 v5, v3, v3
    v_accvgpr_read_b32 v7, a151
    v_mul_f32 v6, v6, v39
    v_mul_f32 v4, v4, v2
    v_fmaak_f32 v5, v5, v44, 0xc0135761
    v_mul_f32 v7, v7, v39
    v_mul_f32 v8, v6, v6
    v_exp_f32 v4, v4
    v_mul_f32 v5, v5, v3
    v_fmaak_f32 v8, v8, v44, 0xc0135761
    v_mul_f32 v9, v7, v7
    v_exp_f32 v5, v5
    v_mul_f32 v8, v8, v6
    v_fmaak_f32 v9, v9, v44, 0xc0135761
    v_exp_f32 v8, v8
    v_mul_f32 v9, v9, v7
    v_add_f32 v4, 1.0, v4
    v_exp_f32 v9, v9
    v_rcp_f32 v4, v4
    v_add_f32 v5, 1.0, v5
    v_rcp_f32 v5, v5
    v_add_f32 v8, 1.0, v8
    v_rcp_f32 v8, v8
    v_add_f32 v9, 1.0, v9
    v_mul_f32 v2, v2, v4
    v_rcp_f32 v9, v9
    v_mul_f32 v3, v3, v5
    v_add_f32 v14, v14, v2
    v_fmac_f32 v15, v2, v2
    v_add_f32 v14, v14, v3
    v_fmac_f32 v15, v3, v3
    v_cvt_pk_bf16_f32 v122, v2, v3
    v_mul_f32 v6, v6, v8
    v_mul_f32 v7, v7, v9
    v_add_f32 v14, v14, v6
    v_fmac_f32 v15, v6, v6
    v_accvgpr_read_b32 v2, a152
    v_accvgpr_read_b32 v3, a153
    v_add_f32 v14, v14, v7
    v_fmac_f32 v15, v7, v7
    v_cvt_pk_bf16_f32 v123, v6, v7
    v_mul_f32 v2, v2, v39
    v_mul_f32 v3, v3, v39
    v_mul_f32 v4, v2, v2
    v_mul_f32 v5, v3, v3
    v_accvgpr_read_b32 v6, a154
    v_accvgpr_read_b32 v7, a155
    v_fmaak_f32 v4, v4, v44, 0xc0135761
    v_fmaak_f32 v5, v5, v44, 0xc0135761
    v_mul_f32 v6, v6, v39
    v_mul_f32 v7, v7, v39
    v_mul_f32 v4, v4, v2
    v_mul_f32 v5, v5, v3
    v_mul_f32 v8, v6, v6
    v_mul_f32 v9, v7, v7
    v_exp_f32 v4, v4
    v_exp_f32 v5, v5
    v_fmaak_f32 v8, v8, v44, 0xc0135761
    v_fmaak_f32 v9, v9, v44, 0xc0135761
    v_mul_f32 v8, v8, v6
    v_mul_f32 v9, v9, v7
    v_exp_f32 v8, v8
    v_exp_f32 v9, v9
    v_add_f32 v4, 1.0, v4
    v_add_f32 v5, 1.0, v5
    v_rcp_f32 v4, v4
    v_rcp_f32 v5, v5
    v_add_f32 v8, 1.0, v8
    v_add_f32 v9, 1.0, v9
    v_rcp_f32 v8, v8
    v_rcp_f32 v9, v9
    v_mul_f32 v2, v2, v4
    v_mul_f32 v3, v3, v5
    v_add_f32 v16, v2, v3
    v_mul_f32 v17, v2, v2
    v_cvt_pk_bf16_f32 v124, v2, v3
    v_fmac_f32 v17, v3, v3
    v_mul_f32 v6, v6, v8
    v_mul_f32 v7, v7, v9
    v_accvgpr_read_b32 v2, a156
    v_add_f32 v16, v16, v6
    v_fmac_f32 v17, v6, v6
    v_cvt_pk_bf16_f32 v125, v6, v7
    v_accvgpr_read_b32 v3, a157
    v_mul_f32 v2, v2, v39
    v_add_f32 v16, v16, v7
    v_fmac_f32 v17, v7, v7
    v_mul_f32 v3, v3, v39
    v_mul_f32 v4, v2, v2
    v_accvgpr_read_b32 v6, a158
    v_fmaak_f32 v4, v4, v44, 0xc0135761
    v_mul_f32 v5, v3, v3
    v_accvgpr_read_b32 v7, a159
    v_mul_f32 v6, v6, v39
    v_mul_f32 v4, v4, v2
    v_fmaak_f32 v5, v5, v44, 0xc0135761
    v_mul_f32 v7, v7, v39
    v_mul_f32 v8, v6, v6
    v_exp_f32 v4, v4
    v_mul_f32 v5, v5, v3
    v_fmaak_f32 v8, v8, v44, 0xc0135761
    v_mul_f32 v9, v7, v7
    v_exp_f32 v5, v5
    v_mul_f32 v8, v8, v6
    v_fmaak_f32 v9, v9, v44, 0xc0135761
    v_exp_f32 v8, v8
    v_mul_f32 v9, v9, v7
    v_add_f32 v4, 1.0, v4
    v_exp_f32 v9, v9
    v_rcp_f32 v4, v4
    v_add_f32 v5, 1.0, v5
    v_rcp_f32 v5, v5
    v_add_f32 v8, 1.0, v8
    v_rcp_f32 v8, v8
    v_add_f32 v9, 1.0, v9
    v_mul_f32 v2, v2, v4
    v_rcp_f32 v9, v9
    v_mul_f32 v3, v3, v5
    v_add_f32 v16, v16, v2
    v_fmac_f32 v17, v2, v2
    v_add_f32 v16, v16, v3
    v_fmac_f32 v17, v3, v3
    v_mul_f32 v6, v6, v8
    v_mul_f32 v7, v7, v9
    v_add_f32 v16, v16, v6
    v_fmac_f32 v17, v6, v6
    v_add_f32 v16, v16, v7
    v_fmac_f32 v17, v7, v7
    v_cvt_pk_bf16_f32 v126, v2, v3
    v_fma_f32 v14, v16, s79, v14
    v_fma_f32 v15, v17, s79, v15
    s_lshr_b32 s79, s62, 1
    v_mov_b32 v2, v14
    v_mov_b32 v3, v15
    v_cndmask_b32 v12, v11, v10
    v_permlane32_swap_b32 v14, v2
    v_permlane32_swap_b32 v15, v3
    v_add_f32 v14, v14, v2
    v_cvt_pk_bf16_f32 v2, v18, v19
    v_accvgpr_read_b32 v18, a164
    v_accvgpr_read_b32 v19, a165
    v_mul_f32 v18, v18, v37
    v_mul_f32 v19, v19, v37
    v_cvt_pk_bf16_f32 v4, v18, v19
    v_accvgpr_read_b32 v18, a168
    v_accvgpr_read_b32 v19, a169
    v_mul_f32 v18, v18, v37
    v_mul_f32 v19, v19, v37
    v_add_f32 v15, v15, v3
    v_cvt_pk_bf16_f32 v3, v23, v42
    v_accvgpr_read_b32 v23, a166
    v_accvgpr_read_b32 v42, a167
    v_mul_f32 v23, v23, v37
    v_mul_f32 v42, v42, v37
    v_cvt_pk_bf16_f32 v5, v23, v42
    v_accvgpr_read_b32 v23, a170
    v_accvgpr_read_b32 v42, a171
    v_mul_f32 v23, v23, v37
    v_mul_f32 v42, v42, v37
    v_cmp_eq_u32 vcc, 0, v41
    buffer_atomic_add_f32 v12, v43, s[4:7], s88 offen sc1
    v_mul_f32 v254, v254, v75
    v_cndmask_b32 v16, v15, v14
    v_mul_f32 v255, v255, v75
    buffer_atomic_add_f32 v16, v43, s[4:7], s89 offen sc1
    v_mul_f32 v252, v252, v75
    v_mul_f32 v253, v253, v75
    v_cvt_pk_bf16_f32 v255, v254, v255
    v_mul_f32 v248, v248, v75
    v_mul_f32 v249, v249, v75
    v_cvt_pk_bf16_f32 v254, v252, v253
    v_mul_f32 v240, v240, v75
    v_mul_f32 v241, v241, v75
    v_cvt_pk_bf16_f32 v252, v248, v249
    v_cvt_pk_bf16_f32 v248, v240, v241
    v_mul_f32 v224, v224, v75
    v_mul_f32 v225, v225, v75
    v_mul_f32 v226, v226, v75
    v_mul_f32 v227, v227, v75
    v_cvt_pk_bf16_f32 v241, v226, v227
    v_cvt_pk_bf16_f32 v240, v224, v225
    v_mul_f32 v192, v192, v75
    v_mul_f32 v193, v193, v75
    v_mul_f32 v194, v194, v75
    v_mul_f32 v195, v195, v75
    v_mul_f32 v196, v196, v75
    v_mul_f32 v197, v197, v75
    v_mul_f32 v198, v198, v75
    v_mul_f32 v199, v199, v75
    v_cvt_pk_bf16_f32 v227, v198, v199
    v_cvt_pk_bf16_f32 v226, v196, v197
    v_cvt_pk_bf16_f32 v225, v194, v195
    v_cvt_pk_bf16_f32 v224, v192, v193
    v_mul_f32 v128, v128, v74
    v_mul_f32 v129, v129, v74
    v_mul_f32 v130, v130, v74
    v_mul_f32 v131, v131, v74
    v_mul_f32 v132, v132, v74
    v_mul_f32 v133, v133, v74
    v_mul_f32 v134, v134, v74
    v_mul_f32 v135, v135, v74
    v_mul_f32 v136, v136, v74
    v_mul_f32 v137, v137, v74
    v_mul_f32 v138, v138, v74
    v_mul_f32 v139, v139, v74
    v_mul_f32 v140, v140, v74
    v_mul_f32 v141, v141, v74
    v_mul_f32 v142, v142, v74
    v_mul_f32 v143, v143, v74
    v_cvt_pk_bf16_f32 v199, v142, v143
    v_cvt_pk_bf16_f32 v198, v140, v141
    v_cvt_pk_bf16_f32 v197, v138, v139
    v_cvt_pk_bf16_f32 v196, v136, v137
    v_cvt_pk_bf16_f32 v195, v134, v135
    v_cvt_pk_bf16_f32 v194, v132, v133
    v_cvt_pk_bf16_f32 v193, v130, v131
    v_cvt_pk_bf16_f32 v192, v128, v129
    v_mul_f32 v242, v242, v75
    v_mul_f32 v243, v243, v75
    s_waitcnt lgkmcnt(0)
    v_mfma_f32_32x32x16_bf16 v[128:143], a[192:195], v[192:195], 0
    v_cvt_pk_bf16_f32 v249, v242, v243
    v_mul_f32 v228, v228, v75
    v_mul_f32 v229, v229, v75
    v_mul_f32 v230, v230, v75
    v_mul_f32 v231, v231, v75
    v_cvt_pk_bf16_f32 v243, v230, v231
    v_cvt_pk_bf16_f32 v242, v228, v229
    v_mul_f32 v200, v200, v75
    v_mul_f32 v201, v201, v75
    v_mul_f32 v202, v202, v75
    v_mul_f32 v203, v203, v75
    v_mul_f32 v204, v204, v75
    v_mul_f32 v205, v205, v75
    v_mul_f32 v206, v206, v75
    v_mul_f32 v207, v207, v75
    v_cvt_pk_bf16_f32 v231, v206, v207
    v_cvt_pk_bf16_f32 v230, v204, v205
    v_cvt_pk_bf16_f32 v229, v202, v203
    v_cvt_pk_bf16_f32 v228, v200, v201
    v_mul_f32 v144, v144, v74
    v_mul_f32 v145, v145, v74
    v_mul_f32 v146, v146, v74
    v_mul_f32 v147, v147, v74
    v_mul_f32 v148, v148, v74
    v_mul_f32 v149, v149, v74
    v_mul_f32 v150, v150, v74
    v_mul_f32 v151, v151, v74
    v_mul_f32 v152, v152, v74
    v_mul_f32 v153, v153, v74
    v_mul_f32 v154, v154, v74
    v_mul_f32 v155, v155, v74
    v_mul_f32 v156, v156, v74
    v_mul_f32 v157, v157, v74
    v_mul_f32 v158, v158, v74
    v_mul_f32 v159, v159, v74
    v_cvt_pk_bf16_f32 v207, v158, v159
    v_cvt_pk_bf16_f32 v206, v156, v157
    v_cvt_pk_bf16_f32 v205, v154, v155
    v_cvt_pk_bf16_f32 v204, v152, v153
    v_cvt_pk_bf16_f32 v203, v150, v151
    v_cvt_pk_bf16_f32 v202, v148, v149
    v_cvt_pk_bf16_f32 v201, v146, v147
    v_cvt_pk_bf16_f32 v200, v144, v145
    v_mfma_f32_32x32x16_bf16 v[144:159], a[192:195], v[224:227], 0
    ds_read_b128 a[204:207], v27 offset:16384
    v_mul_f32 v250, v250, v75
    v_mul_f32 v251, v251, v75
    v_mul_f32 v244, v244, v75
    ds_read_b128 a[208:211], v28 offset:16384
    v_mul_f32 v245, v245, v75
    v_mfma_f32_32x32x16_bf16 v[128:143], a[196:199], v[196:199], v[128:143]
    v_cvt_pk_bf16_f32 v253, v250, v251
    v_cvt_pk_bf16_f32 v250, v244, v245
    v_mul_f32 v232, v232, v75
    v_mul_f32 v233, v233, v75
    v_mul_f32 v234, v234, v75
    v_mul_f32 v235, v235, v75
    v_mfma_f32_32x32x16_bf16 v[144:159], a[196:199], v[228:231], v[144:159]
    v_cvt_pk_bf16_f32 v245, v234, v235
    v_cvt_pk_bf16_f32 v244, v232, v233
    v_mul_f32 v208, v208, v75
    v_mul_f32 v209, v209, v75
    v_mul_f32 v210, v210, v75
    v_mul_f32 v211, v211, v75
    v_mfma_f32_32x32x16_bf16 v[128:143], a[200:203], v[200:203], v[128:143]
    v_mul_f32 v212, v212, v75
    v_mul_f32 v213, v213, v75
    v_mul_f32 v214, v214, v75
    v_mul_f32 v215, v215, v75
    v_cvt_pk_bf16_f32 v235, v214, v215
    v_cvt_pk_bf16_f32 v234, v212, v213
    v_cvt_pk_bf16_f32 v233, v210, v211
    v_cvt_pk_bf16_f32 v232, v208, v209
    ds_read_b128 a[212:215], v29 offset:16384
    v_mul_f32 v246, v246, v75
    v_mfma_f32_32x32x16_bf16 v[144:159], a[200:203], v[232:235], v[144:159]
    v_mul_f32 v247, v247, v75
    v_cvt_pk_bf16_f32 v251, v246, v247
    v_mul_f32 v236, v236, v75
    v_mul_f32 v237, v237, v75
    v_mul_f32 v238, v238, v75
    s_waitcnt lgkmcnt(2)
    v_mfma_f32_32x32x16_bf16 v[128:143], a[204:207], v[204:207], v[128:143]
    v_mul_f32 v239, v239, v75
    v_cvt_pk_bf16_f32 v247, v238, v239
    v_cvt_pk_bf16_f32 v246, v236, v237
    v_mul_f32 v216, v216, v75
    v_mul_f32 v217, v217, v75
    v_mul_f32 v218, v218, v75
    v_mul_f32 v219, v219, v75
    v_mul_f32 v220, v220, v75
    v_mul_f32 v221, v221, v75
    v_mul_f32 v222, v222, v75
    v_mul_f32 v223, v223, v75
    v_cvt_pk_bf16_f32 v239, v222, v223
    v_cvt_pk_bf16_f32 v238, v220, v221
    v_cvt_pk_bf16_f32 v237, v218, v219
    v_cvt_pk_bf16_f32 v236, v216, v217
    ds_read_b128 a[216:219], v30 offset:16384
    v_mul_f32 v160, v160, v74
    v_mfma_f32_32x32x16_bf16 v[144:159], a[204:207], v[236:239], v[144:159]
    v_mul_f32 v161, v161, v74
    v_mul_f32 v162, v162, v74
    v_mul_f32 v163, v163, v74
    v_mul_f32 v164, v164, v74
    v_mul_f32 v165, v165, v74
    v_mul_f32 v166, v166, v74
    v_mul_f32 v167, v167, v74
    v_cvt_pk_bf16_f32 v211, v166, v167
    v_cvt_pk_bf16_f32 v210, v164, v165
    v_cvt_pk_bf16_f32 v209, v162, v163
    v_cvt_pk_bf16_f32 v208, v160, v161
    ds_read_b128 a[220:223], v31 offset:16384
    v_mul_f32 v168, v168, v74
    s_waitcnt lgkmcnt(3)
    v_mfma_f32_32x32x16_bf16 v[128:143], a[208:211], v[208:211], v[128:143]
    v_mul_f32 v169, v169, v74
    v_mul_f32 v170, v170, v74
    v_mul_f32 v171, v171, v74
    v_mul_f32 v172, v172, v74
    v_mul_f32 v173, v173, v74
    v_mul_f32 v174, v174, v74
    v_mfma_f32_32x32x16_bf16 v[144:159], a[208:211], v[240:243], v[144:159]
    v_mul_f32 v175, v175, v74
    v_cvt_pk_bf16_f32 v215, v174, v175
    v_cvt_pk_bf16_f32 v214, v172, v173
    v_cvt_pk_bf16_f32 v213, v170, v171
    v_cvt_pk_bf16_f32 v212, v168, v169
    v_mul_f32 v176, v176, v74
    v_mul_f32 v177, v177, v74
    s_waitcnt lgkmcnt(2)
    v_mfma_f32_32x32x16_bf16 v[128:143], a[212:215], v[212:215], v[128:143]
    v_mul_f32 v178, v178, v74
    v_mul_f32 v179, v179, v74
    v_mul_f32 v180, v180, v74
    v_mul_f32 v181, v181, v74
    v_mul_f32 v182, v182, v74
    v_mul_f32 v183, v183, v74
    v_mfma_f32_32x32x16_bf16 v[144:159], a[212:215], v[244:247], v[144:159]
    v_cvt_pk_bf16_f32 v219, v182, v183
    v_cvt_pk_bf16_f32 v218, v180, v181
    v_cvt_pk_bf16_f32 v217, v178, v179
    v_cvt_pk_bf16_f32 v216, v176, v177
    v_mul_f32 v184, v184, v74
    v_mul_f32 v185, v185, v74
    s_waitcnt lgkmcnt(1)
    v_mfma_f32_32x32x16_bf16 v[128:143], a[216:219], v[216:219], v[128:143]
    s_barrier
    ds_read_b128 a[224:227], v24 offset:40960
    v_mul_f32 v186, v186, v74
    v_mfma_f32_32x32x16_bf16 v[144:159], a[216:219], v[248:251], v[144:159]
    v_mul_f32 v187, v187, v74
    v_mul_f32 v188, v188, v74
    v_mul_f32 v189, v189, v74
    v_mul_f32 v190, v190, v74
    v_mul_f32 v191, v191, v74
    v_cvt_pk_bf16_f32 v223, v190, v191
    v_cvt_pk_bf16_f32 v222, v188, v189
    v_cvt_pk_bf16_f32 v221, v186, v187
    v_cvt_pk_bf16_f32 v220, v184, v185
    ds_read_b128 a[228:231], v25 offset:40960
    v_cvt_pk_bf16_f32 v127, v6, v7
    s_waitcnt lgkmcnt(2)
    v_mfma_f32_32x32x16_bf16 v[128:143], a[220:223], v[220:223], v[128:143]
    v_cvt_pk_bf16_f32 v6, v18, v19
    v_cvt_pk_bf16_f32 v7, v23, v42
    v_accvgpr_read_b32 v18, a172
    v_accvgpr_read_b32 v19, a173
    v_accvgpr_read_b32 v23, a174
    v_accvgpr_read_b32 v42, a175
    v_mfma_f32_32x32x16_bf16 v[144:159], a[220:223], v[252:255], v[144:159]
    v_mul_f32 v18, v18, v37
    v_mul_f32 v19, v19, v37
    v_mul_f32 v23, v23, v37
    v_mul_f32 v42, v42, v37
    v_cvt_pk_bf16_f32 v8, v18, v19
    v_cvt_pk_bf16_f32 v9, v23, v42
    v_accvgpr_read_b32 v18, a176
    v_accvgpr_read_b32 v19, a177
    v_accvgpr_read_b32 v23, a178
    v_accvgpr_read_b32 v42, a179
    v_mul_f32 v18, v18, v39
    v_mul_f32 v19, v19, v39
    v_mul_f32 v23, v23, v39
    v_mul_f32 v42, v42, v39
    v_max3_f32 v53, v128, v129, v130
    v_max3_f32 v53, v131, v132, v53
    v_max3_f32 v53, v133, v134, v53
    v_max3_f32 v53, v135, v136, v53
    v_max3_f32 v53, v137, v138, v53
    v_max3_f32 v53, v139, v140, v53
    v_max3_f32 v53, v141, v142, v53
    v_max_f32 v53, v143, v53
    v_mov_b32 v54, v53
    v_max3_f32 v55, v144, v145, v146
    v_max3_f32 v55, v147, v148, v55
    v_permlane32_swap_b32 v53, v54
    v_max_f32 v53, v53, v54
    v_max3_f32 v55, v149, v150, v55
    ds_read_b128 a[232:235], v26 offset:40960
    v_sub_f32 v54, 0, v53
    v_max3_f32 v55, v151, v152, v55
    v_mov_b32 v64, v54
    v_mov_b32 v65, v54
    v_mov_b32 v66, v54
    v_mov_b32 v67, v54
    v_mov_b32 v68, v54
    v_mov_b32 v69, v54
    v_mov_b32 v70, v54
    v_mov_b32 v71, v54
    v_mov_b32 v72, v54
    v_mov_b32 v73, v54
    v_mov_b32 v74, v54
    v_mov_b32 v75, v54
    v_mov_b32 v76, v54
    v_mov_b32 v77, v54
    v_mov_b32 v78, v54
    v_mov_b32 v79, v54
    v_max3_f32 v55, v153, v154, v55
    v_max3_f32 v55, v155, v156, v55
    s_waitcnt lgkmcnt(1)
    v_mfma_f32_32x32x16_bf16 v[160:175], a[224:227], v[192:195], v[64:79]
    v_max3_f32 v55, v157, v158, v55
    v_max_f32 v55, v159, v55
    v_mov_b32 v56, v55
    ds_read_b128 a[236:239], v27 offset:40960
    v_sub_f32 v128, v128, v53
    v_permlane32_swap_b32 v55, v56
    v_max_f32 v55, v55, v56
    v_sub_f32 v56, 0, v55
    v_mov_b32 v80, v56
    v_mov_b32 v81, v56
    v_mov_b32 v82, v56
    v_mov_b32 v83, v56
    v_mov_b32 v84, v56
    v_mov_b32 v85, v56
    v_mov_b32 v86, v56
    v_mov_b32 v87, v56
    v_mov_b32 v88, v56
    v_mov_b32 v89, v56
    v_mov_b32 v90, v56
    v_mov_b32 v91, v56
    v_mov_b32 v92, v56
    v_mov_b32 v93, v56
    v_mov_b32 v94, v56
    v_mov_b32 v95, v56
    ds_read_b128 a[240:243], v28 offset:40960
    v_sub_f32 v129, v129, v53
    v_mfma_f32_32x32x16_bf16 v[176:191], a[224:227], v[224:227], v[80:95]
    ds_read_b128 a[244:247], v29 offset:40960
    v_sub_f32 v130, v130, v53
    v_sub_f32 v131, v131, v53
    v_sub_f32 v132, v132, v53
    ds_read_b128 a[248:251], v30 offset:40960
    v_sub_f32 v133, v133, v53
    v_mfma_f32_32x32x16_bf16 v[160:175], a[228:231], v[196:199], v[160:175]
    ds_read_b128 a[252:255], v31 offset:40960
    v_sub_f32 v134, v134, v53
    v_sub_f32 v135, v135, v53
    v_exp_f32 v128, v128
    ds_read_b64_tr_b16 a[192:193], v32
    v_mfma_f32_32x32x16_bf16 v[176:191], a[228:231], v[228:231], v[176:191]
    ds_read_b64_tr_b16 a[194:195], v32 offset:1024
    v_exp_f32 v129, v129
    ds_read_b64_tr_b16 a[196:197], v33
    v_cvt_pk_bf16_f32 v96, v128, v129
    s_waitcnt lgkmcnt(8)
    v_mfma_f32_32x32x16_bf16 v[160:175], a[232:235], v[200:203], v[160:175]
    ds_read_b64_tr_b16 a[198:199], v33 offset:1024
    v_exp_f32 v130, v130
    v_exp_f32 v131, v131
    ds_read_b64_tr_b16 a[200:201], v34
    v_mfma_f32_32x32x16_bf16 v[176:191], a[232:235], v[232:235], v[176:191]
    v_exp_f32 v132, v132
    v_exp_f32 v133, v133
    ds_read_b64_tr_b16 a[202:203], v34 offset:1024
    s_waitcnt lgkmcnt(10)
    v_mfma_f32_32x32x16_bf16 v[160:175], a[236:239], v[204:207], v[160:175]
    v_exp_f32 v134, v134
    v_exp_f32 v135, v135
    v_cvt_pk_bf16_f32 v97, v130, v131
    v_cvt_pk_bf16_f32 v98, v132, v133
    v_mfma_f32_32x32x16_bf16 v[176:191], a[236:239], v[236:239], v[176:191]
    v_cvt_pk_bf16_f32 v99, v134, v135
    v_sub_f32 v144, v144, v55
    v_sub_f32 v145, v145, v55
    v_sub_f32 v146, v146, v55
    v_sub_f32 v147, v147, v55
    s_waitcnt lgkmcnt(8)
    v_mfma_f32_32x32x16_bf16 v[160:175], a[240:243], v[208:211], v[160:175]
    v_sub_f32 v148, v148, v55
    v_sub_f32 v149, v149, v55
    v_sub_f32 v150, v150, v55
    v_sub_f32 v151, v151, v55
    v_exp_f32 v144, v144
    v_mfma_f32_32x32x16_bf16 v[176:191], a[240:243], v[240:243], v[176:191]
    v_exp_f32 v145, v145
    v_exp_f32 v146, v146
    v_exp_f32 v147, v147
    v_mfma_f32_32x32x16_bf16 v[160:175], a[244:247], v[212:215], v[160:175]
    v_exp_f32 v148, v148
    v_exp_f32 v149, v149
    v_exp_f32 v150, v150
    v_mfma_f32_32x32x16_bf16 v[176:191], a[244:247], v[244:247], v[176:191]
    v_exp_f32 v151, v151
    v_cvt_pk_bf16_f32 v104, v144, v145
    v_cvt_pk_bf16_f32 v105, v146, v147
    v_cvt_pk_bf16_f32 v106, v148, v149
    s_waitcnt lgkmcnt(1)
    v_mfma_f32_32x32x16_bf16 v[160:175], a[248:251], v[216:219], v[160:175]
    v_cvt_pk_bf16_f32 v107, v150, v151
    ds_read_b64_tr_b16 a[204:205], v35
    v_sub_f32 v136, v136, v53
    ds_read_b64_tr_b16 a[206:207], v35 offset:1024
    v_sub_f32 v137, v137, v53
    ds_read_b64_tr_b16 a[208:209], v32 offset:4096
    v_mfma_f32_32x32x16_bf16 v[176:191], a[248:251], v[248:251], v[176:191]
    ds_read_b64_tr_b16 a[210:211], v32 offset:5120
    v_sub_f32 v138, v138, v53
    ds_read_b64_tr_b16 a[212:213], v33 offset:4096
    v_sub_f32 v139, v139, v53
    ds_read_b64_tr_b16 a[214:215], v33 offset:5120
    v_sub_f32 v140, v140, v53
    v_mfma_f32_32x32x16_bf16 v[160:175], a[252:255], v[220:223], v[160:175]
    v_sub_f32 v141, v141, v53
    v_sub_f32 v142, v142, v53
    v_sub_f32 v143, v143, v53
    v_exp_f32 v136, v136
    ds_read_b64_tr_b16 a[216:217], v34 offset:4096
    v_mfma_f32_32x32x16_bf16 v[176:191], a[252:255], v[252:255], v[176:191]
    v_exp_f32 v137, v137
    v_exp_f32 v138, v138
    v_exp_f32 v139, v139
    v_mfma_f32_32x32x16_bf16 a[0:15], a[192:195], v[96:99], 0
    v_exp_f32 v140, v140
    v_exp_f32 v141, v141
    v_exp_f32 v142, v142
    v_mfma_f32_32x32x16_bf16 a[64:79], a[192:195], v[104:107], 0
    v_exp_f32 v143, v143
    ds_read_b64_tr_b16 a[218:219], v34 offset:5120
    v_cvt_pk_bf16_f32 v100, v136, v137
    v_cvt_pk_bf16_f32 v101, v138, v139
    v_cvt_pk_bf16_f32 v102, v140, v141
    v_mfma_f32_32x32x16_bf16 a[16:31], a[196:199], v[96:99], 0
    v_cvt_pk_bf16_f32 v103, v142, v143
    v_sub_f32 v152, v152, v55
    v_sub_f32 v153, v153, v55
    v_sub_f32 v154, v154, v55
    v_sub_f32 v155, v155, v55
    v_sub_f32 v156, v156, v55
    v_mfma_f32_32x32x16_bf16 a[80:95], a[196:199], v[104:107], 0
    v_sub_f32 v157, v157, v55
    v_sub_f32 v158, v158, v55
    v_sub_f32 v159, v159, v55
    v_exp_f32 v152, v152
    s_waitcnt lgkmcnt(3)
    v_mfma_f32_32x32x16_bf16 a[32:47], a[200:203], v[96:99], 0
    v_exp_f32 v153, v153
    v_exp_f32 v154, v154
    v_exp_f32 v155, v155
    v_mfma_f32_32x32x16_bf16 a[96:111], a[200:203], v[104:107], 0
    v_exp_f32 v156, v156
    v_exp_f32 v157, v157
    v_exp_f32 v158, v158
    v_mfma_f32_32x32x16_bf16 a[48:63], a[204:207], v[96:99], 0
    v_exp_f32 v159, v159
    v_cvt_pk_bf16_f32 v108, v152, v153
    v_cvt_pk_bf16_f32 v109, v154, v155
    v_cvt_pk_bf16_f32 v110, v156, v157
    v_cvt_pk_bf16_f32 v111, v158, v159
    v_mfma_f32_32x32x16_bf16 a[112:127], a[204:207], v[104:107], 0
    ds_read_b64_tr_b16 a[220:221], v35 offset:4096
    v_max3_f32 v52, v160, v161, v162
    ds_read_b64_tr_b16 a[222:223], v35 offset:5120
    v_max3_f32 v52, v163, v164, v52
    v_max3_f32 v52, v165, v166, v52
    v_max3_f32 v52, v167, v168, v52
    v_mfma_f32_32x32x16_bf16 a[0:15], a[208:211], v[100:103], a[0:15]
    v_max3_f32 v52, v169, v170, v52
    v_max3_f32 v52, v171, v172, v52
    v_max3_f32 v52, v173, v174, v52
    v_max3_f32 v52, v175, v176, v52
    v_max3_f32 v52, v177, v178, v52
    v_add_f32 v48, v48, v128
    v_mfma_f32_32x32x16_bf16 a[64:79], a[208:211], v[108:111], a[64:79]
    v_add_f32 v49, v49, v129
    v_add_f32 v50, v50, v144
    v_add_f32 v51, v51, v145
    v_max3_f32 v52, v179, v180, v52
    v_add_f32 v48, v48, v130
    s_waitcnt lgkmcnt(2)
    v_mfma_f32_32x32x16_bf16 a[16:31], a[212:215], v[100:103], a[16:31]
    v_add_f32 v49, v49, v131
    v_add_f32 v50, v50, v146
    v_add_f32 v51, v51, v147
    v_max3_f32 v52, v181, v182, v52
    v_add_f32 v48, v48, v132
    v_add_f32 v49, v49, v133
    v_mfma_f32_32x32x16_bf16 a[80:95], a[212:215], v[108:111], a[80:95]
    v_add_f32 v50, v50, v148
    v_add_f32 v51, v51, v149
    v_max3_f32 v52, v183, v184, v52
    v_add_f32 v48, v48, v134
    v_add_f32 v49, v49, v135
    v_add_f32 v50, v50, v150
    v_mfma_f32_32x32x16_bf16 a[32:47], a[216:219], v[100:103], a[32:47]
    v_add_f32 v51, v51, v151
    v_max3_f32 v52, v185, v186, v52
    v_add_f32 v48, v48, v136
    v_add_f32 v49, v49, v137
    v_add_f32 v50, v50, v152
    v_add_f32 v51, v51, v153
    v_mfma_f32_32x32x16_bf16 a[96:111], a[216:219], v[108:111], a[96:111]
    s_waitcnt vmcnt(0)
    s_barrier
    s_waitcnt lgkmcnt(0)
    v_mfma_f32_32x32x16_bf16 a[48:63], a[220:223], v[100:103], a[48:63]
    buffer_store_dword v59, v58, s[4:7], s81 offen sc1
    ds_read_b128 a[224:227], v24
    v_max3_f32 v52, v187, v188, v52
    v_add_f32 v48, v48, v138
    buffer_store_dwordx4 v[2:5], v46, s[4:7], s94 offen sc1
    s_add_u32 s94, s77, 0xb000
    v_mfma_f32_32x32x16_bf16 a[112:127], a[220:223], v[108:111], a[112:127]
    v_cvt_pk_bf16_f32 v2, v18, v19
    v_cvt_pk_bf16_f32 v3, v23, v42
    v_accvgpr_read_b32 v18, a180
    v_accvgpr_read_b32 v19, a181
    v_accvgpr_read_b32 v23, a182
    v_accvgpr_read_b32 v42, a183
    v_mul_f32 v18, v18, v39
    v_mul_f32 v19, v19, v39
    v_mul_f32 v23, v23, v39
    v_mul_f32 v42, v42, v39
    v_cvt_pk_bf16_f32 v4, v18, v19
    v_cvt_pk_bf16_f32 v5, v23, v42
    buffer_store_dwordx4 v[6:9], v46, s[4:7], s95 offen sc1
    v_accvgpr_read_b32 v18, a184
    v_accvgpr_read_b32 v19, a185
    v_accvgpr_read_b32 v23, a186
    v_accvgpr_read_b32 v42, a187
    v_mul_f32 v18, v18, v39
    v_mul_f32 v19, v19, v39
    v_mul_f32 v23, v23, v39
    v_mul_f32 v42, v42, v39
    v_cvt_pk_bf16_f32 v6, v18, v19
    v_cvt_pk_bf16_f32 v7, v23, v42
    v_accvgpr_read_b32 v18, a188
    v_accvgpr_read_b32 v19, a189
    v_accvgpr_read_b32 v23, a190
    v_accvgpr_read_b32 v42, a191
    v_mul_f32 v18, v18, v39
    buffer_store_dwordx4 v[2:5], v46, s[4:7], s94 offen sc1
    v_mul_f32 v19, v19, v39
    v_mul_f32 v23, v23, v39
    v_mul_f32 v42, v42, v39
    v_cvt_pk_bf16_f32 v8, v18, v19
    v_cvt_pk_bf16_f32 v9, v23, v42
    s_add_u32 s95, s77, 0xb400
    s_mul_i32 s94, s65, 0xaaab
    s_lshr_b32 s94, s94, 17
    s_lshl_b32 s81, s94, 7
    v_lshlrev_b32 v39, 1, v40
    ds_read_b128 a[228:231], v25
    v_add_f32 v49, v49, v139
    v_add_f32 v50, v50, v154
    v_add_f32 v51, v51, v155
    v_max3_f32 v52, v189, v190, v52
    buffer_store_dwordx4 v[6:9], v46, s[4:7], s95 offen sc1
    s_mul_i32 s95, s94, 3
    s_sub_u32 s95, s65, s95
    s_lshl_b32 s95, s95, 3
    s_add_u32 s95, s95, s66
    s_lshl_b32 s83, s95, 2
    s_add_u32 s81, s81, s83
    s_add_u32 s81, s81, 0x81000
    s_cmp_lt_u32 s59, 22
    s_cselect_b32 s83, s3, 0x10000000
    s_lshl_b32 s94, s65, 2
    s_lshr_b32 s3, s60, 1
    s_and_b32 s3, s3, 1
    s_lshl_b32 s59, s46, 1
    s_add_u32 s59, s59, s3
    s_mul_i32 s59, s59, 44
    s_lshl_b32 s3, s3, 5
    v_add_f32 v48, v48, v140
    v_add_f32 v49, v49, v141
    v_add_f32 v50, v50, v156
    v_add_f32 v51, v51, v157
    v_max_f32 v52, v191, v52
    ds_read_b128 a[232:235], v26
    v_add_f32 v48, v48, v142
    v_add_f32 v49, v49, v143
    v_add_f32 v50, v50, v158
    v_add_f32 v51, v51, v159
    v_cmp_lt_f32 vcc, v57, v52
    ds_read_b128 a[236:239], v27
    s_cbranch_vccnz L_rare1
L_rare1_ret:
    s_waitcnt lgkmcnt(3)
    v_mfma_f32_32x32x16_bf16 v[128:143], a[224:227], v[192:195], v[64:79]
    ds_read_b128 a[240:243], v28
    v_exp_f32 v160, v160
    v_exp_f32 v161, v161
    ds_read_b128 a[244:247], v29
    v_mfma_f32_32x32x16_bf16 v[144:159], a[224:227], v[224:227], v[80:95]
    v_exp_f32 v162, v162
    ds_read_b128 a[248:251], v30
    v_exp_f32 v163, v163
    s_waitcnt lgkmcnt(5)
    v_mfma_f32_32x32x16_bf16 v[128:143], a[228:231], v[196:199], v[128:143]
    ds_read_b128 a[252:255], v31
    v_exp_f32 v164, v164
    v_exp_f32 v165, v165
    ds_read_b64_tr_b16 a[192:193], v32 offset:24576
    v_mfma_f32_32x32x16_bf16 v[144:159], a[228:231], v[228:231], v[144:159]
    ds_read_b64_tr_b16 a[194:195], v32 offset:25600
    v_exp_f32 v166, v166
    ds_read_b64_tr_b16 a[196:197], v33 offset:24576
    v_cvt_pk_bf16_f32 v96, v160, v161
    s_waitcnt lgkmcnt(8)
    v_mfma_f32_32x32x16_bf16 v[128:143], a[232:235], v[200:203], v[128:143]
    ds_read_b64_tr_b16 a[198:199], v33 offset:25600
    v_exp_f32 v167, v167
    ds_read_b64_tr_b16 a[200:201], v34 offset:24576
    v_cvt_pk_bf16_f32 v97, v162, v163
    ds_read_b64_tr_b16 a[202:203], v34 offset:25600
    v_mfma_f32_32x32x16_bf16 v[144:159], a[232:235], v[232:235], v[144:159]
    v_cvt_pk_bf16_f32 v98, v164, v165
    v_cvt_pk_bf16_f32 v99, v166, v167
    v_exp_f32 v176, v176
    ds_read_b64_tr_b16 a[204:205], v35 offset:24576
    s_waitcnt lgkmcnt(11)
    v_mfma_f32_32x32x16_bf16 v[128:143], a[236:239], v[204:207], v[128:143]
    v_exp_f32 v177, v177
    v_exp_f32 v178, v178
    v_exp_f32 v179, v179
    v_mfma_f32_32x32x16_bf16 v[144:159], a[236:239], v[236:239], v[144:159]
    v_exp_f32 v180, v180
    v_exp_f32 v181, v181
    v_cvt_pk_bf16_f32 v104, v176, v177
    s_waitcnt lgkmcnt(8)
    v_mfma_f32_32x32x16_bf16 v[128:143], a[240:243], v[208:211], v[128:143]
    v_exp_f32 v182, v182
    v_exp_f32 v183, v183
    v_cvt_pk_bf16_f32 v105, v178, v179
    v_cvt_pk_bf16_f32 v106, v180, v181
    v_mfma_f32_32x32x16_bf16 v[144:159], a[240:243], v[240:243], v[144:159]
    v_cvt_pk_bf16_f32 v107, v182, v183
    ds_read_b64_tr_b16 a[206:207], v35 offset:25600
    v_exp_f32 v168, v168
    ds_read_b64_tr_b16 a[208:209], v32 offset:28672
    v_add_f32 v48, v48, v160
    v_mfma_f32_32x32x16_bf16 v[128:143], a[244:247], v[212:215], v[128:143]
    ds_read_b64_tr_b16 a[210:211], v32 offset:29696
    v_exp_f32 v169, v169
    ds_read_b64_tr_b16 a[212:213], v33 offset:28672
    v_exp_f32 v170, v170
    v_mfma_f32_32x32x16_bf16 v[144:159], a[244:247], v[244:247], v[144:159]
    ds_read_b64_tr_b16 a[214:215], v33 offset:29696
    v_exp_f32 v171, v171
    v_exp_f32 v172, v172
    ds_read_b64_tr_b16 a[216:217], v34 offset:28672
    v_mfma_f32_32x32x16_bf16 v[128:143], a[248:251], v[216:219], v[128:143]
    v_exp_f32 v173, v173
    v_exp_f32 v174, v174
    v_exp_f32 v175, v175
    v_mfma_f32_32x32x16_bf16 v[144:159], a[248:251], v[248:251], v[144:159]
    ds_read_b64_tr_b16 a[218:219], v34 offset:29696
    v_cvt_pk_bf16_f32 v100, v168, v169
    v_cvt_pk_bf16_f32 v101, v170, v171
    v_cvt_pk_bf16_f32 v102, v172, v173
    v_cvt_pk_bf16_f32 v103, v174, v175
    s_waitcnt lgkmcnt(7)
    v_mfma_f32_32x32x16_bf16 v[128:143], a[252:255], v[220:223], v[128:143]
    v_exp_f32 v184, v184
    v_exp_f32 v185, v185
    v_exp_f32 v186, v186
    v_mfma_f32_32x32x16_bf16 v[144:159], a[252:255], v[252:255], v[144:159]
    v_exp_f32 v187, v187
    v_exp_f32 v188, v188
    v_exp_f32 v189, v189
    v_mfma_f32_32x32x16_bf16 a[0:15], a[192:195], v[96:99], a[0:15]
    v_exp_f32 v190, v190
    v_exp_f32 v191, v191
    v_cvt_pk_bf16_f32 v108, v184, v185
    v_cvt_pk_bf16_f32 v109, v186, v187
    v_mfma_f32_32x32x16_bf16 a[64:79], a[192:195], v[104:107], a[64:79]
    v_cvt_pk_bf16_f32 v110, v188, v189
    v_cvt_pk_bf16_f32 v111, v190, v191
    ds_read_b64_tr_b16 a[220:221], v35 offset:28672
    v_max3_f32 v52, v128, v129, v130
    ds_read_b64_tr_b16 a[222:223], v35 offset:29696
    v_max3_f32 v52, v131, v132, v52
    v_mfma_f32_32x32x16_bf16 a[16:31], a[196:199], v[96:99], a[16:31]
    s_barrier
    ds_read_b128 a[224:227], v24 offset:24576
    v_max3_f32 v52, v133, v134, v52
    v_mfma_f32_32x32x16_bf16 a[80:95], a[196:199], v[104:107], a[80:95]
    ds_read_b128 a[228:231], v25 offset:24576
    v_max3_f32 v52, v135, v136, v52
    v_max3_f32 v52, v137, v138, v52
    v_max3_f32 v52, v139, v140, v52
    v_max3_f32 v52, v141, v142, v52
    v_max3_f32 v52, v143, v144, v52
    v_mfma_f32_32x32x16_bf16 a[32:47], a[200:203], v[96:99], a[32:47]
    v_max3_f32 v52, v145, v146, v52
    v_add_f32 v49, v49, v161
    v_add_f32 v50, v50, v176
    v_add_f32 v51, v51, v177
    v_max3_f32 v52, v147, v148, v52
    v_add_f32 v48, v48, v162
    v_mfma_f32_32x32x16_bf16 a[96:111], a[200:203], v[104:107], a[96:111]
    v_add_f32 v49, v49, v163
    v_add_f32 v50, v50, v178
    v_add_f32 v51, v51, v179
    v_max3_f32 v52, v149, v150, v52
    v_add_f32 v48, v48, v164
    s_waitcnt lgkmcnt(4)
    v_mfma_f32_32x32x16_bf16 a[48:63], a[204:207], v[96:99], a[48:63]
    v_add_f32 v49, v49, v165
    v_add_f32 v50, v50, v180
    v_add_f32 v51, v51, v181
    v_max3_f32 v52, v151, v152, v52
    v_add_f32 v48, v48, v166
    v_add_f32 v49, v49, v167
    v_mfma_f32_32x32x16_bf16 a[112:127], a[204:207], v[104:107], a[112:127]
    v_add_f32 v50, v50, v182
    v_add_f32 v51, v51, v183
    v_max3_f32 v52, v153, v154, v52
    v_add_f32 v48, v48, v168
    v_add_f32 v49, v49, v169
    v_add_f32 v50, v50, v184
    v_mfma_f32_32x32x16_bf16 a[0:15], a[208:211], v[100:103], a[0:15]
    v_add_f32 v51, v51, v185
    v_max3_f32 v52, v155, v156, v52
    v_add_f32 v48, v48, v170
    v_add_f32 v49, v49, v171
    v_add_f32 v50, v50, v186
    v_add_f32 v51, v51, v187
    v_mfma_f32_32x32x16_bf16 a[64:79], a[208:211], v[108:111], a[64:79]
    v_max3_f32 v52, v157, v158, v52
    v_add_f32 v48, v48, v172
    v_add_f32 v49, v49, v173
    v_add_f32 v50, v50, v188
    v_add_f32 v51, v51, v189
    v_max_f32 v52, v159, v52
    v_mfma_f32_32x32x16_bf16 a[16:31], a[212:215], v[100:103], a[16:31]
    ds_read_b128 a[232:235], v26 offset:24576
    v_add_f32 v48, v48, v174
    v_add_f32 v49, v49, v175
    v_add_f32 v50, v50, v190
    v_add_f32 v51, v51, v191
    v_cmp_lt_f32 vcc, v57, v52
    v_mfma_f32_32x32x16_bf16 a[80:95], a[212:215], v[108:111], a[80:95]
    ds_read_b128 a[236:239], v27 offset:24576
    s_nop 0
    v_bfe_u32 v2, v0, 2, 2
    v_lshl_add_u32 v3, v41, 3, v2
    ds_read_b128 a[240:243], v28 offset:24576
    v_lshlrev_b32 v3, 6, v3
    v_mfma_f32_32x32x16_bf16 a[32:47], a[216:219], v[100:103], a[32:47]
    ds_read_b128 a[244:247], v29 offset:24576
    v_and_b32 v4, 63, v32
    v_lshlrev_b32 v5, 6, v2
    v_add_u32 v3, v3, v4
    ds_read_b128 a[248:251], v30 offset:24576
    v_and_b32 v5, 63, v5
    v_mfma_f32_32x32x16_bf16 a[96:111], a[216:219], v[108:111], a[96:111]
    ds_read_b128 a[252:255], v31 offset:24576
    v_add_u32 v23, s69, v3
    v_lshlrev_b32 v2, 16, v112
    v_and_b32 v3, 0xffff0000, v112
    ds_read_b64_tr_b16 a[192:193], v32 offset:49152
    s_waitcnt lgkmcnt(7)
    v_mfma_f32_32x32x16_bf16 a[48:63], a[220:223], v[100:103], a[48:63]
    ds_read_b64_tr_b16 a[194:195], v32 offset:50176
    v_lshlrev_b32 v4, 16, v113
    ds_read_b64_tr_b16 a[196:197], v33 offset:49152
    v_and_b32 v5, 0xffff0000, v113
    ds_read_b64_tr_b16 a[198:199], v33 offset:50176
    v_lshlrev_b32 v6, 16, v114
    v_mfma_f32_32x32x16_bf16 a[112:127], a[220:223], v[108:111], a[112:127]
    s_cbranch_vccnz L_rare2
L_rare2_ret:
    v_exp_f32 v128, v128
    v_exp_f32 v129, v129
    ds_read_b64_tr_b16 a[200:201], v34 offset:49152
    v_mfma_f32_32x32x16_bf16 v[160:175], a[224:227], v[192:195], v[64:79]
    v_exp_f32 v130, v130
    v_exp_f32 v131, v131
    v_exp_f32 v132, v132
    v_mfma_f32_32x32x16_bf16 v[176:191], a[224:227], v[224:227], v[80:95]
    v_exp_f32 v133, v133
    v_exp_f32 v134, v134
    v_exp_f32 v135, v135
    v_mfma_f32_32x32x16_bf16 v[160:175], a[228:231], v[196:199], v[160:175]
    ds_read_b64_tr_b16 a[202:203], v34 offset:50176
    v_cvt_pk_bf16_f32 v96, v128, v129
    v_cvt_pk_bf16_f32 v97, v130, v131
    v_cvt_pk_bf16_f32 v98, v132, v133
    v_cvt_pk_bf16_f32 v99, v134, v135
    ds_read_b64_tr_b16 a[204:205], v35 offset:49152
    v_mfma_f32_32x32x16_bf16 v[176:191], a[228:231], v[228:231], v[176:191]
    v_exp_f32 v144, v144
    v_exp_f32 v145, v145
    ds_read_b64_tr_b16 a[206:207], v35 offset:50176
    s_waitcnt lgkmcnt(8)
    v_mfma_f32_32x32x16_bf16 v[160:175], a[232:235], v[200:203], v[160:175]
    v_exp_f32 v146, v146
    v_exp_f32 v147, v147
    v_exp_f32 v148, v148
    v_mfma_f32_32x32x16_bf16 v[176:191], a[232:235], v[232:235], v[176:191]
    v_exp_f32 v149, v149
    v_exp_f32 v150, v150
    v_exp_f32 v151, v151
    v_mfma_f32_32x32x16_bf16 v[160:175], a[236:239], v[204:207], v[160:175]
    v_cvt_pk_bf16_f32 v104, v144, v145
    v_cvt_pk_bf16_f32 v105, v146, v147
    v_cvt_pk_bf16_f32 v106, v148, v149
    v_cvt_pk_bf16_f32 v107, v150, v151
    ds_read_b64_tr_b16 a[208:209], v32 offset:53248
    v_add_f32 v48, v48, v128
    v_mfma_f32_32x32x16_bf16 v[176:191], a[236:239], v[236:239], v[176:191]
    ds_read_b64_tr_b16 a[210:211], v32 offset:54272
    v_exp_f32 v136, v136
    ds_read_b64_tr_b16 a[212:213], v33 offset:53248
    v_exp_f32 v137, v137
    v_mfma_f32_32x32x16_bf16 v[160:175], a[240:243], v[208:211], v[160:175]
    ds_read_b64_tr_b16 a[214:215], v33 offset:54272
    v_exp_f32 v138, v138
    ds_read_b64_tr_b16 a[216:217], v34 offset:53248
    v_exp_f32 v139, v139
    v_mfma_f32_32x32x16_bf16 v[176:191], a[240:243], v[240:243], v[176:191]
    ds_read_b64_tr_b16 a[218:219], v34 offset:54272
    v_exp_f32 v140, v140
    ds_read_b64_tr_b16 a[220:221], v35 offset:53248
    v_exp_f32 v141, v141
    v_mfma_f32_32x32x16_bf16 v[160:175], a[244:247], v[212:215], v[160:175]
    ds_read_b64_tr_b16 a[222:223], v35 offset:54272
    v_exp_f32 v142, v142
    v_exp_f32 v143, v143
    v_cvt_pk_bf16_f32 v100, v136, v137
    v_mfma_f32_32x32x16_bf16 v[176:191], a[244:247], v[244:247], v[176:191]
    v_cvt_pk_bf16_f32 v101, v138, v139
    v_cvt_pk_bf16_f32 v102, v140, v141
    v_cvt_pk_bf16_f32 v103, v142, v143
    v_exp_f32 v152, v152
    v_add_f32 v49, v49, v129
    v_mfma_f32_32x32x16_bf16 v[160:175], a[248:251], v[216:219], v[160:175]
    s_barrier
    buffer_load_dwordx4 v20, s[24:27], s86 offen lds
    ds_read_b128 a[224:227], v24 offset:49152
    v_mfma_f32_32x32x16_bf16 v[176:191], a[248:251], v[248:251], v[176:191]
    v_exp_f32 v153, v153
    v_exp_f32 v154, v154
    v_exp_f32 v155, v155
    v_mfma_f32_32x32x16_bf16 v[160:175], a[252:255], v[220:223], v[160:175]
    v_exp_f32 v156, v156
    v_exp_f32 v157, v157
    buffer_load_dwordx4 v21, s[24:27], s86 offen offset:1024 lds
    s_add_u32 m0, s76, 0x10000
    v_mfma_f32_32x32x16_bf16 v[176:191], a[252:255], v[252:255], v[176:191]
    s_mov_b32 s86, 0x12000
    v_exp_f32 v158, v158
    v_exp_f32 v159, v159
    s_waitcnt lgkmcnt(2)
    v_mfma_f32_32x32x16_bf16 a[0:15], a[192:195], v[96:99], a[0:15]
    s_waitcnt lgkmcnt(1)
    s_barrier
    buffer_load_dword v1, v60, s[4:7], s82 offen sc1
    v_mfma_f32_32x32x16_bf16 a[64:79], a[192:195], v[104:107], a[64:79]
    v_cvt_pk_bf16_f32 v108, v152, v153
    buffer_load_dwordx4 v22, s[28:31], s87 offen lds
    v_cvt_pk_bf16_f32 v109, v154, v155
    v_cvt_pk_bf16_f32 v110, v156, v157
    v_cvt_pk_bf16_f32 v111, v158, v159
    ds_read_b128 a[228:231], v25 offset:49152
    v_mfma_f32_32x32x16_bf16 a[16:31], a[196:199], v[96:99], a[16:31]
    v_max3_f32 v52, v160, v161, v162
    v_max3_f32 v52, v163, v164, v52
    v_max3_f32 v52, v165, v166, v52
    v_max3_f32 v52, v167, v168, v52
    v_max3_f32 v52, v169, v170, v52
    v_max3_f32 v52, v171, v172, v52
    v_mfma_f32_32x32x16_bf16 a[80:95], a[196:199], v[104:107], a[80:95]
    v_max3_f32 v52, v173, v174, v52
    buffer_load_dwordx4 v22, s[28:31], s87 offen offset:1024 lds
    s_add_u32 m0, s76, 0x6000
    s_mov_b32 s87, 0x12000
    v_max3_f32 v52, v175, v176, v52
    v_max3_f32 v52, v177, v178, v52
    v_mfma_f32_32x32x16_bf16 a[32:47], a[200:203], v[96:99], a[32:47]
    v_add_f32 v50, v50, v144
    v_add_f32 v51, v51, v145
    v_max3_f32 v52, v179, v180, v52
    v_add_f32 v48, v48, v130
    v_add_f32 v49, v49, v131
    v_add_f32 v50, v50, v146
    v_mfma_f32_32x32x16_bf16 a[96:111], a[200:203], v[104:107], a[96:111]
    v_add_f32 v51, v51, v147
    buffer_load_dwordx4 v20, s[24:27], s86 offen lds
    v_max3_f32 v52, v181, v182, v52
    v_add_f32 v48, v48, v132
    v_add_f32 v49, v49, v133
    v_add_f32 v50, v50, v148
    v_mfma_f32_32x32x16_bf16 a[48:63], a[204:207], v[96:99], a[48:63]
    v_add_f32 v51, v51, v149
    v_max3_f32 v52, v183, v184, v52
    v_add_f32 v48, v48, v134
    v_add_f32 v49, v49, v135
    v_add_f32 v50, v50, v150
    v_add_f32 v51, v51, v151
    v_mfma_f32_32x32x16_bf16 a[112:127], a[204:207], v[104:107], a[112:127]
    v_max3_f32 v52, v185, v186, v52
    buffer_load_dwordx4 v21, s[24:27], s86 offen offset:1024 lds
    s_add_u32 m0, s76, 0x16000
    s_mov_b32 s86, 0x14000
    v_add_f32 v48, v48, v136
    v_add_f32 v49, v49, v137
    v_mfma_f32_32x32x16_bf16 a[0:15], a[208:211], v[100:103], a[0:15]
    v_add_f32 v50, v50, v152
    v_add_f32 v51, v51, v153
    v_max3_f32 v52, v187, v188, v52
    v_add_f32 v48, v48, v138
    v_add_f32 v49, v49, v139
    v_add_f32 v50, v50, v154
    v_mfma_f32_32x32x16_bf16 a[64:79], a[208:211], v[108:111], a[64:79]
    v_add_f32 v51, v51, v155
    buffer_load_dwordx4 v22, s[28:31], s87 offen lds
    v_max3_f32 v52, v189, v190, v52
    v_add_f32 v48, v48, v140
    v_add_f32 v49, v49, v141
    v_add_f32 v50, v50, v156
    v_mfma_f32_32x32x16_bf16 a[16:31], a[212:215], v[100:103], a[16:31]
    v_add_f32 v51, v51, v157
    v_max_f32 v52, v191, v52
    ds_read_b128 a[232:235], v26 offset:49152
    v_add_f32 v48, v48, v142
    v_add_f32 v49, v49, v143
    v_add_f32 v50, v50, v158
    v_mfma_f32_32x32x16_bf16 a[80:95], a[212:215], v[108:111], a[80:95]
    v_add_f32 v51, v51, v159
    buffer_load_dwordx4 v22, s[28:31], s87 offen offset:1024 lds
    s_add_u32 m0, s76, 0xc000
    s_mov_b32 s87, 0x14000
    v_cmp_lt_f32 vcc, v57, v52
    ds_read_b128 a[236:239], v27 offset:49152
    v_mfma_f32_32x32x16_bf16 a[32:47], a[216:219], v[100:103], a[32:47]
    v_and_b32 v7, 0xffff0000, v114
    ds_read_b128 a[240:243], v28 offset:49152
    v_lshlrev_b32 v8, 16, v115
    v_and_b32 v9, 0xffff0000, v115
    v_lshlrev_b32 v19, 6, v40
    ds_read_b128 a[244:247], v29 offset:49152
    v_mfma_f32_32x32x16_bf16 a[96:111], a[216:219], v[108:111], a[96:111]
    v_lshl_add_u32 v19, v41, 4, v19
    ds_read_b128 a[248:251], v30 offset:49152
    v_add_u32 v19, s69, v19
    s_lshl_b32 s69, s62, 4
    s_add_u32 s88, s70, 0
    ds_read_b128 a[252:255], v31 offset:49152
    v_mfma_f32_32x32x16_bf16 a[48:63], a[220:223], v[100:103], a[48:63]
    s_add_u32 s89, s70, 0x400
    ds_read_b64_tr_b16 a[192:193], v32 offset:57344
    buffer_load_dwordx4 a[172:175], v46, s[32:35], s73 offen
    ds_read_b64_tr_b16 a[194:195], v32 offset:58368
    ds_read_b64_tr_b16 a[196:197], v33 offset:57344
    v_mfma_f32_32x32x16_bf16 a[112:127], a[220:223], v[108:111], a[112:127]
    s_cbranch_vccnz L_rare3
L_rare3_ret:
    ds_read_b64_tr_b16 a[198:199], v33 offset:58368
    v_exp_f32 v160, v160
    ds_read_b64_tr_b16 a[200:201], v34 offset:57344
    s_waitcnt lgkmcnt(11)
    v_mfma_f32_32x32x16_bf16 v[128:143], a[224:227], v[192:195], v[64:79]
    v_exp_f32 v161, v161
    v_exp_f32 v162, v162
    v_exp_f32 v163, v163
    v_mfma_f32_32x32x16_bf16 v[144:159], a[224:227], v[224:227], v[80:95]
    v_exp_f32 v164, v164
    v_exp_f32 v165, v165
    v_exp_f32 v166, v166
    v_mfma_f32_32x32x16_bf16 v[128:143], a[228:231], v[196:199], v[128:143]
    v_exp_f32 v167, v167
    ds_read_b64_tr_b16 a[202:203], v34 offset:58368
    v_cvt_pk_bf16_f32 v96, v160, v161
    v_cvt_pk_bf16_f32 v97, v162, v163
    v_cvt_pk_bf16_f32 v98, v164, v165
    v_mfma_f32_32x32x16_bf16 v[144:159], a[228:231], v[228:231], v[144:159]
    v_cvt_pk_bf16_f32 v99, v166, v167
    v_exp_f32 v176, v176
    v_exp_f32 v177, v177
    s_waitcnt lgkmcnt(7)
    v_mfma_f32_32x32x16_bf16 v[128:143], a[232:235], v[200:203], v[128:143]
    v_exp_f32 v178, v178
    v_exp_f32 v179, v179
    v_exp_f32 v180, v180
    v_mfma_f32_32x32x16_bf16 v[144:159], a[232:235], v[232:235], v[144:159]
    v_exp_f32 v181, v181
    v_exp_f32 v182, v182
    v_exp_f32 v183, v183
    v_mfma_f32_32x32x16_bf16 v[128:143], a[236:239], v[204:207], v[128:143]
    v_cvt_pk_bf16_f32 v104, v176, v177
    v_cvt_pk_bf16_f32 v105, v178, v179
    v_cvt_pk_bf16_f32 v106, v180, v181
    v_cvt_pk_bf16_f32 v107, v182, v183
    ds_read_b64_tr_b16 a[204:205], v35 offset:57344
    v_add_f32 v48, v48, v160
    v_mfma_f32_32x32x16_bf16 v[144:159], a[236:239], v[236:239], v[144:159]
    ds_read_b64_tr_b16 a[206:207], v35 offset:58368
    v_exp_f32 v168, v168
    ds_read_b64_tr_b16 a[208:209], v32 offset:61440
    v_exp_f32 v169, v169
    v_mfma_f32_32x32x16_bf16 v[128:143], a[240:243], v[208:211], v[128:143]
    ds_read_b64_tr_b16 a[210:211], v32 offset:62464
    v_exp_f32 v170, v170
    ds_read_b64_tr_b16 a[212:213], v33 offset:61440
    v_exp_f32 v171, v171
    v_mfma_f32_32x32x16_bf16 v[144:159], a[240:243], v[240:243], v[144:159]
    ds_read_b64_tr_b16 a[214:215], v33 offset:62464
    v_exp_f32 v172, v172
    v_exp_f32 v173, v173
    ds_read_b64_tr_b16 a[216:217], v34 offset:61440
    v_mfma_f32_32x32x16_bf16 v[128:143], a[244:247], v[212:215], v[128:143]
    v_exp_f32 v174, v174
    v_exp_f32 v175, v175
    ds_read_b64_tr_b16 a[218:219], v34 offset:62464
    v_cvt_pk_bf16_f32 v100, v168, v169
    v_mfma_f32_32x32x16_bf16 v[144:159], a[244:247], v[244:247], v[144:159]
    v_cvt_pk_bf16_f32 v101, v170, v171
    v_cvt_pk_bf16_f32 v102, v172, v173
    v_cvt_pk_bf16_f32 v103, v174, v175
    v_exp_f32 v184, v184
    ds_read_b64_tr_b16 a[220:221], v35 offset:61440
    v_mfma_f32_32x32x16_bf16 v[128:143], a[248:251], v[216:219], v[128:143]
    v_exp_f32 v185, v185
    v_exp_f32 v186, v186
    v_exp_f32 v187, v187
    v_mfma_f32_32x32x16_bf16 v[144:159], a[248:251], v[248:251], v[144:159]
    v_exp_f32 v188, v188
    v_exp_f32 v189, v189
    v_cvt_pk_bf16_f32 v108, v184, v185
    s_waitcnt lgkmcnt(6)
    v_mfma_f32_32x32x16_bf16 v[128:143], a[252:255], v[220:223], v[128:143]
    v_exp_f32 v190, v190
    v_exp_f32 v191, v191
    v_cvt_pk_bf16_f32 v109, v186, v187
    v_cvt_pk_bf16_f32 v110, v188, v189
    v_mfma_f32_32x32x16_bf16 v[144:159], a[252:255], v[252:255], v[144:159]
    v_cvt_pk_bf16_f32 v111, v190, v191
    ds_read_b64_tr_b16 a[222:223], v35 offset:62464
    v_add_f32 v49, v49, v161
    ds_read_b128 a[224:227], v24 offset:8192
    v_add_f32 v50, v50, v176
    v_add_f32 v51, v51, v177
    v_mfma_f32_32x32x16_bf16 a[0:15], a[192:195], v[96:99], a[0:15]
    ds_read_b128 a[228:231], v25 offset:8192
    v_max3_f32 v52, v128, v129, v130
    v_max3_f32 v52, v131, v132, v52
    v_max3_f32 v52, v133, v134, v52
    v_max3_f32 v52, v135, v136, v52
    v_max3_f32 v52, v137, v138, v52
    v_mfma_f32_32x32x16_bf16 a[64:79], a[192:195], v[104:107], a[64:79]
    v_max3_f32 v52, v139, v140, v52
    v_max3_f32 v52, v141, v142, v52
    v_max3_f32 v52, v143, v144, v52
    v_max3_f32 v52, v145, v146, v52
    v_max3_f32 v52, v147, v148, v52
    v_add_f32 v48, v48, v162
    v_mfma_f32_32x32x16_bf16 a[16:31], a[196:199], v[96:99], a[16:31]
    v_add_f32 v49, v49, v163
    v_add_f32 v50, v50, v178
    v_add_f32 v51, v51, v179
    v_max3_f32 v52, v149, v150, v52
    v_add_f32 v48, v48, v164
    v_add_f32 v49, v49, v165
    v_mfma_f32_32x32x16_bf16 a[80:95], a[196:199], v[104:107], a[80:95]
    v_add_f32 v50, v50, v180
    v_add_f32 v51, v51, v181
    v_max3_f32 v52, v151, v152, v52
    v_add_f32 v48, v48, v166
    v_add_f32 v49, v49, v167
    v_add_f32 v50, v50, v182
    v_mfma_f32_32x32x16_bf16 a[32:47], a[200:203], v[96:99], a[32:47]
    v_add_f32 v51, v51, v183
    v_max3_f32 v52, v153, v154, v52
    v_add_f32 v48, v48, v168
    v_add_f32 v49, v49, v169
    v_add_f32 v50, v50, v184
    v_add_f32 v51, v51, v185
    v_mfma_f32_32x32x16_bf16 a[96:111], a[200:203], v[104:107], a[96:111]
    v_max3_f32 v52, v155, v156, v52
    v_add_f32 v48, v48, v170
    v_add_f32 v49, v49, v171
    v_add_f32 v50, v50, v186
    v_add_f32 v51, v51, v187
    v_max3_f32 v52, v157, v158, v52
    v_mfma_f32_32x32x16_bf16 a[48:63], a[204:207], v[96:99], a[48:63]
    v_add_f32 v48, v48, v172
    v_add_f32 v49, v49, v173
    v_add_f32 v50, v50, v188
    v_add_f32 v51, v51, v189
    v_max_f32 v52, v159, v52
    ds_read_b128 a[232:235], v26 offset:8192
    v_mfma_f32_32x32x16_bf16 a[112:127], a[204:207], v[104:107], a[112:127]
    v_add_f32 v48, v48, v174
    v_add_f32 v49, v49, v175
    v_add_f32 v50, v50, v190
    v_add_f32 v51, v51, v191
    v_cmp_lt_f32 vcc, v57, v52
    s_waitcnt lgkmcnt(1)
    v_mfma_f32_32x32x16_bf16 a[0:15], a[208:211], v[100:103], a[0:15]
    ds_read_b128 a[236:239], v27 offset:8192
    buffer_load_dwordx4 a[172:175], v46, s[32:35], s73 offen offset:1024
    ds_read_b128 a[240:243], v28 offset:8192
    v_mfma_f32_32x32x16_bf16 a[64:79], a[208:211], v[108:111], a[64:79]
    ds_read_b128 a[244:247], v29 offset:8192
    ds_read_b128 a[248:251], v30 offset:8192
    v_mfma_f32_32x32x16_bf16 a[16:31], a[212:215], v[100:103], a[16:31]
    ds_read_b128 a[252:255], v31 offset:8192
    buffer_load_dwordx4 a[172:175], v46, s[32:35], s73 offen offset:2048
    ds_read_b64_tr_b16 a[192:193], v32 offset:8192
    v_mfma_f32_32x32x16_bf16 a[80:95], a[212:215], v[108:111], a[80:95]
    ds_read_b64_tr_b16 a[194:195], v32 offset:9216
    ds_read_b64_tr_b16 a[196:197], v33 offset:8192
    ds_read_b64_tr_b16 a[198:199], v33 offset:9216
    v_mfma_f32_32x32x16_bf16 a[32:47], a[216:219], v[100:103], a[32:47]
    ds_read_b64_tr_b16 a[200:201], v34 offset:8192
    buffer_load_dwordx4 a[172:175], v46, s[32:35], s73 offen offset:3072
    ds_read_b64_tr_b16 a[202:203], v34 offset:9216
    s_lshl_b32 s73, s64, 2
    ds_read_b64_tr_b16 a[204:205], v35 offset:8192
    s_add_u32 s73, s73, s62
    v_mfma_f32_32x32x16_bf16 a[96:111], a[216:219], v[108:111], a[96:111]
    ds_read_b64_tr_b16 a[206:207], v35 offset:9216
    s_lshl_b32 s73, s73, 13
    ds_read_b64_tr_b16 a[208:209], v32 offset:12288
    s_add_u32 s73, s73, s61
    s_mov_b32 s61, 0x20000
    ds_read_b64_tr_b16 a[210:211], v32 offset:13312
    v_mfma_f32_32x32x16_bf16 a[48:63], a[220:223], v[100:103], a[48:63]
    ds_read_b64_tr_b16 a[212:213], v33 offset:12288
    s_mov_b32 s32, s50
    ds_read_b64_tr_b16 a[214:215], v33 offset:13312
    s_and_b32 s33, s51, 0xffff
    ds_read_b64_tr_b16 a[216:217], v34 offset:12288
    s_mov_b32 s34, 0x800000
    v_mfma_f32_32x32x16_bf16 a[112:127], a[220:223], v[108:111], a[112:127]
    s_cbranch_vccnz L_rare4
L_rare4_ret:
    ds_read_b64_tr_b16 a[218:219], v34 offset:13312
    v_exp_f32 v128, v128
    ds_read_b64_tr_b16 a[220:221], v35 offset:12288
    v_add_f32 v48, v48, v128
    v_mfma_f32_32x32x16_bf16 v[160:175], a[224:227], v[192:195], v[64:79]
    ds_read_b64_tr_b16 a[222:223], v35 offset:13312
    s_waitcnt vmcnt(10)
    v_cmp_ne_u32 vcc, v59, v1
    v_exp_f32 v129, v129
    s_cbranch_vccnz L_slow_z2s
L_ret_z2s:
    v_mfma_f32_32x32x16_bf16 v[176:191], a[224:227], v[224:227], v[80:95]
    s_mov_b32 s82, 0xc00
    v_exp_f32 v130, v130
    v_exp_f32 v131, v131
    v_cvt_pk_bf16_f32 v96, v128, v129
    v_mfma_f32_32x32x16_bf16 v[160:175], a[228:231], v[196:199], v[160:175]
    s_barrier
    buffer_load_dwordx4 v20, s[24:27], s86 offen lds
    v_cvt_pk_bf16_f32 v97, v130, v131
    v_mfma_f32_32x32x16_bf16 v[176:191], a[228:231], v[228:231], v[176:191]
    v_exp_f32 v132, v132
    v_exp_f32 v133, v133
    ds_read_b128 a[224:227], v24 offset:32768
    s_waitcnt lgkmcnt(8)
    v_mfma_f32_32x32x16_bf16 v[160:175], a[232:235], v[200:203], v[160:175]
    v_exp_f32 v134, v134
    v_exp_f32 v135, v135
    buffer_load_dwordx4 v21, s[24:27], s86 offen offset:1024 lds
    s_add_u32 m0, s76, 0x1c000
    v_mfma_f32_32x32x16_bf16 v[176:191], a[232:235], v[232:235], v[176:191]
    s_mov_b32 s86, 0x16000
    v_cvt_pk_bf16_f32 v98, v132, v133
    v_cvt_pk_bf16_f32 v99, v134, v135
    v_exp_f32 v144, v144
    ds_read_b128 a[228:231], v25 offset:32768
    v_mfma_f32_32x32x16_bf16 v[160:175], a[236:239], v[204:207], v[160:175]
    s_waitcnt lgkmcnt(2)
    s_barrier
    buffer_load_dwordx2 v[10:11], v47, s[4:7], s68 offen sc1
    v_mfma_f32_32x32x16_bf16 v[176:191], a[236:239], v[236:239], v[176:191]
    v_exp_f32 v145, v145
    v_exp_f32 v146, v146
    v_exp_f32 v147, v147
    v_mfma_f32_32x32x16_bf16 v[160:175], a[240:243], v[208:211], v[160:175]
    buffer_load_dwordx2 v[14:15], v47, s[4:7], s68 offen offset:256 sc1
    s_lshl_b32 s68, s65, 13
    s_add_u32 s67, s67, s68
    s_add_u32 s93, s67, 0x1000000
    s_and_b32 s67, s63, 1
    s_lshl_b32 s67, s67, 3
    v_mfma_f32_32x32x16_bf16 v[176:191], a[240:243], v[240:243], v[176:191]
    buffer_load_dwordx4 v22, s[28:31], s87 offen lds
    s_lshr_b32 s68, s64, 2
    s_add_u32 s77, s67, s68
    s_lshl_b32 s68, s78, 8
    v_exp_f32 v148, v148
    v_mfma_f32_32x32x16_bf16 v[160:175], a[244:247], v[212:215], v[160:175]
    v_exp_f32 v149, v149
    v_exp_f32 v150, v150
    v_exp_f32 v151, v151
    v_mfma_f32_32x32x16_bf16 v[176:191], a[244:247], v[244:247], v[176:191]
    buffer_load_dwordx4 v22, s[28:31], s87 offen offset:1024 lds
    s_add_u32 m0, s76, 0x2000
    s_mov_b32 s87, 0x16000
    v_cvt_pk_bf16_f32 v104, v144, v145
    v_cvt_pk_bf16_f32 v105, v146, v147
    v_cvt_pk_bf16_f32 v106, v148, v149
    v_mfma_f32_32x32x16_bf16 v[160:175], a[248:251], v[216:219], v[160:175]
    v_cvt_pk_bf16_f32 v107, v150, v151
    v_exp_f32 v136, v136
    v_exp_f32 v137, v137
    v_add_f32 v49, v49, v129
    v_mfma_f32_32x32x16_bf16 v[176:191], a[248:251], v[248:251], v[176:191]
    buffer_load_dwordx4 v20, s[24:27], s86 offen lds
    v_exp_f32 v138, v138
    v_exp_f32 v139, v139
    v_cvt_pk_bf16_f32 v100, v136, v137
    v_mfma_f32_32x32x16_bf16 v[160:175], a[252:255], v[220:223], v[160:175]
    v_exp_f32 v140, v140
    v_exp_f32 v141, v141
    v_exp_f32 v142, v142
    v_mfma_f32_32x32x16_bf16 v[176:191], a[252:255], v[252:255], v[176:191]
    buffer_load_dwordx4 v21, s[24:27], s86 offen offset:1024 lds
    s_add_u32 m0, s76, 0x1e000
    s_mov_b32 s86, 0x18000
    v_exp_f32 v143, v143
    v_cvt_pk_bf16_f32 v101, v138, v139
    v_mfma_f32_32x32x16_bf16 a[0:15], a[192:195], v[96:99], a[0:15]
    v_cvt_pk_bf16_f32 v102, v140, v141
    v_cvt_pk_bf16_f32 v103, v142, v143
    v_exp_f32 v152, v152
    v_exp_f32 v153, v153
    v_mfma_f32_32x32x16_bf16 a[64:79], a[192:195], v[104:107], a[64:79]
    buffer_load_dwordx4 v22, s[28:31], s87 offen lds
    v_exp_f32 v154, v154
    v_exp_f32 v155, v155
    v_cvt_pk_bf16_f32 v108, v152, v153
    v_mfma_f32_32x32x16_bf16 a[16:31], a[196:199], v[96:99], a[16:31]
    v_exp_f32 v156, v156
    v_exp_f32 v157, v157
    v_exp_f32 v158, v158
    v_mfma_f32_32x32x16_bf16 a[80:95], a[196:199], v[104:107], a[80:95]
    buffer_load_dwordx4 v22, s[28:31], s87 offen offset:1024 lds
    s_add_u32 m0, s76, 0x8000
    s_mov_b32 s87, 0x18000
    v_exp_f32 v159, v159
    v_cvt_pk_bf16_f32 v109, v154, v155
    v_mfma_f32_32x32x16_bf16 a[32:47], a[200:203], v[96:99], a[32:47]
    v_cvt_pk_bf16_f32 v110, v156, v157
    v_cvt_pk_bf16_f32 v111, v158, v159
    v_max3_f32 v52, v160, v161, v162
    v_max3_f32 v52, v163, v164, v52
    v_max3_f32 v52, v165, v166, v52
    v_max3_f32 v52, v167, v168, v52
    v_mfma_f32_32x32x16_bf16 a[96:111], a[200:203], v[104:107], a[96:111]
    v_max3_f32 v52, v169, v170, v52
    v_max3_f32 v52, v171, v172, v52
    v_max3_f32 v52, v173, v174, v52
    v_max3_f32 v52, v175, v176, v52
    v_max3_f32 v52, v177, v178, v52
    v_add_f32 v50, v50, v144
    v_mfma_f32_32x32x16_bf16 a[48:63], a[204:207], v[96:99], a[48:63]
    v_add_f32 v51, v51, v145
    v_max3_f32 v52, v179, v180, v52
    v_add_f32 v48, v48, v130
    v_add_f32 v49, v49, v131
    v_add_f32 v50, v50, v146
    v_add_f32 v51, v51, v147
    v_mfma_f32_32x32x16_bf16 a[112:127], a[204:207], v[104:107], a[112:127]
    v_max3_f32 v52, v181, v182, v52
    v_add_f32 v48, v48, v132
    v_add_f32 v49, v49, v133
    v_add_f32 v50, v50, v148
    v_add_f32 v51, v51, v149
    v_max3_f32 v52, v183, v184, v52
    v_mfma_f32_32x32x16_bf16 a[0:15], a[208:211], v[100:103], a[0:15]
    v_add_f32 v48, v48, v134
    v_add_f32 v49, v49, v135
    v_add_f32 v50, v50, v150
    v_add_f32 v51, v51, v151
    v_max3_f32 v52, v185, v186, v52
    v_add_f32 v48, v48, v136
    v_mfma_f32_32x32x16_bf16 a[64:79], a[208:211], v[108:111], a[64:79]
    v_add_f32 v49, v49, v137
    v_add_f32 v50, v50, v152
    v_add_f32 v51, v51, v153
    v_max3_f32 v52, v187, v188, v52
    v_add_f32 v48, v48, v138
    v_add_f32 v49, v49, v139
    v_mfma_f32_32x32x16_bf16 a[16:31], a[212:215], v[100:103], a[16:31]
    v_add_f32 v50, v50, v154
    v_add_f32 v51, v51, v155
    v_max3_f32 v52, v189, v190, v52
    v_add_f32 v48, v48, v140
    v_add_f32 v49, v49, v141
    v_add_f32 v50, v50, v156
    v_mfma_f32_32x32x16_bf16 a[80:95], a[212:215], v[108:111], a[80:95]
    v_add_f32 v51, v51, v157
    v_max_f32 v52, v191, v52
    ds_read_b128 a[232:235], v26 offset:32768
    v_add_f32 v48, v48, v142
    v_add_f32 v49, v49, v143
    v_add_f32 v50, v50, v158
    v_mfma_f32_32x32x16_bf16 a[32:47], a[216:219], v[100:103], a[32:47]
    v_add_f32 v51, v51, v159
    v_cmp_lt_f32 vcc, v57, v52
    ds_read_b128 a[236:239], v27 offset:32768
    s_mov_b32 s35, 0x20000
    s_add_u32 s73, s73, 0x1000
    buffer_load_dwordx4 a[172:175], v46, s[32:35], s73 offen
    v_mfma_f32_32x32x16_bf16 a[96:111], a[216:219], v[108:111], a[96:111]
    ds_read_b128 a[240:243], v28 offset:32768
    ds_read_b128 a[244:247], v29 offset:32768
    v_mfma_f32_32x32x16_bf16 a[48:63], a[220:223], v[100:103], a[48:63]
    ds_read_b128 a[248:251], v30 offset:32768
    ds_read_b128 a[252:255], v31 offset:32768
    buffer_load_dwordx4 a[172:175], v46, s[32:35], s73 offen offset:1024
    v_mfma_f32_32x32x16_bf16 a[112:127], a[220:223], v[108:111], a[112:127]
    s_cbranch_vccnz L_rare5
L_rare5_ret:
    ds_read_b64_tr_b16 a[192:193], v32 offset:16384
    v_exp_f32 v160, v160
    ds_read_b64_tr_b16 a[194:195], v32 offset:17408
    s_waitcnt lgkmcnt(8)
    v_mfma_f32_32x32x16_bf16 v[128:143], a[224:227], v[192:195], v[64:79]
    ds_read_b64_tr_b16 a[196:197], v33 offset:16384
    v_exp_f32 v161, v161
    ds_read_b64_tr_b16 a[198:199], v33 offset:17408
    v_exp_f32 v162, v162
    v_mfma_f32_32x32x16_bf16 v[144:159], a[224:227], v[224:227], v[80:95]
    v_exp_f32 v163, v163
    v_exp_f32 v164, v164
    v_exp_f32 v165, v165
    v_mfma_f32_32x32x16_bf16 v[128:143], a[228:231], v[196:199], v[128:143]
    v_exp_f32 v166, v166
    v_exp_f32 v167, v167
    ds_read_b64_tr_b16 a[200:201], v34 offset:16384
    v_cvt_pk_bf16_f32 v96, v160, v161
    v_mfma_f32_32x32x16_bf16 v[144:159], a[228:231], v[228:231], v[144:159]
    ds_read_b64_tr_b16 a[202:203], v34 offset:17408
    v_cvt_pk_bf16_f32 v97, v162, v163
    v_cvt_pk_bf16_f32 v98, v164, v165
    v_cvt_pk_bf16_f32 v99, v166, v167
    ds_read_b64_tr_b16 a[204:205], v35 offset:16384
    s_waitcnt lgkmcnt(10)
    v_mfma_f32_32x32x16_bf16 v[128:143], a[232:235], v[200:203], v[128:143]
    v_exp_f32 v176, v176
    v_exp_f32 v177, v177
    v_exp_f32 v178, v178
    v_mfma_f32_32x32x16_bf16 v[144:159], a[232:235], v[232:235], v[144:159]
    v_exp_f32 v179, v179
    v_exp_f32 v180, v180
    v_exp_f32 v181, v181
    v_mfma_f32_32x32x16_bf16 v[128:143], a[236:239], v[204:207], v[128:143]
    v_exp_f32 v182, v182
    v_exp_f32 v183, v183
    v_cvt_pk_bf16_f32 v104, v176, v177
    v_cvt_pk_bf16_f32 v105, v178, v179
    v_mfma_f32_32x32x16_bf16 v[144:159], a[236:239], v[236:239], v[144:159]
    v_cvt_pk_bf16_f32 v106, v180, v181
    v_cvt_pk_bf16_f32 v107, v182, v183
    ds_read_b64_tr_b16 a[206:207], v35 offset:17408
    v_exp_f32 v168, v168
    ds_read_b64_tr_b16 a[208:209], v32 offset:20480
    v_mfma_f32_32x32x16_bf16 v[128:143], a[240:243], v[208:211], v[128:143]
    ds_read_b64_tr_b16 a[210:211], v32 offset:21504
    v_exp_f32 v169, v169
    ds_read_b64_tr_b16 a[212:213], v33 offset:20480
    v_exp_f32 v170, v170
    v_mfma_f32_32x32x16_bf16 v[144:159], a[240:243], v[240:243], v[144:159]
    ds_read_b64_tr_b16 a[214:215], v33 offset:21504
    v_exp_f32 v171, v171
    v_exp_f32 v172, v172
    s_waitcnt lgkmcnt(6)
    v_mfma_f32_32x32x16_bf16 v[128:143], a[244:247], v[212:215], v[128:143]
    v_exp_f32 v173, v173
    v_exp_f32 v174, v174
    v_exp_f32 v175, v175
    v_mfma_f32_32x32x16_bf16 v[144:159], a[244:247], v[244:247], v[144:159]
    ds_read_b64_tr_b16 a[216:217], v34 offset:20480
    v_cvt_pk_bf16_f32 v100, v168, v169
    ds_read_b64_tr_b16 a[218:219], v34 offset:21504
    v_cvt_pk_bf16_f32 v101, v170, v171
    v_cvt_pk_bf16_f32 v102, v172, v173
    v_cvt_pk_bf16_f32 v103, v174, v175
    v_mfma_f32_32x32x16_bf16 v[128:143], a[248:251], v[216:219], v[128:143]
    v_exp_f32 v184, v184
    v_exp_f32 v185, v185
    v_exp_f32 v186, v186
    v_mfma_f32_32x32x16_bf16 v[144:159], a[248:251], v[248:251], v[144:159]
    v_exp_f32 v187, v187
    v_exp_f32 v188, v188
    v_exp_f32 v189, v189
    v_mfma_f32_32x32x16_bf16 v[128:143], a[252:255], v[220:223], v[128:143]
    v_exp_f32 v190, v190
    v_exp_f32 v191, v191
    v_cvt_pk_bf16_f32 v108, v184, v185
    v_cvt_pk_bf16_f32 v109, v186, v187
    v_mfma_f32_32x32x16_bf16 v[144:159], a[252:255], v[252:255], v[144:159]
    v_cvt_pk_bf16_f32 v110, v188, v189
    v_cvt_pk_bf16_f32 v111, v190, v191
    ds_read_b64_tr_b16 a[220:221], v35 offset:20480
    v_add_f32 v48, v48, v160
    ds_read_b64_tr_b16 a[222:223], v35 offset:21504
    v_add_f32 v49, v49, v161
    v_mfma_f32_32x32x16_bf16 a[0:15], a[192:195], v[96:99], a[0:15]
    ds_read_b128 a[224:227], v24 offset:57344
    v_max3_f32 v52, v128, v129, v130
    v_max3_f32 v52, v131, v132, v52
    v_max3_f32 v52, v133, v134, v52
    ds_read_b128 a[228:231], v25 offset:57344
    v_max3_f32 v52, v135, v136, v52
    v_mfma_f32_32x32x16_bf16 a[64:79], a[192:195], v[104:107], a[64:79]
    v_max3_f32 v52, v137, v138, v52
    v_max3_f32 v52, v139, v140, v52
    v_max3_f32 v52, v141, v142, v52
    v_max3_f32 v52, v143, v144, v52
    v_max3_f32 v52, v145, v146, v52
    v_add_f32 v50, v50, v176
    v_mfma_f32_32x32x16_bf16 a[16:31], a[196:199], v[96:99], a[16:31]
    v_add_f32 v51, v51, v177
    v_max3_f32 v52, v147, v148, v52
    v_add_f32 v48, v48, v162
    v_add_f32 v49, v49, v163
    v_add_f32 v50, v50, v178
    v_add_f32 v51, v51, v179
    v_mfma_f32_32x32x16_bf16 a[80:95], a[196:199], v[104:107], a[80:95]
    v_max3_f32 v52, v149, v150, v52
    v_add_f32 v48, v48, v164
    v_add_f32 v49, v49, v165
    v_add_f32 v50, v50, v180
    v_add_f32 v51, v51, v181
    v_max3_f32 v52, v151, v152, v52
    v_mfma_f32_32x32x16_bf16 a[32:47], a[200:203], v[96:99], a[32:47]
    v_add_f32 v48, v48, v166
    v_add_f32 v49, v49, v167
    v_add_f32 v50, v50, v182
    v_add_f32 v51, v51, v183
    v_max3_f32 v52, v153, v154, v52
    v_add_f32 v48, v48, v168
    v_mfma_f32_32x32x16_bf16 a[96:111], a[200:203], v[104:107], a[96:111]
    v_add_f32 v49, v49, v169
    v_add_f32 v50, v50, v184
    v_add_f32 v51, v51, v185
    v_max3_f32 v52, v155, v156, v52
    v_add_f32 v48, v48, v170
    s_waitcnt lgkmcnt(3)
    v_mfma_f32_32x32x16_bf16 a[48:63], a[204:207], v[96:99], a[48:63]
    v_add_f32 v49, v49, v171
    v_add_f32 v50, v50, v186
    v_add_f32 v51, v51, v187
    v_max3_f32 v52, v157, v158, v52
    v_add_f32 v48, v48, v172
    v_add_f32 v49, v49, v173
    v_mfma_f32_32x32x16_bf16 a[112:127], a[204:207], v[104:107], a[112:127]
    v_add_f32 v50, v50, v188
    v_add_f32 v51, v51, v189
    v_max_f32 v52, v159, v52
    ds_read_b128 a[232:235], v26 offset:57344
    v_add_f32 v48, v48, v174
    v_add_f32 v49, v49, v175
    v_mfma_f32_32x32x16_bf16 a[0:15], a[208:211], v[100:103], a[0:15]
    v_add_f32 v50, v50, v190
    v_add_f32 v51, v51, v191
    v_cmp_lt_f32 vcc, v57, v52
    ds_read_b128 a[236:239], v27 offset:57344
    buffer_load_dwordx4 a[172:175], v46, s[32:35], s73 offen offset:2048
    v_mfma_f32_32x32x16_bf16 a[64:79], a[208:211], v[108:111], a[64:79]
    ds_read_b128 a[240:243], v28 offset:57344
    ds_read_b128 a[244:247], v29 offset:57344
    v_mfma_f32_32x32x16_bf16 a[16:31], a[212:215], v[100:103], a[16:31]
    ds_read_b128 a[248:251], v30 offset:57344
    ds_read_b128 a[252:255], v31 offset:57344
    buffer_load_dwordx4 a[172:175], v46, s[32:35], s73 offen offset:3072
    v_mfma_f32_32x32x16_bf16 a[80:95], a[212:215], v[108:111], a[80:95]
    ds_read_b64_tr_b16 a[192:193], v32 offset:32768
    s_lshl_b32 s73, s2, 2
    ds_read_b64_tr_b16 a[194:195], v32 offset:33792
    s_add_u32 s73, s73, s62
    ds_read_b64_tr_b16 a[196:197], v33 offset:32768
    s_mov_b32 s32, s44
    v_mfma_f32_32x32x16_bf16 a[32:47], a[216:219], v[100:103], a[32:47]
    ds_read_b64_tr_b16 a[198:199], v33 offset:33792
    s_and_b32 s33, s45, 0xffff
    ds_read_b64_tr_b16 a[200:201], v34 offset:32768
    s_mov_b32 s34, 0x400000
    ds_read_b64_tr_b16 a[202:203], v34 offset:33792
    s_mov_b32 s35, 0x20000
    v_mfma_f32_32x32x16_bf16 a[96:111], a[216:219], v[108:111], a[96:111]
    ds_read_b64_tr_b16 a[204:205], v35 offset:32768
    s_lshl_b32 s73, s73, 12
    ds_read_b64_tr_b16 a[206:207], v35 offset:33792
    ds_read_b64_tr_b16 a[208:209], v32 offset:36864
    s_waitcnt lgkmcnt(14)
    v_mfma_f32_32x32x16_bf16 a[48:63], a[220:223], v[100:103], a[48:63]
    ds_read_b64_tr_b16 a[210:211], v32 offset:37888
    ds_read_b64_tr_b16 a[212:213], v33 offset:36864
    ds_read_b64_tr_b16 a[214:215], v33 offset:37888
    v_mfma_f32_32x32x16_bf16 a[112:127], a[220:223], v[108:111], a[112:127]
    s_cbranch_vccnz L_rare6
L_rare6_ret:
    v_exp_f32 v128, v128
    v_exp_f32 v129, v129
    ds_read_b64_tr_b16 a[216:217], v34 offset:36864
    v_mfma_f32_32x32x16_bf16 v[160:175], a[224:227], v[192:195], v[64:79]
    v_exp_f32 v130, v130
    v_exp_f32 v131, v131
    v_exp_f32 v132, v132
    v_mfma_f32_32x32x16_bf16 v[176:191], a[224:227], v[224:227], v[80:95]
    v_exp_f32 v133, v133
    v_exp_f32 v134, v134
    v_exp_f32 v135, v135
    v_mfma_f32_32x32x16_bf16 v[160:175], a[228:231], v[196:199], v[160:175]
    v_cvt_pk_bf16_f32 v96, v128, v129
    v_cvt_pk_bf16_f32 v97, v130, v131
    v_cvt_pk_bf16_f32 v98, v132, v133
    v_cvt_pk_bf16_f32 v99, v134, v135
    v_exp_f32 v144, v144
    v_mfma_f32_32x32x16_bf16 v[176:191], a[228:231], v[228:231], v[176:191]
    v_exp_f32 v145, v145
    v_exp_f32 v146, v146
    v_exp_f32 v147, v147
    v_mfma_f32_32x32x16_bf16 v[160:175], a[232:235], v[200:203], v[160:175]
    v_exp_f32 v148, v148
    v_exp_f32 v149, v149
    v_exp_f32 v150, v150
    v_mfma_f32_32x32x16_bf16 v[176:191], a[232:235], v[232:235], v[176:191]
    v_exp_f32 v151, v151
    v_cvt_pk_bf16_f32 v104, v144, v145
    v_cvt_pk_bf16_f32 v105, v146, v147
    v_cvt_pk_bf16_f32 v106, v148, v149
    s_waitcnt lgkmcnt(1)
    v_mfma_f32_32x32x16_bf16 v[160:175], a[236:239], v[204:207], v[160:175]
    v_cvt_pk_bf16_f32 v107, v150, v151
    v_exp_f32 v136, v136
    v_exp_f32 v137, v137
    ds_read_b64_tr_b16 a[218:219], v34 offset:37888
    v_mfma_f32_32x32x16_bf16 v[176:191], a[236:239], v[236:239], v[176:191]
    v_exp_f32 v138, v138
    v_exp_f32 v139, v139
    v_exp_f32 v140, v140
    v_mfma_f32_32x32x16_bf16 v[160:175], a[240:243], v[208:211], v[160:175]
    v_exp_f32 v141, v141
    v_exp_f32 v142, v142
    v_exp_f32 v143, v143
    v_mfma_f32_32x32x16_bf16 v[176:191], a[240:243], v[240:243], v[176:191]
    v_cvt_pk_bf16_f32 v100, v136, v137
    v_cvt_pk_bf16_f32 v101, v138, v139
    v_cvt_pk_bf16_f32 v102, v140, v141
    v_cvt_pk_bf16_f32 v103, v142, v143
    v_exp_f32 v152, v152
    v_mfma_f32_32x32x16_bf16 v[160:175], a[244:247], v[212:215], v[160:175]
    v_exp_f32 v153, v153
    v_exp_f32 v154, v154
    v_exp_f32 v155, v155
    v_mfma_f32_32x32x16_bf16 v[176:191], a[244:247], v[244:247], v[176:191]
    v_exp_f32 v156, v156
    v_exp_f32 v157, v157
    v_exp_f32 v158, v158
    v_mfma_f32_32x32x16_bf16 v[160:175], a[248:251], v[216:219], v[160:175]
    v_exp_f32 v159, v159
    v_cvt_pk_bf16_f32 v108, v152, v153
    v_cvt_pk_bf16_f32 v109, v154, v155
    v_cvt_pk_bf16_f32 v110, v156, v157
    v_cvt_pk_bf16_f32 v111, v158, v159
    v_mfma_f32_32x32x16_bf16 v[176:191], a[248:251], v[248:251], v[176:191]
    ds_read_b64_tr_b16 a[220:221], v35 offset:36864
    v_add_f32 v48, v48, v128
    ds_read_b64_tr_b16 a[222:223], v35 offset:37888
    v_add_f32 v49, v49, v129
    v_add_f32 v50, v50, v144
    v_add_f32 v51, v51, v145
    v_mfma_f32_32x32x16_bf16 v[160:175], a[252:255], v[220:223], v[160:175]
    v_add_f32 v48, v48, v130
    v_add_f32 v49, v49, v131
    v_add_f32 v50, v50, v146
    v_add_f32 v51, v51, v147
    v_add_f32 v48, v48, v132
    v_add_f32 v49, v49, v133
    v_mfma_f32_32x32x16_bf16 v[176:191], a[252:255], v[252:255], v[176:191]
    v_add_f32 v50, v50, v148
    v_add_f32 v51, v51, v149
    v_add_f32 v48, v48, v134
    v_add_f32 v49, v49, v135
    v_add_f32 v50, v50, v150
    v_max3_f32 v52, v160, v161, v162
    v_mfma_f32_32x32x16_bf16 a[0:15], a[192:195], v[96:99], a[0:15]
    s_barrier
    buffer_load_dwordx4 v20, s[24:27], s86 offen lds
    ds_read_b128 a[224:227], v24
    v_mfma_f32_32x32x16_bf16 a[64:79], a[192:195], v[104:107], a[64:79]
    v_max3_f32 v52, v163, v164, v52
    ds_read_b128 a[228:231], v25
    v_max3_f32 v52, v165, v166, v52
    v_max3_f32 v52, v167, v168, v52
    v_max3_f32 v52, v169, v170, v52
    v_max3_f32 v52, v171, v172, v52
    v_mfma_f32_32x32x16_bf16 a[16:31], a[196:199], v[96:99], a[16:31]
    s_waitcnt vmcnt(12)
    v_mul_f32 v10, 0x3abe82fa, v10
    v_mul_f32 v11, 0x3abe82fa, v11
    v_mul_f32 v12, v10, v10
    buffer_load_dwordx4 v21, s[24:27], s86 offen offset:1024 lds
    s_add_u32 m0, s76, 0x12000
    v_mfma_f32_32x32x16_bf16 a[80:95], a[196:199], v[104:107], a[80:95]
    s_mov_b32 s86, 0x1a000
    v_sub_f32 v11, v11, v12
    v_max_f32 v11, 0, v11
    v_cvt_pk_bf16_f32 v11, v11, v11
    v_and_b32 v11, 0xffff0000, v11
    v_add_f32 v11, 0x3727c5ac, v11
    v_mfma_f32_32x32x16_bf16 a[32:47], a[200:203], v[96:99], a[32:47]
    v_cvt_pk_bf16_f32 v11, v11, v11
    v_and_b32 v11, 0xffff0000, v11
    s_waitcnt vmcnt(12)
    v_mul_f32 v14, 0x3abe82fa, v14
    buffer_load_dwordx4 v22, s[28:31], s87 offen lds
    v_mul_f32 v15, 0x3abe82fa, v15
    v_mfma_f32_32x32x16_bf16 a[96:111], a[200:203], v[104:107], a[96:111]
    v_sqrt_f32 v11, v11
    v_mul_f32 v16, v14, v14
    v_sub_f32 v15, v15, v16
    v_max_f32 v15, 0, v15
    v_cvt_pk_bf16_f32 v11, v11, v11
    v_mfma_f32_32x32x16_bf16 a[48:63], a[204:207], v[96:99], a[48:63]
    v_cvt_pk_bf16_f32 v15, v15, v15
    v_and_b32 v11, 0xffff0000, v11
    v_and_b32 v15, 0xffff0000, v15
    v_cvt_pk_bf16_f32 v10, v10, v10
    buffer_load_dwordx4 v22, s[28:31], s87 offen offset:1024 lds
    s_add_u32 m0, s76, 0xe000
    v_mfma_f32_32x32x16_bf16 a[112:127], a[204:207], v[104:107], a[112:127]
    s_mov_b32 s87, 0x1a000
    v_rcp_f32 v11, v11
    v_add_f32 v15, 0x3727c5ac, v15
    v_and_b32 v10, 0xffff0000, v10
    v_cvt_pk_bf16_f32 v15, v15, v15
    v_mfma_f32_32x32x16_bf16 a[0:15], a[208:211], v[100:103], a[0:15]
    v_sub_f32 v2, v2, v10
    v_sub_f32 v3, v3, v10
    v_sub_f32 v4, v4, v10
    v_sub_f32 v5, v5, v10
    v_sub_f32 v6, v6, v10
    v_sub_f32 v7, v7, v10
    v_mfma_f32_32x32x16_bf16 a[64:79], a[208:211], v[108:111], a[64:79]
    v_sub_f32 v8, v8, v10
    v_sub_f32 v9, v9, v10
    v_and_b32 v15, 0xffff0000, v15
    v_mul_f32 v2, v2, v11
    v_mul_f32 v3, v3, v11
    v_mul_f32 v4, v4, v11
    v_mfma_f32_32x32x16_bf16 a[16:31], a[212:215], v[100:103], a[16:31]
    v_mul_f32 v5, v5, v11
    v_mul_f32 v6, v6, v11
    v_mul_f32 v7, v7, v11
    v_mul_f32 v8, v8, v11
    v_mul_f32 v9, v9, v11
    v_cvt_pk_bf16_f32 v112, v2, v3
    v_mfma_f32_32x32x16_bf16 a[80:95], a[212:215], v[108:111], a[80:95]
    v_sqrt_f32 v15, v15
    v_cvt_pk_bf16_f32 v113, v4, v5
    v_cvt_pk_bf16_f32 v114, v6, v7
    v_cvt_pk_bf16_f32 v115, v8, v9
    s_waitcnt lgkmcnt(0)
    v_mfma_f32_32x32x16_bf16 a[32:47], a[216:219], v[100:103], a[32:47]
    v_lshlrev_b32 v2, 16, v116
    v_and_b32 v3, 0xffff0000, v116
    v_lshlrev_b32 v4, 16, v117
    v_and_b32 v5, 0xffff0000, v117
    v_lshlrev_b32 v6, 16, v118
    v_and_b32 v7, 0xffff0000, v118
    v_mfma_f32_32x32x16_bf16 a[96:111], a[216:219], v[108:111], a[96:111]
    v_lshlrev_b32 v8, 16, v119
    v_and_b32 v9, 0xffff0000, v119
    v_sub_f32 v2, v2, v10
    v_sub_f32 v3, v3, v10
    v_sub_f32 v4, v4, v10
    v_sub_f32 v5, v5, v10
    v_mfma_f32_32x32x16_bf16 a[48:63], a[220:223], v[100:103], a[48:63]
    v_sub_f32 v6, v6, v10
    v_sub_f32 v7, v7, v10
    v_sub_f32 v8, v8, v10
    v_sub_f32 v9, v9, v10
    v_cvt_pk_bf16_f32 v15, v15, v15
    v_mul_f32 v2, v2, v11
    v_mfma_f32_32x32x16_bf16 a[112:127], a[220:223], v[108:111], a[112:127]
    v_mul_f32 v3, v3, v11
    v_mul_f32 v4, v4, v11
    v_mul_f32 v5, v5, v11
    v_mul_f32 v6, v6, v11
    v_mul_f32 v7, v7, v11
    v_mul_f32 v8, v8, v11
    v_mul_f32 v9, v9, v11
    v_and_b32 v15, 0xffff0000, v15
    v_cvt_pk_bf16_f32 v116, v2, v3
    v_cvt_pk_bf16_f32 v117, v4, v5
    v_cvt_pk_bf16_f32 v118, v6, v7
    v_cvt_pk_bf16_f32 v119, v8, v9
    v_cvt_pk_bf16_f32 v14, v14, v14
    v_rcp_f32 v15, v15
    v_and_b32 v14, 0xffff0000, v14
    v_lshlrev_b32 v2, 16, v120
    v_and_b32 v3, 0xffff0000, v120
    v_lshlrev_b32 v4, 16, v121
    v_and_b32 v5, 0xffff0000, v121
    v_lshlrev_b32 v6, 16, v122
    v_and_b32 v7, 0xffff0000, v122
    v_lshlrev_b32 v8, 16, v123
    v_and_b32 v9, 0xffff0000, v123
    v_sub_f32 v2, v2, v14
    v_sub_f32 v3, v3, v14
    v_sub_f32 v4, v4, v14
    v_sub_f32 v5, v5, v14
    v_sub_f32 v6, v6, v14
    v_sub_f32 v7, v7, v14
    v_sub_f32 v8, v8, v14
    v_sub_f32 v9, v9, v14
    v_mul_f32 v2, v2, v15
    v_mul_f32 v3, v3, v15
    v_mul_f32 v4, v4, v15
    v_mul_f32 v5, v5, v15
    v_mul_f32 v6, v6, v15
    v_mul_f32 v7, v7, v15
    v_mul_f32 v8, v8, v15
    v_mul_f32 v9, v9, v15
    v_cvt_pk_bf16_f32 v120, v2, v3
    v_cvt_pk_bf16_f32 v121, v4, v5
    v_cvt_pk_bf16_f32 v122, v6, v7
    v_cvt_pk_bf16_f32 v123, v8, v9
    v_lshlrev_b32 v2, 16, v124
    v_and_b32 v3, 0xffff0000, v124
    v_lshlrev_b32 v4, 16, v125
    v_and_b32 v5, 0xffff0000, v125
    v_lshlrev_b32 v6, 16, v126
    v_and_b32 v7, 0xffff0000, v126
    v_lshlrev_b32 v8, 16, v127
    v_and_b32 v9, 0xffff0000, v127
    v_sub_f32 v2, v2, v14
    v_sub_f32 v3, v3, v14
    v_sub_f32 v4, v4, v14
    v_sub_f32 v5, v5, v14
    v_sub_f32 v6, v6, v14
    v_sub_f32 v7, v7, v14
    v_sub_f32 v8, v8, v14
    v_sub_f32 v9, v9, v14
    v_mul_f32 v2, v2, v15
    v_mul_f32 v3, v3, v15
    v_mul_f32 v4, v4, v15
    v_mul_f32 v5, v5, v15
    v_mul_f32 v6, v6, v15
    v_mul_f32 v7, v7, v15
    v_mul_f32 v8, v8, v15
    v_mul_f32 v9, v9, v15
    v_cvt_pk_bf16_f32 v124, v2, v3
    v_cvt_pk_bf16_f32 v125, v4, v5
    v_cvt_pk_bf16_f32 v126, v6, v7
    v_cvt_pk_bf16_f32 v127, v8, v9
    ds_write_b128 v19, v[112:115]
    v_max3_f32 v52, v173, v174, v52
    v_max3_f32 v52, v175, v176, v52
    v_max3_f32 v52, v177, v178, v52
    v_max3_f32 v52, v179, v180, v52
    v_max3_f32 v52, v181, v182, v52
    v_max3_f32 v52, v183, v184, v52
    v_add_f32 v51, v51, v151
    v_max3_f32 v52, v185, v186, v52
    v_add_f32 v48, v48, v136
    ds_write_b128 v19, v[116:119] offset:32
    v_add_f32 v49, v49, v137
    v_add_f32 v50, v50, v152
    v_add_f32 v51, v51, v153
    v_max3_f32 v52, v187, v188, v52
    v_add_f32 v48, v48, v138
    v_add_f32 v49, v49, v139
    v_add_f32 v50, v50, v154
    v_add_f32 v51, v51, v155
    v_max3_f32 v52, v189, v190, v52
    ds_write_b128 v19, v[120:123] offset:2048
    v_add_f32 v48, v48, v140
    v_add_f32 v49, v49, v141
    v_add_f32 v50, v50, v156
    v_add_f32 v51, v51, v157
    v_max_f32 v52, v191, v52
    v_add_f32 v48, v48, v142
    v_add_f32 v49, v49, v143
    v_add_f32 v50, v50, v158
    v_add_f32 v51, v51, v159
    ds_write_b128 v19, v[124:127] offset:2080
    v_cmp_lt_f32 vcc, v57, v52
    s_waitcnt lgkmcnt(2)
    ds_read_b64_tr_b16 v[112:113], v23
    s_cbranch_vccnz L_rare7
L_rare7_ret:
    v_mfma_f32_32x32x16_bf16 v[128:143], a[224:227], v[192:195], v[64:79]
    ds_read_b64_tr_b16 v[114:115], v23 offset:256
    v_exp_f32 v160, v160
    ds_read_b64_tr_b16 v[116:117], v23 offset:1024
    v_exp_f32 v161, v161
    v_mfma_f32_32x32x16_bf16 v[144:159], a[224:227], v[224:227], v[80:95]
    ds_read_b64_tr_b16 v[118:119], v23 offset:1280
    v_exp_f32 v162, v162
    s_waitcnt lgkmcnt(4)
    ds_read_b64_tr_b16 v[120:121], v23 offset:2048
    v_cvt_pk_bf16_f32 v96, v160, v161
    v_mfma_f32_32x32x16_bf16 v[128:143], a[228:231], v[196:199], v[128:143]
    ds_read_b64_tr_b16 v[122:123], v23 offset:2304
    v_exp_f32 v163, v163
    ds_read_b64_tr_b16 v[124:125], v23 offset:3072
    v_exp_f32 v164, v164
    v_mfma_f32_32x32x16_bf16 v[144:159], a[228:231], v[228:231], v[144:159]
    ds_read_b64_tr_b16 v[126:127], v23 offset:3328
    v_exp_f32 v165, v165
    ds_read_b128 a[232:235], v26
    v_exp_f32 v166, v166
    v_exp_f32 v167, v167
    ds_read_b128 a[236:239], v27
    v_cvt_pk_bf16_f32 v97, v162, v163
    v_cvt_pk_bf16_f32 v98, v164, v165
    s_waitcnt lgkmcnt(8)
    buffer_store_dwordx4 v[112:115], v46, s[4:7], s88 offen sc1
    s_add_u32 s88, s93, 0
    ds_read_b128 a[240:243], v28
    v_cvt_pk_bf16_f32 v99, v166, v167
    v_exp_f32 v176, v176
    ds_read_b128 a[244:247], v29
    v_exp_f32 v177, v177
    v_exp_f32 v178, v178
    ds_read_b128 a[248:251], v30
    v_exp_f32 v179, v179
    v_exp_f32 v180, v180
    s_waitcnt lgkmcnt(9)
    buffer_store_dwordx4 v[116:119], v46, s[4:7], s89 offen sc1
    s_add_u32 s89, s93, 0x400
    ds_read_b128 a[252:255], v31
    v_exp_f32 v181, v181
    v_exp_f32 v182, v182
    ds_read_b64_tr_b16 a[192:193], v32 offset:40960
    s_waitcnt lgkmcnt(6)
    v_mfma_f32_32x32x16_bf16 v[128:143], a[232:235], v[200:203], v[128:143]
    ds_read_b64_tr_b16 a[194:195], v32 offset:41984
    v_exp_f32 v183, v183
    ds_read_b64_tr_b16 a[196:197], v33 offset:40960
    v_cvt_pk_bf16_f32 v104, v176, v177
    buffer_store_dwordx4 v[120:123], v46, s[4:7], s90 offen sc1
    v_mfma_f32_32x32x16_bf16 v[144:159], a[232:235], v[232:235], v[144:159]
    s_add_u32 s90, s93, 0x800
    v_lshrrev_b32 v122, 3, v0
    v_and_b32 v123, 7, v0
    ds_read_b64_tr_b16 a[198:199], v33 offset:41984
    v_cvt_pk_bf16_f32 v105, v178, v179
    s_waitcnt lgkmcnt(8)
    v_mfma_f32_32x32x16_bf16 v[128:143], a[236:239], v[204:207], v[128:143]
    ds_read_b64_tr_b16 a[200:201], v34 offset:40960
    v_cvt_pk_bf16_f32 v106, v180, v181
    ds_read_b64_tr_b16 a[202:203], v34 offset:41984
    v_cvt_pk_bf16_f32 v107, v182, v183
    ds_read_b64_tr_b16 a[204:205], v35 offset:40960
    buffer_store_dwordx4 v[124:127], v46, s[4:7], s91 offen sc1
    v_mfma_f32_32x32x16_bf16 v[144:159], a[236:239], v[236:239], v[144:159]
    s_add_u32 s91, s93, 0xc00
    ds_read_b64_tr_b16 a[206:207], v35 offset:41984
    v_exp_f32 v168, v168
    ds_read_b64_tr_b16 a[208:209], v32 offset:45056
    s_waitcnt lgkmcnt(11)
    v_mfma_f32_32x32x16_bf16 v[128:143], a[240:243], v[208:211], v[128:143]
    ds_read_b64_tr_b16 a[210:211], v32 offset:46080
    v_exp_f32 v169, v169
    ds_read_b64_tr_b16 a[212:213], v33 offset:45056
    v_exp_f32 v170, v170
    v_mfma_f32_32x32x16_bf16 v[144:159], a[240:243], v[240:243], v[144:159]
    ds_read_b64_tr_b16 a[214:215], v33 offset:46080
    v_exp_f32 v171, v171
    v_exp_f32 v172, v172
    ds_read_b64_tr_b16 a[216:217], v34 offset:45056
    v_mfma_f32_32x32x16_bf16 v[128:143], a[244:247], v[212:215], v[128:143]
    v_exp_f32 v173, v173
    v_exp_f32 v174, v174
    v_exp_f32 v175, v175
    v_mfma_f32_32x32x16_bf16 v[144:159], a[244:247], v[244:247], v[144:159]
    ds_read_b64_tr_b16 a[218:219], v34 offset:46080
    v_cvt_pk_bf16_f32 v100, v168, v169
    v_cvt_pk_bf16_f32 v101, v170, v171
    v_cvt_pk_bf16_f32 v102, v172, v173
    v_cvt_pk_bf16_f32 v103, v174, v175
    s_waitcnt lgkmcnt(10)
    v_mfma_f32_32x32x16_bf16 v[128:143], a[248:251], v[216:219], v[128:143]
    v_exp_f32 v184, v184
    v_exp_f32 v185, v185
    v_exp_f32 v186, v186
    v_mfma_f32_32x32x16_bf16 v[144:159], a[248:251], v[248:251], v[144:159]
    v_exp_f32 v187, v187
    v_exp_f32 v188, v188
    v_exp_f32 v189, v189
    v_mfma_f32_32x32x16_bf16 v[128:143], a[252:255], v[220:223], v[128:143]
    v_exp_f32 v190, v190
    v_exp_f32 v191, v191
    v_cvt_pk_bf16_f32 v108, v184, v185
    v_cvt_pk_bf16_f32 v109, v186, v187
    v_mfma_f32_32x32x16_bf16 v[144:159], a[252:255], v[252:255], v[144:159]
    v_cvt_pk_bf16_f32 v110, v188, v189
    v_cvt_pk_bf16_f32 v111, v190, v191
    ds_read_b64_tr_b16 a[220:221], v35 offset:45056
    v_add_f32 v48, v48, v160
    ds_read_b64_tr_b16 a[222:223], v35 offset:46080
    v_add_f32 v49, v49, v161
    v_mfma_f32_32x32x16_bf16 a[0:15], a[192:195], v[96:99], a[0:15]
    s_barrier
    buffer_load_dwordx4 v20, s[24:27], s86 offen lds
    ds_read_b128 a[224:227], v24 offset:24576
    v_mfma_f32_32x32x16_bf16 a[64:79], a[192:195], v[104:107], a[64:79]
    v_max3_f32 v52, v128, v129, v130
    ds_read_b128 a[228:231], v25 offset:24576
    v_max3_f32 v52, v131, v132, v52
    v_max3_f32 v52, v133, v134, v52
    v_max3_f32 v52, v135, v136, v52
    v_max3_f32 v52, v137, v138, v52
    v_mfma_f32_32x32x16_bf16 a[16:31], a[196:199], v[96:99], a[16:31]
    v_max3_f32 v52, v139, v140, v52
    v_max3_f32 v52, v141, v142, v52
    v_max3_f32 v52, v143, v144, v52
    v_max3_f32 v52, v145, v146, v52
    buffer_load_dwordx4 v21, s[24:27], s86 offen offset:1024 lds
    s_add_u32 m0, s76, 0x14000
    v_mfma_f32_32x32x16_bf16 a[80:95], a[196:199], v[104:107], a[80:95]
    s_mov_b32 s86, 0x1c000
    v_add_f32 v50, v50, v176
    v_add_f32 v51, v51, v177
    v_max3_f32 v52, v147, v148, v52
    v_add_f32 v48, v48, v162
    s_waitcnt lgkmcnt(4)
    v_mfma_f32_32x32x16_bf16 a[32:47], a[200:203], v[96:99], a[32:47]
    v_add_f32 v49, v49, v163
    v_add_f32 v50, v50, v178
    v_add_f32 v51, v51, v179
    v_max3_f32 v52, v149, v150, v52
    buffer_load_dwordx4 v22, s[28:31], s87 offen lds
    v_add_f32 v48, v48, v164
    v_mfma_f32_32x32x16_bf16 a[96:111], a[200:203], v[104:107], a[96:111]
    v_add_f32 v49, v49, v165
    v_add_f32 v50, v50, v180
    v_add_f32 v51, v51, v181
    v_max3_f32 v52, v151, v152, v52
    v_add_f32 v48, v48, v166
    v_add_f32 v49, v49, v167
    v_mfma_f32_32x32x16_bf16 a[48:63], a[204:207], v[96:99], a[48:63]
    v_add_f32 v50, v50, v182
    v_add_f32 v51, v51, v183
    v_max3_f32 v52, v153, v154, v52
    v_add_f32 v48, v48, v168
    buffer_load_dwordx4 v22, s[28:31], s87 offen offset:1024 lds
    s_add_u32 m0, s76, 0xa000
    v_mfma_f32_32x32x16_bf16 a[112:127], a[204:207], v[104:107], a[112:127]
    s_mov_b32 s87, 0x1c000
    v_add_f32 v49, v49, v169
    v_add_f32 v50, v50, v184
    v_add_f32 v51, v51, v185
    v_max3_f32 v52, v155, v156, v52
    v_add_f32 v48, v48, v170
    v_mfma_f32_32x32x16_bf16 a[0:15], a[208:211], v[100:103], a[0:15]
    v_add_f32 v49, v49, v171
    v_add_f32 v50, v50, v186
    v_add_f32 v51, v51, v187
    v_max3_f32 v52, v157, v158, v52
    buffer_load_dwordx4 v20, s[24:27], s86 offen lds
    v_add_f32 v48, v48, v172
    v_mfma_f32_32x32x16_bf16 a[64:79], a[208:211], v[108:111], a[64:79]
    v_add_f32 v49, v49, v173
    v_add_f32 v50, v50, v188
    v_add_f32 v51, v51, v189
    v_max_f32 v52, v159, v52
    ds_read_b128 a[232:235], v26 offset:24576
    v_add_f32 v48, v48, v174
    v_mfma_f32_32x32x16_bf16 a[16:31], a[212:215], v[100:103], a[16:31]
    v_add_f32 v49, v49, v175
    v_add_f32 v50, v50, v190
    v_add_f32 v51, v51, v191
    v_cmp_lt_f32 vcc, v57, v52
    buffer_load_dwordx4 v21, s[24:27], s86 offen offset:1024 lds
    s_add_u32 m0, s76, 0x18000
    v_mfma_f32_32x32x16_bf16 a[80:95], a[212:215], v[108:111], a[80:95]
    s_mov_b32 s86, 0x1e000
    ds_read_b128 a[236:239], v27 offset:24576
    v_and_b32 v116, 3, v0
    v_and_b32 v117, 1, v116
    v_lshlrev_b32 v117, 1, v117
    ds_read_b128 a[240:243], v28 offset:24576
    v_mfma_f32_32x32x16_bf16 a[32:47], a[216:219], v[100:103], a[32:47]
    v_lshrrev_b32 v118, 1, v116
    ds_read_b128 a[244:247], v29 offset:24576
    v_or_b32 v117, v117, v118
    v_lshrrev_b32 v118, 1, v122
    buffer_load_dwordx4 v22, s[28:31], s87 offen lds
    v_xor_b32 v124, v123, v118
    v_mfma_f32_32x32x16_bf16 a[96:111], a[216:219], v[108:111], a[96:111]
    v_or_b32 v118, 4, v118
    ds_read_b128 a[248:251], v30 offset:24576
    v_bfe_u32 v114, v0, 4, 1
    v_lshlrev_b32 v117, 3, v117
    v_lshl_add_u32 v119, v114, 5, v117
    s_waitcnt lgkmcnt(5)
    v_mfma_f32_32x32x16_bf16 a[48:63], a[220:223], v[100:103], a[48:63]
    v_lshlrev_b32 v117, 12, v122
    v_add_u32 v117, s1, v117
    v_lshl_add_u32 v2, v124, 4, v117
    v_xor_b32 v124, v123, v118
    buffer_load_dwordx4 v22, s[28:31], s87 offen offset:1024 lds
    s_add_u32 m0, s76, 0x4000
    v_mfma_f32_32x32x16_bf16 a[112:127], a[220:223], v[108:111], a[112:127]
    s_mov_b32 s87, 0x1e000
    v_lshl_add_u32 v3, v124, 4, v117
    v_add_u32 v3, 0x7c00, v3
    s_mul_i32 s1, s47, 3
    s_add_u32 s1, s1, s0
    s_lshl_b32 s0, s1, 1
    s_add_u32 s59, s59, s0
    s_add_u32 s59, s59, s58
    s_lshl_b32 s59, s59, 10
    s_cmp_lt_u32 s1, 22
    s_cselect_b32 s38, s59, 0x10000000
    s_lshl_b32 s1, s46, 6
    buffer_load_dwordx4 v20, s[24:27], s86 offen lds
    s_add_u32 s1, s1, s3
    s_lshl_b32 s1, s1, 1
    s_lshl_b32 s59, s46, 1
    s_cbranch_vccnz L_rare8
L_rare8_ret:
    v_mfma_f32_32x32x16_bf16 v[160:175], a[224:227], v[192:195], v[64:79]
    ds_read_b128 a[252:255], v31 offset:24576
    v_exp_f32 v128, v128
    v_exp_f32 v129, v129
    ds_read_b64_tr_b16 a[192:193], v32
    v_mfma_f32_32x32x16_bf16 v[176:191], a[224:227], v[224:227], v[80:95]
    ds_read_b64_tr_b16 a[194:195], v32 offset:1024
    buffer_load_dwordx4 v21, s[24:27], s86 offen offset:1024 lds
    s_add_u32 m0, s76, 0x1a000
    s_lshr_b32 s76, s63, 1
    s_lshl_b32 s70, s76, 6
    s_lshl_b32 s67, s76, 20
    v_mfma_f32_32x32x16_bf16 v[160:175], a[228:231], v[196:199], v[160:175]
    s_add_u32 s67, s67, s68
    s_lshl_b32 s68, s77, 2
    ds_read_b64_tr_b16 a[196:197], v33
    v_exp_f32 v130, v130
    ds_read_b64_tr_b16 a[198:199], v33 offset:1024
    v_mfma_f32_32x32x16_bf16 v[176:191], a[228:231], v[228:231], v[176:191]
    v_exp_f32 v131, v131
    buffer_load_ushort v36, v39, s[16:19], s1 offen
    s_mul_i32 s1, s47, 3
    ds_read_b64_tr_b16 a[200:201], v34
    s_waitcnt lgkmcnt(6)
    v_mfma_f32_32x32x16_bf16 v[160:175], a[232:235], v[200:203], v[160:175]
    v_exp_f32 v132, v132
    v_exp_f32 v133, v133
    v_exp_f32 v134, v134
    v_mfma_f32_32x32x16_bf16 v[176:191], a[232:235], v[232:235], v[176:191]
    v_exp_f32 v135, v135
    ds_read_b64_tr_b16 a[202:203], v34 offset:1024
    v_cvt_pk_bf16_f32 v96, v128, v129
    v_cvt_pk_bf16_f32 v97, v130, v131
    v_cvt_pk_bf16_f32 v98, v132, v133
    v_mfma_f32_32x32x16_bf16 v[160:175], a[236:239], v[204:207], v[160:175]
    v_cvt_pk_bf16_f32 v99, v134, v135
    v_exp_f32 v144, v144
    v_exp_f32 v145, v145
    ds_read_b64_tr_b16 a[204:205], v35
    v_mfma_f32_32x32x16_bf16 v[176:191], a[236:239], v[236:239], v[176:191]
    v_exp_f32 v146, v146
    v_exp_f32 v147, v147
    v_exp_f32 v148, v148
    v_mfma_f32_32x32x16_bf16 v[160:175], a[240:243], v[208:211], v[160:175]
    v_exp_f32 v149, v149
    v_exp_f32 v150, v150
    v_exp_f32 v151, v151
    v_mfma_f32_32x32x16_bf16 v[176:191], a[240:243], v[240:243], v[176:191]
    v_cvt_pk_bf16_f32 v104, v144, v145
    v_cvt_pk_bf16_f32 v105, v146, v147
    v_cvt_pk_bf16_f32 v106, v148, v149
    v_cvt_pk_bf16_f32 v107, v150, v151
    ds_read_b64_tr_b16 a[206:207], v35 offset:1024
    v_add_f32 v48, v48, v128
    v_mfma_f32_32x32x16_bf16 v[160:175], a[244:247], v[212:215], v[160:175]
    ds_read_b64_tr_b16 a[208:209], v32 offset:4096
    v_exp_f32 v136, v136
    ds_read_b64_tr_b16 a[210:211], v32 offset:5120
    v_exp_f32 v137, v137
    v_mfma_f32_32x32x16_bf16 v[176:191], a[244:247], v[244:247], v[176:191]
    ds_read_b64_tr_b16 a[212:213], v33 offset:4096
    v_exp_f32 v138, v138
    ds_read_b64_tr_b16 a[214:215], v33 offset:5120
    v_exp_f32 v139, v139
    v_mfma_f32_32x32x16_bf16 v[160:175], a[248:251], v[216:219], v[160:175]
    v_exp_f32 v140, v140
    v_exp_f32 v141, v141
    v_exp_f32 v142, v142
    v_mfma_f32_32x32x16_bf16 v[176:191], a[248:251], v[248:251], v[176:191]
    v_exp_f32 v143, v143
    ds_read_b64_tr_b16 a[216:217], v34 offset:4096
    v_cvt_pk_bf16_f32 v100, v136, v137
    ds_read_b64_tr_b16 a[218:219], v34 offset:5120
    s_waitcnt lgkmcnt(7)
    v_mfma_f32_32x32x16_bf16 v[160:175], a[252:255], v[220:223], v[160:175]
    v_cvt_pk_bf16_f32 v101, v138, v139
    v_cvt_pk_bf16_f32 v102, v140, v141
    v_cvt_pk_bf16_f32 v103, v142, v143
    v_exp_f32 v152, v152
    ds_read_b64_tr_b16 a[220:221], v35 offset:4096
    v_mfma_f32_32x32x16_bf16 v[176:191], a[252:255], v[252:255], v[176:191]
    v_exp_f32 v153, v153
    v_exp_f32 v154, v154
    v_exp_f32 v155, v155
    v_mfma_f32_32x32x16_bf16 a[0:15], a[192:195], v[96:99], a[0:15]
    v_exp_f32 v156, v156
    v_exp_f32 v157, v157
    v_exp_f32 v158, v158
    v_mfma_f32_32x32x16_bf16 a[64:79], a[192:195], v[104:107], a[64:79]
    v_exp_f32 v159, v159
    v_cvt_pk_bf16_f32 v108, v152, v153
    v_cvt_pk_bf16_f32 v109, v154, v155
    v_cvt_pk_bf16_f32 v110, v156, v157
    v_cvt_pk_bf16_f32 v111, v158, v159
    v_mfma_f32_32x32x16_bf16 a[16:31], a[196:199], v[96:99], a[16:31]
    ds_read_b64_tr_b16 a[222:223], v35 offset:5120
    v_max3_f32 v52, v160, v161, v162
    v_max3_f32 v52, v163, v164, v52
    v_max3_f32 v52, v165, v166, v52
    v_max3_f32 v52, v167, v168, v52
    v_max3_f32 v52, v169, v170, v52
    v_mfma_f32_32x32x16_bf16 a[80:95], a[196:199], v[104:107], a[80:95]
    v_max3_f32 v52, v171, v172, v52
    v_max3_f32 v52, v173, v174, v52
    v_max3_f32 v52, v175, v176, v52
    v_max3_f32 v52, v177, v178, v52
    v_add_f32 v49, v49, v129
    v_add_f32 v50, v50, v144
    v_mfma_f32_32x32x16_bf16 a[32:47], a[200:203], v[96:99], a[32:47]
    v_add_f32 v51, v51, v145
    v_max3_f32 v52, v179, v180, v52
    v_add_f32 v48, v48, v130
    v_add_f32 v49, v49, v131
    v_add_f32 v50, v50, v146
    v_add_f32 v51, v51, v147
    v_mfma_f32_32x32x16_bf16 a[96:111], a[200:203], v[104:107], a[96:111]
    v_max3_f32 v52, v181, v182, v52
    v_add_f32 v48, v48, v132
    v_add_f32 v49, v49, v133
    v_add_f32 v50, v50, v148
    v_add_f32 v51, v51, v149
    s_waitcnt lgkmcnt(1)
    v_mfma_f32_32x32x16_bf16 a[48:63], a[204:207], v[96:99], a[48:63]
    v_max3_f32 v52, v183, v184, v52
    v_add_f32 v48, v48, v134
    v_add_f32 v49, v49, v135
    v_add_f32 v50, v50, v150
    v_add_f32 v51, v51, v151
    v_max3_f32 v52, v185, v186, v52
    v_mfma_f32_32x32x16_bf16 a[112:127], a[204:207], v[104:107], a[112:127]
    v_add_f32 v48, v48, v136
    v_add_f32 v49, v49, v137
    v_add_f32 v50, v50, v152
    v_add_f32 v51, v51, v153
    v_max3_f32 v52, v187, v188, v52
    v_add_f32 v48, v48, v138
    v_mfma_f32_32x32x16_bf16 a[0:15], a[208:211], v[100:103], a[0:15]
    v_add_f32 v49, v49, v139
    v_add_f32 v50, v50, v154
    v_add_f32 v51, v51, v155
    v_max3_f32 v52, v189, v190, v52
    v_add_f32 v48, v48, v140
    v_add_f32 v49, v49, v141
    v_mfma_f32_32x32x16_bf16 a[64:79], a[208:211], v[108:111], a[64:79]
    v_add_f32 v50, v50, v156
    v_add_f32 v51, v51, v157
    v_max_f32 v52, v191, v52
    v_add_f32 v48, v48, v142
    v_add_f32 v49, v49, v143
    v_add_f32 v50, v50, v158
    v_mfma_f32_32x32x16_bf16 a[16:31], a[212:215], v[100:103], a[16:31]
    v_add_f32 v51, v51, v159
    v_cmp_lt_f32 vcc, v57, v52
    v_and_b32 v112, 31, v0
    v_lshrrev_b32 v113, 5, v0
    v_bfe_u32 v117, v112, 1, 3
    v_xor_b32 v117, v117, v113
    v_mfma_f32_32x32x16_bf16 a[80:95], a[212:215], v[108:111], a[80:95]
    v_lshlrev_b32 v117, 4, v117
    v_lshl_add_u32 v117, v112, 7, v117
    v_add_u32 v117, s48, v117
    v_xor_b32 v4, 0, v117
    v_xor_b32 v5, 32, v117
    v_xor_b32 v6, 64, v117
    v_mfma_f32_32x32x16_bf16 a[32:47], a[216:219], v[100:103], a[32:47]
    v_xor_b32 v7, 0x60, v117
    v_bfe_u32 v115, v0, 2, 2
    v_lshrrev_b32 v120, 4, v0
    v_and_b32 v121, 15, v0
    s_lshr_b32 s0, s60, 1
    s_mul_i32 s60, s62, 3
    v_mfma_f32_32x32x16_bf16 a[96:111], a[216:219], v[108:111], a[96:111]
    s_add_u32 s60, s60, 1
    s_lshr_b32 s3, s60, 1
    s_and_b32 s3, s3, 1
    s_add_u32 s59, s59, s3
    s_mul_i32 s59, s59, 44
    s_waitcnt lgkmcnt(0)
    v_mfma_f32_32x32x16_bf16 a[48:63], a[220:223], v[100:103], a[48:63]
    s_lshl_b32 s3, s3, 5
    s_lshl_b32 s0, s0, 12
    s_lshl_b32 s58, s58, 11
    s_add_u32 s41, s0, s58
    s_lshr_b32 s0, s60, 2
    s_add_u32 s1, s1, s0
    v_mfma_f32_32x32x16_bf16 a[112:127], a[220:223], v[108:111], a[112:127]
    s_lshl_b32 s0, s1, 1
    s_and_b32 s58, s60, 1
    s_add_u32 s59, s59, s0
    s_add_u32 s59, s59, s58
    s_lshl_b32 s59, s59, 10
    s_cmp_lt_u32 s1, 22
    s_cselect_b32 s39, s59, 0x10000000
    s_lshl_b32 s1, s46, 6
    s_add_u32 s1, s1, s3
    s_lshl_b32 s1, s1, 1
    buffer_load_ushort v37, v39, s[16:19], s1 offen
    s_mul_i32 s1, s47, 3
    s_lshl_b32 s59, s46, 1
    s_cbranch_vccnz L_rare9
L_rare9_ret:
    v_exp_f32 v160, v160
    v_exp_f32 v161, v161
    v_exp_f32 v162, v162
    v_exp_f32 v163, v163
    v_exp_f32 v164, v164
    v_exp_f32 v165, v165
    v_exp_f32 v166, v166
    v_exp_f32 v167, v167
    v_cvt_pk_bf16_f32 v96, v160, v161
    v_cvt_pk_bf16_f32 v97, v162, v163
    v_cvt_pk_bf16_f32 v98, v164, v165
    v_cvt_pk_bf16_f32 v99, v166, v167
    v_exp_f32 v176, v176
    v_exp_f32 v177, v177
    s_waitcnt vmcnt(12)
    s_barrier
    buffer_store_dword v59, v58, s[4:7], s81 offen sc1
    s_lshl_b32 s81, s62, 12
    ds_read_b128 a[224:227], v24 offset:49152
    v_exp_f32 v178, v178
    buffer_load_dwordx4 v22, s[28:31], s87 offen lds
    ds_read_b128 a[228:231], v25 offset:49152
    v_exp_f32 v179, v179
    v_exp_f32 v180, v180
    ds_read_b128 a[232:235], v26 offset:49152
    v_exp_f32 v181, v181
    v_exp_f32 v182, v182
    ds_read_b128 a[236:239], v27 offset:49152
    v_exp_f32 v183, v183
    v_cvt_pk_bf16_f32 v104, v176, v177
    ds_read_b128 a[240:243], v28 offset:49152
    buffer_load_dwordx4 v22, s[28:31], s87 offen offset:1024 lds
    s_add_u32 m0, s48, 0
    s_lshr_b32 s87, s77, 1
    s_lshl_b32 s95, s87, 7
    s_add_u32 s95, s95, 0x81800
    s_add_u32 s28, s44, s67
    s_addc_u32 s29, s45, 0
    s_and_b32 s29, s29, 0xffff
    s_mov_b32 s30, 0x100000
    s_mov_b32 s31, 0x20000
    s_lshl_b32 s67, s76, 6
    s_add_u32 s67, s67, s68
    s_lshl_b32 s68, s79, 1
    s_add_u32 s67, s67, s68
    s_lshl_b32 s67, s67, 4
    s_waitcnt lgkmcnt(4)
    v_mfma_f32_32x32x16_bf16 v[128:143], a[224:227], v[192:195], v[64:79]
    s_lshl_b32 s68, s78, 2
    s_add_u32 s67, s67, s68
    s_lshl_b32 s68, s80, 1
    s_add_u32 s67, s67, s68
    s_lshl_b32 s67, s67, 11
    s_add_u32 s67, s67, 0x2000000
    v_mfma_f32_32x32x16_bf16 v[144:159], a[224:227], v[224:227], v[80:95]
    s_add_u32 s68, s67, 0
    ds_read_b128 a[244:247], v29 offset:49152
    v_cvt_pk_bf16_f32 v105, v178, v179
    v_cvt_pk_bf16_f32 v106, v180, v181
    v_cvt_pk_bf16_f32 v107, v182, v183
    s_waitcnt lgkmcnt(4)
    v_mfma_f32_32x32x16_bf16 v[128:143], a[228:231], v[196:199], v[128:143]
    ds_read_b128 a[248:251], v30 offset:49152
    v_exp_f32 v168, v168
    v_exp_f32 v169, v169
    ds_read_b128 a[252:255], v31 offset:49152
    v_mfma_f32_32x32x16_bf16 v[144:159], a[228:231], v[228:231], v[144:159]
    v_exp_f32 v170, v170
    ds_read_b64_tr_b16 a[192:193], v32 offset:24576
    v_exp_f32 v171, v171
    s_waitcnt lgkmcnt(5)
    v_mfma_f32_32x32x16_bf16 v[128:143], a[232:235], v[200:203], v[128:143]
    ds_read_b64_tr_b16 a[194:195], v32 offset:25600
    v_exp_f32 v172, v172
    ds_read_b64_tr_b16 a[196:197], v33 offset:24576
    v_exp_f32 v173, v173
    v_mfma_f32_32x32x16_bf16 v[144:159], a[232:235], v[232:235], v[144:159]
    ds_read_b64_tr_b16 a[198:199], v33 offset:25600
    v_exp_f32 v174, v174
    ds_read_b64_tr_b16 a[200:201], v34 offset:24576
    v_exp_f32 v175, v175
    v_mfma_f32_32x32x16_bf16 v[128:143], a[236:239], v[204:207], v[128:143]
    ds_read_b64_tr_b16 a[202:203], v34 offset:25600
    v_cvt_pk_bf16_f32 v100, v168, v169
    ds_read_b64_tr_b16 a[204:205], v35 offset:24576
    v_cvt_pk_bf16_f32 v101, v170, v171
    ds_read_b64_tr_b16 a[206:207], v35 offset:25600
    v_cvt_pk_bf16_f32 v102, v172, v173
    v_mfma_f32_32x32x16_bf16 v[144:159], a[236:239], v[236:239], v[144:159]
    ds_read_b64_tr_b16 a[208:209], v32 offset:28672
    v_cvt_pk_bf16_f32 v103, v174, v175
    ds_read_b64_tr_b16 a[210:211], v32 offset:29696
    v_exp_f32 v184, v184
    s_waitcnt lgkmcnt(12)
    v_mfma_f32_32x32x16_bf16 v[128:143], a[240:243], v[208:211], v[128:143]
    ds_read_b64_tr_b16 a[212:213], v33 offset:28672
    v_exp_f32 v185, v185
    ds_read_b64_tr_b16 a[214:215], v33 offset:29696
    v_exp_f32 v186, v186
    v_mfma_f32_32x32x16_bf16 v[144:159], a[240:243], v[240:243], v[144:159]
    ds_read_b64_tr_b16 a[216:217], v34 offset:28672
    v_exp_f32 v187, v187
    ds_read_b64_tr_b16 a[218:219], v34 offset:29696
    v_exp_f32 v188, v188
    v_mfma_f32_32x32x16_bf16 v[128:143], a[244:247], v[212:215], v[128:143]
    v_exp_f32 v189, v189
    v_exp_f32 v190, v190
    v_exp_f32 v191, v191
    v_mfma_f32_32x32x16_bf16 v[144:159], a[244:247], v[244:247], v[144:159]
    v_cvt_pk_bf16_f32 v108, v184, v185
    v_cvt_pk_bf16_f32 v109, v186, v187
    v_cvt_pk_bf16_f32 v110, v188, v189
    v_cvt_pk_bf16_f32 v111, v190, v191
    ds_read_b64_tr_b16 a[220:221], v35 offset:28672
    s_waitcnt lgkmcnt(10)
    v_mfma_f32_32x32x16_bf16 v[128:143], a[248:251], v[216:219], v[128:143]
    ds_read_b64_tr_b16 a[222:223], v35 offset:29696
    v_add_f32 v48, v48, v160
    v_add_f32 v49, v49, v161
    v_add_f32 v50, v50, v176
    v_add_f32 v51, v51, v177
    v_add_f32 v48, v48, v162
    v_mfma_f32_32x32x16_bf16 v[144:159], a[248:251], v[248:251], v[144:159]
    v_add_f32 v49, v49, v163
    v_add_f32 v50, v50, v178
    v_add_f32 v51, v51, v179
    v_add_f32 v48, v48, v164
    v_add_f32 v49, v49, v165
    v_add_f32 v50, v50, v180
    v_mfma_f32_32x32x16_bf16 v[128:143], a[252:255], v[220:223], v[128:143]
    v_add_f32 v51, v51, v181
    v_add_f32 v48, v48, v166
    v_add_f32 v49, v49, v167
    v_add_f32 v50, v50, v182
    v_add_f32 v51, v51, v183
    v_add_f32 v48, v48, v168
    v_mfma_f32_32x32x16_bf16 v[144:159], a[252:255], v[252:255], v[144:159]
    v_add_f32 v49, v49, v169
    v_add_f32 v50, v50, v184
    v_add_f32 v51, v51, v185
    v_add_f32 v48, v48, v170
    v_add_f32 v49, v49, v171
    v_max3_f32 v52, v128, v129, v130
    v_mfma_f32_32x32x16_bf16 a[0:15], a[192:195], v[96:99], a[0:15]
    s_barrier
    ds_read_b128 a[224:227], v24 offset:8192
    v_max3_f32 v52, v131, v132, v52
    v_mfma_f32_32x32x16_bf16 a[64:79], a[192:195], v[104:107], a[64:79]
    ds_read_b128 a[228:231], v25 offset:8192
    v_max3_f32 v52, v133, v134, v52
    v_max3_f32 v52, v135, v136, v52
    v_max3_f32 v52, v137, v138, v52
    v_max3_f32 v52, v139, v140, v52
    v_max3_f32 v52, v141, v142, v52
    v_mfma_f32_32x32x16_bf16 a[16:31], a[196:199], v[96:99], a[16:31]
    v_max3_f32 v52, v143, v144, v52
    v_max3_f32 v52, v145, v146, v52
    v_max3_f32 v52, v147, v148, v52
    v_max3_f32 v52, v149, v150, v52
    v_max3_f32 v52, v151, v152, v52
    v_max3_f32 v52, v153, v154, v52
    v_mfma_f32_32x32x16_bf16 a[80:95], a[196:199], v[104:107], a[80:95]
    v_max3_f32 v52, v155, v156, v52
    v_add_f32 v50, v50, v186
    v_add_f32 v51, v51, v187
    v_max3_f32 v52, v157, v158, v52
    v_add_f32 v48, v48, v172
    s_waitcnt lgkmcnt(2)
    v_mfma_f32_32x32x16_bf16 a[32:47], a[200:203], v[96:99], a[32:47]
    v_add_f32 v49, v49, v173
    v_add_f32 v50, v50, v188
    v_add_f32 v51, v51, v189
    v_max_f32 v52, v159, v52
    ds_read_b128 a[232:235], v26 offset:8192
    v_add_f32 v48, v48, v174
    v_mfma_f32_32x32x16_bf16 a[96:111], a[200:203], v[104:107], a[96:111]
    v_add_f32 v49, v49, v175
    v_add_f32 v50, v50, v190
    v_add_f32 v51, v51, v191
    v_cmp_lt_f32 vcc, v57, v52
    ds_read_b128 a[236:239], v27 offset:8192
    s_lshr_b32 s0, s60, 1
    v_mfma_f32_32x32x16_bf16 a[48:63], a[204:207], v[96:99], a[48:63]
    s_mul_i32 s60, s62, 3
    s_add_u32 s60, s60, 2
    s_lshr_b32 s3, s60, 1
    s_and_b32 s3, s3, 1
    s_add_u32 s59, s59, s3
    s_mul_i32 s59, s59, 44
    v_mfma_f32_32x32x16_bf16 a[112:127], a[204:207], v[104:107], a[112:127]
    s_lshl_b32 s3, s3, 5
    ds_read_b128 a[240:243], v28 offset:8192
    s_lshl_b32 s0, s0, 12
    s_lshl_b32 s58, s58, 11
    s_add_u32 s42, s0, s58
    s_lshr_b32 s0, s60, 2
    v_mfma_f32_32x32x16_bf16 a[0:15], a[208:211], v[100:103], a[0:15]
    s_add_u32 s1, s1, s0
    s_lshl_b32 s0, s1, 1
    s_and_b32 s58, s60, 1
    s_add_u32 s59, s59, s0
    s_add_u32 s59, s59, s58
    s_lshl_b32 s59, s59, 10
    v_mfma_f32_32x32x16_bf16 a[64:79], a[208:211], v[108:111], a[64:79]
    s_cmp_lt_u32 s1, 22
    s_cselect_b32 s40, s59, 0x10000000
    s_lshl_b32 s1, s46, 6
    s_add_u32 s1, s1, s3
    s_lshl_b32 s1, s1, 1
    buffer_load_ushort v38, v39, s[16:19], s1 offen
    v_mfma_f32_32x32x16_bf16 a[16:31], a[212:215], v[100:103], a[16:31]
    s_lshl_b32 s59, s46, 16
    ds_read_b128 a[244:247], v29 offset:8192
    s_lshr_b32 s0, s60, 1
    s_lshl_b32 s60, s78, 2
    s_lshl_b32 s0, s0, 12
    ds_read_b128 a[248:251], v30 offset:8192
    v_mfma_f32_32x32x16_bf16 a[80:95], a[212:215], v[108:111], a[80:95]
    s_lshl_b32 s58, s58, 11
    ds_read_b128 a[252:255], v31 offset:8192
    s_add_u32 s43, s0, s58
    s_mul_i32 s0, s62, 0x6000
    v_add_u32 v42, s0, v46
    s_mul_i32 s58, s62, 0x2c000
    v_mfma_f32_32x32x16_bf16 a[32:47], a[216:219], v[100:103], a[32:47]
    ds_read_b64_tr_b16 a[192:193], v32 offset:49152
    v_add_u32 v43, s41, v46
    ds_read_b64_tr_b16 a[194:195], v32 offset:50176
    v_add_u32 v44, s42, v46
    ds_read_b64_tr_b16 a[196:197], v33 offset:49152
    v_add_u32 v45, s43, v46
    v_mfma_f32_32x32x16_bf16 a[96:111], a[216:219], v[108:111], a[96:111]
    s_lshr_b32 s43, s62, 1
    s_lshl_b32 s43, s43, 6
    ds_read_b64_tr_b16 a[198:199], v33 offset:50176
    v_add_u32 v47, 0xc000, v43
    ds_read_b64_tr_b16 a[200:201], v34 offset:49152
    s_add_u32 s0, s38, 0xa00000
    v_mfma_f32_32x32x16_bf16 a[48:63], a[220:223], v[100:103], a[48:63]
    ds_read_b64_tr_b16 a[202:203], v34 offset:50176
    s_waitcnt vmcnt(5)
    v_lshlrev_b32 v36, 16, v36
    ds_read_b64_tr_b16 a[204:205], v35 offset:49152
    s_add_u32 s1, s39, 0xa00000
    ds_read_b64_tr_b16 a[206:207], v35 offset:50176
    v_mfma_f32_32x32x16_bf16 a[112:127], a[220:223], v[108:111], a[112:127]
    s_cbranch_vccnz L_rare10
L_rare10_ret:
    v_exp_f32 v128, v128
    v_exp_f32 v129, v129
    s_waitcnt lgkmcnt(11)
    v_mfma_f32_32x32x16_bf16 v[160:175], a[224:227], v[192:195], v[64:79]
    v_exp_f32 v130, v130
    v_exp_f32 v131, v131
    v_exp_f32 v132, v132
    v_mfma_f32_32x32x16_bf16 v[176:191], a[224:227], v[224:227], v[80:95]
    v_exp_f32 v133, v133
    v_exp_f32 v134, v134
    v_exp_f32 v135, v135
    v_mfma_f32_32x32x16_bf16 v[160:175], a[228:231], v[196:199], v[160:175]
    v_cvt_pk_bf16_f32 v96, v128, v129
    v_cvt_pk_bf16_f32 v97, v130, v131
    v_cvt_pk_bf16_f32 v98, v132, v133
    v_cvt_pk_bf16_f32 v99, v134, v135
    v_exp_f32 v144, v144
    v_mfma_f32_32x32x16_bf16 v[176:191], a[228:231], v[228:231], v[176:191]
    v_exp_f32 v145, v145
    v_exp_f32 v146, v146
    v_exp_f32 v147, v147
    v_mfma_f32_32x32x16_bf16 v[160:175], a[232:235], v[200:203], v[160:175]
    v_exp_f32 v148, v148
    v_exp_f32 v149, v149
    v_exp_f32 v150, v150
    v_mfma_f32_32x32x16_bf16 v[176:191], a[232:235], v[232:235], v[176:191]
    v_exp_f32 v151, v151
    v_cvt_pk_bf16_f32 v104, v144, v145
    v_cvt_pk_bf16_f32 v105, v146, v147
    v_cvt_pk_bf16_f32 v106, v148, v149
    v_cvt_pk_bf16_f32 v107, v150, v151
    v_mfma_f32_32x32x16_bf16 v[160:175], a[236:239], v[204:207], v[160:175]
    ds_read_b64_tr_b16 a[208:209], v32 offset:53248
    v_exp_f32 v136, v136
    ds_read_b64_tr_b16 a[210:211], v32 offset:54272
    v_exp_f32 v137, v137
    v_mfma_f32_32x32x16_bf16 v[176:191], a[236:239], v[236:239], v[176:191]
    ds_read_b64_tr_b16 a[212:213], v33 offset:53248
    v_exp_f32 v138, v138
    ds_read_b64_tr_b16 a[214:215], v33 offset:54272
    v_exp_f32 v139, v139
    v_mfma_f32_32x32x16_bf16 v[160:175], a[240:243], v[208:211], v[160:175]
    v_exp_f32 v140, v140
    v_exp_f32 v141, v141
    v_exp_f32 v142, v142
    v_mfma_f32_32x32x16_bf16 v[176:191], a[240:243], v[240:243], v[176:191]
    v_exp_f32 v143, v143
    ds_read_b64_tr_b16 a[216:217], v34 offset:53248
    v_cvt_pk_bf16_f32 v100, v136, v137
    ds_read_b64_tr_b16 a[218:219], v34 offset:54272
    s_waitcnt lgkmcnt(6)
    v_mfma_f32_32x32x16_bf16 v[160:175], a[244:247], v[212:215], v[160:175]
    v_cvt_pk_bf16_f32 v101, v138, v139
    v_cvt_pk_bf16_f32 v102, v140, v141
    v_cvt_pk_bf16_f32 v103, v142, v143
    v_exp_f32 v152, v152
    ds_read_b64_tr_b16 a[220:221], v35 offset:53248
    v_mfma_f32_32x32x16_bf16 v[176:191], a[244:247], v[244:247], v[176:191]
    v_exp_f32 v153, v153
    v_exp_f32 v154, v154
    v_exp_f32 v155, v155
    v_mfma_f32_32x32x16_bf16 v[160:175], a[248:251], v[216:219], v[160:175]
    v_exp_f32 v156, v156
    v_exp_f32 v157, v157
    v_exp_f32 v158, v158
    v_mfma_f32_32x32x16_bf16 v[176:191], a[248:251], v[248:251], v[176:191]
    v_exp_f32 v159, v159
    v_cvt_pk_bf16_f32 v108, v152, v153
    v_cvt_pk_bf16_f32 v109, v154, v155
    v_cvt_pk_bf16_f32 v110, v156, v157
    v_cvt_pk_bf16_f32 v111, v158, v159
    v_mfma_f32_32x32x16_bf16 v[160:175], a[252:255], v[220:223], v[160:175]
    ds_read_b64_tr_b16 a[222:223], v35 offset:54272
    v_add_f32 v48, v48, v128
    v_add_f32 v49, v49, v129
    v_add_f32 v50, v50, v144
    v_add_f32 v51, v51, v145
    v_add_f32 v48, v48, v130
    v_mfma_f32_32x32x16_bf16 v[176:191], a[252:255], v[252:255], v[176:191]
    v_add_f32 v49, v49, v131
    v_add_f32 v50, v50, v146
    v_add_f32 v51, v51, v147
    v_add_f32 v48, v48, v132
    v_add_f32 v49, v49, v133
    v_max3_f32 v52, v160, v161, v162
    v_mfma_f32_32x32x16_bf16 a[0:15], a[192:195], v[96:99], a[0:15]
    s_barrier
    ds_read_b128 a[224:227], v24 offset:32768
    v_max3_f32 v52, v163, v164, v52
    v_mfma_f32_32x32x16_bf16 a[64:79], a[192:195], v[104:107], a[64:79]
    ds_read_b128 a[228:231], v25 offset:32768
    v_max3_f32 v52, v165, v166, v52
    v_max3_f32 v52, v167, v168, v52
    v_max3_f32 v52, v169, v170, v52
    v_max3_f32 v52, v171, v172, v52
    v_max3_f32 v52, v173, v174, v52
    v_mfma_f32_32x32x16_bf16 a[16:31], a[196:199], v[96:99], a[16:31]
    v_max3_f32 v52, v175, v176, v52
    v_max3_f32 v52, v177, v178, v52
    v_max3_f32 v52, v179, v180, v52
    v_max3_f32 v52, v181, v182, v52
    v_add_f32 v50, v50, v148
    v_add_f32 v51, v51, v149
    v_mfma_f32_32x32x16_bf16 a[80:95], a[196:199], v[104:107], a[80:95]
    v_max3_f32 v52, v183, v184, v52
    v_add_f32 v48, v48, v134
    v_add_f32 v49, v49, v135
    v_add_f32 v50, v50, v150
    v_add_f32 v51, v51, v151
    v_max3_f32 v52, v185, v186, v52
    v_mfma_f32_32x32x16_bf16 a[32:47], a[200:203], v[96:99], a[32:47]
    v_add_f32 v48, v48, v136
    v_add_f32 v49, v49, v137
    v_add_f32 v50, v50, v152
    v_add_f32 v51, v51, v153
    v_max3_f32 v52, v187, v188, v52
    v_add_f32 v48, v48, v138
    v_mfma_f32_32x32x16_bf16 a[96:111], a[200:203], v[104:107], a[96:111]
    v_add_f32 v49, v49, v139
    v_add_f32 v50, v50, v154
    v_add_f32 v51, v51, v155
    v_max3_f32 v52, v189, v190, v52
    v_add_f32 v48, v48, v140
    v_add_f32 v49, v49, v141
    v_mfma_f32_32x32x16_bf16 a[48:63], a[204:207], v[96:99], a[48:63]
    v_add_f32 v50, v50, v156
    v_add_f32 v51, v51, v157
    v_max_f32 v52, v191, v52
    ds_read_b128 a[232:235], v26 offset:32768
    v_add_f32 v48, v48, v142
    v_add_f32 v49, v49, v143
    v_mfma_f32_32x32x16_bf16 a[112:127], a[204:207], v[104:107], a[112:127]
    v_add_f32 v50, v50, v158
    v_add_f32 v51, v51, v159
    v_cmp_lt_f32 vcc, v57, v52
    ds_read_b128 a[236:239], v27 offset:32768
    s_add_u32 s3, s40, 0xa00000
    s_waitcnt lgkmcnt(2)
    v_mfma_f32_32x32x16_bf16 a[0:15], a[208:211], v[100:103], a[0:15]
    ds_read_b128 a[240:243], v28 offset:32768
    s_waitcnt vmcnt(4)
    v_lshlrev_b32 v37, 16, v37
    s_mov_b32 s26, 0
    ds_read_b128 a[244:247], v29 offset:32768
    s_mov_b32 s27, 0x20000
    v_mfma_f32_32x32x16_bf16 a[64:79], a[208:211], v[108:111], a[64:79]
    ds_read_b128 a[248:251], v30 offset:32768
    ds_read_b128 a[252:255], v31 offset:32768
    v_mfma_f32_32x32x16_bf16 a[16:31], a[212:215], v[100:103], a[16:31]
    ds_read_b64_tr_b16 a[192:193], v32 offset:57344
    ds_read_b64_tr_b16 a[194:195], v32 offset:58368
    ds_read_b64_tr_b16 a[196:197], v33 offset:57344
    v_mfma_f32_32x32x16_bf16 a[80:95], a[212:215], v[108:111], a[80:95]
    ds_read_b64_tr_b16 a[198:199], v33 offset:58368
    ds_read_b64_tr_b16 a[200:201], v34 offset:57344
    ds_read_b64_tr_b16 a[202:203], v34 offset:58368
    v_mfma_f32_32x32x16_bf16 a[32:47], a[216:219], v[100:103], a[32:47]
    ds_read_b64_tr_b16 a[204:205], v35 offset:57344
    ds_read_b64_tr_b16 a[206:207], v35 offset:58368
    ds_read_b64_tr_b16 a[208:209], v32 offset:61440
    v_mfma_f32_32x32x16_bf16 a[96:111], a[216:219], v[108:111], a[96:111]
    ds_read_b64_tr_b16 a[210:211], v32 offset:62464
    ds_read_b64_tr_b16 a[212:213], v33 offset:61440
    ds_read_b64_tr_b16 a[214:215], v33 offset:62464
    v_mfma_f32_32x32x16_bf16 a[48:63], a[220:223], v[100:103], a[48:63]
    ds_read_b64_tr_b16 a[216:217], v34 offset:61440
    ds_read_b64_tr_b16 a[218:219], v34 offset:62464
    v_mfma_f32_32x32x16_bf16 a[112:127], a[220:223], v[108:111], a[112:127]
    s_cbranch_vccnz L_rare11
L_rare11_ret:
    v_exp_f32 v160, v160
    v_exp_f32 v161, v161
    ds_read_b64_tr_b16 a[220:221], v35 offset:61440
    v_mfma_f32_32x32x16_bf16 v[128:143], a[224:227], v[192:195], v[64:79]
    v_exp_f32 v162, v162
    v_exp_f32 v163, v163
    v_exp_f32 v164, v164
    v_mfma_f32_32x32x16_bf16 v[144:159], a[224:227], v[224:227], v[80:95]
    v_exp_f32 v165, v165
    v_exp_f32 v166, v166
    v_exp_f32 v167, v167
    v_mfma_f32_32x32x16_bf16 v[128:143], a[228:231], v[196:199], v[128:143]
    v_cvt_pk_bf16_f32 v96, v160, v161
    v_cvt_pk_bf16_f32 v97, v162, v163
    v_cvt_pk_bf16_f32 v98, v164, v165
    v_cvt_pk_bf16_f32 v99, v166, v167
    v_exp_f32 v176, v176
    v_mfma_f32_32x32x16_bf16 v[144:159], a[228:231], v[228:231], v[144:159]
    v_exp_f32 v177, v177
    v_exp_f32 v178, v178
    v_cvt_pk_bf16_f32 v104, v176, v177
    s_waitcnt lgkmcnt(4)
    v_mfma_f32_32x32x16_bf16 v[128:143], a[232:235], v[200:203], v[128:143]
    v_exp_f32 v179, v179
    v_exp_f32 v180, v180
    v_exp_f32 v181, v181
    v_mfma_f32_32x32x16_bf16 v[144:159], a[232:235], v[232:235], v[144:159]
    s_barrier
    buffer_load_dword v1, v61, s[4:7], s92 offen sc1
    v_cvt_pk_bf16_f32 v105, v178, v179
    v_mfma_f32_32x32x16_bf16 v[128:143], a[236:239], v[204:207], v[128:143]
    v_exp_f32 v182, v182
    v_exp_f32 v183, v183
    v_cvt_pk_bf16_f32 v106, v180, v181
    v_cvt_pk_bf16_f32 v107, v182, v183
    v_mfma_f32_32x32x16_bf16 v[144:159], a[236:239], v[236:239], v[144:159]
    v_exp_f32 v168, v168
    v_exp_f32 v169, v169
    v_exp_f32 v170, v170
    v_mfma_f32_32x32x16_bf16 v[128:143], a[240:243], v[208:211], v[128:143]
    v_exp_f32 v171, v171
    v_exp_f32 v172, v172
    v_exp_f32 v173, v173
    v_mfma_f32_32x32x16_bf16 v[144:159], a[240:243], v[240:243], v[144:159]
    v_exp_f32 v174, v174
    v_exp_f32 v175, v175
    v_cvt_pk_bf16_f32 v100, v168, v169
    v_cvt_pk_bf16_f32 v101, v170, v171
    v_mfma_f32_32x32x16_bf16 v[128:143], a[244:247], v[212:215], v[128:143]
    v_cvt_pk_bf16_f32 v102, v172, v173
    v_cvt_pk_bf16_f32 v103, v174, v175
    v_exp_f32 v184, v184
    v_exp_f32 v185, v185
    v_mfma_f32_32x32x16_bf16 v[144:159], a[244:247], v[244:247], v[144:159]
    v_exp_f32 v186, v186
    v_exp_f32 v187, v187
    v_exp_f32 v188, v188
    v_mfma_f32_32x32x16_bf16 v[128:143], a[248:251], v[216:219], v[128:143]
    v_exp_f32 v189, v189
    v_exp_f32 v190, v190
    v_exp_f32 v191, v191
    v_mfma_f32_32x32x16_bf16 v[144:159], a[248:251], v[248:251], v[144:159]
    v_cvt_pk_bf16_f32 v108, v184, v185
    v_cvt_pk_bf16_f32 v109, v186, v187
    v_cvt_pk_bf16_f32 v110, v188, v189
    v_cvt_pk_bf16_f32 v111, v190, v191
    ds_read_b64_tr_b16 a[222:223], v35 offset:62464
    v_add_f32 v48, v48, v160
    v_mfma_f32_32x32x16_bf16 v[128:143], a[252:255], v[220:223], v[128:143]
    ds_read_b128 a[224:227], v24 offset:57344
    v_add_f32 v49, v49, v161
    v_add_f32 v50, v50, v176
    v_add_f32 v51, v51, v177
    ds_read_b128 a[228:231], v25 offset:57344
    v_add_f32 v48, v48, v162
    v_mfma_f32_32x32x16_bf16 v[144:159], a[252:255], v[252:255], v[144:159]
    v_add_f32 v49, v49, v163
    v_add_f32 v50, v50, v178
    v_add_f32 v51, v51, v179
    v_add_f32 v48, v48, v164
    v_add_f32 v49, v49, v165
    v_max3_f32 v52, v128, v129, v130
    v_mfma_f32_32x32x16_bf16 a[0:15], a[192:195], v[96:99], a[0:15]
    v_max3_f32 v52, v131, v132, v52
    v_max3_f32 v52, v133, v134, v52
    v_max3_f32 v52, v135, v136, v52
    v_max3_f32 v52, v137, v138, v52
    v_max3_f32 v52, v139, v140, v52
    v_max3_f32 v52, v141, v142, v52
    v_mfma_f32_32x32x16_bf16 a[64:79], a[192:195], v[104:107], a[64:79]
    v_max3_f32 v52, v143, v144, v52
    v_max3_f32 v52, v145, v146, v52
    v_max3_f32 v52, v147, v148, v52
    v_max3_f32 v52, v149, v150, v52
    v_add_f32 v50, v50, v180
    v_add_f32 v51, v51, v181
    v_mfma_f32_32x32x16_bf16 a[16:31], a[196:199], v[96:99], a[16:31]
    v_max3_f32 v52, v151, v152, v52
    v_add_f32 v48, v48, v166
    v_add_f32 v49, v49, v167
    v_add_f32 v50, v50, v182
    v_add_f32 v51, v51, v183
    v_max3_f32 v52, v153, v154, v52
    v_mfma_f32_32x32x16_bf16 a[80:95], a[196:199], v[104:107], a[80:95]
    v_add_f32 v48, v48, v168
    v_add_f32 v49, v49, v169
    v_add_f32 v50, v50, v184
    v_add_f32 v51, v51, v185
    v_max3_f32 v52, v155, v156, v52
    v_add_f32 v48, v48, v170
    v_mfma_f32_32x32x16_bf16 a[32:47], a[200:203], v[96:99], a[32:47]
    v_add_f32 v49, v49, v171
    v_add_f32 v50, v50, v186
    v_add_f32 v51, v51, v187
    v_max3_f32 v52, v157, v158, v52
    v_add_f32 v48, v48, v172
    v_add_f32 v49, v49, v173
    v_mfma_f32_32x32x16_bf16 a[96:111], a[200:203], v[104:107], a[96:111]
    v_add_f32 v50, v50, v188
    v_add_f32 v51, v51, v189
    v_max_f32 v52, v159, v52
    ds_read_b128 a[232:235], v26 offset:57344
    v_add_f32 v48, v48, v174
    v_add_f32 v49, v49, v175
    v_mfma_f32_32x32x16_bf16 a[48:63], a[204:207], v[96:99], a[48:63]
    v_add_f32 v50, v50, v190
    v_add_f32 v51, v51, v191
    v_cmp_lt_f32 vcc, v57, v52
    ds_read_b128 a[236:239], v27 offset:57344
    buffer_load_dwordx4 a[172:175], v46, s[32:35], s73 offen
    v_mfma_f32_32x32x16_bf16 a[112:127], a[204:207], v[104:107], a[112:127]
    ds_read_b128 a[240:243], v28 offset:57344
    s_waitcnt vmcnt(2)
    v_lshlrev_b32 v38, 16, v38
    ds_read_b128 a[244:247], v29 offset:57344
    v_mfma_f32_32x32x16_bf16 a[0:15], a[208:211], v[100:103], a[0:15]
    ds_read_b128 a[248:251], v30 offset:57344
    ds_read_b128 a[252:255], v31 offset:57344
    buffer_load_dwordx4 a[172:175], v46, s[32:35], s73 offen offset:1024
    v_mfma_f32_32x32x16_bf16 a[64:79], a[208:211], v[108:111], a[64:79]
    ds_read_b64_tr_b16 a[192:193], v32 offset:8192
    ds_read_b64_tr_b16 a[194:195], v32 offset:9216
    ds_read_b64_tr_b16 a[196:197], v33 offset:8192
    s_waitcnt lgkmcnt(9)
    v_mfma_f32_32x32x16_bf16 a[16:31], a[212:215], v[100:103], a[16:31]
    ds_read_b64_tr_b16 a[198:199], v33 offset:9216
    ds_read_b64_tr_b16 a[200:201], v34 offset:8192
    ds_read_b64_tr_b16 a[202:203], v34 offset:9216
    buffer_load_dwordx4 a[172:175], v46, s[32:35], s73 offen offset:2048
    v_mfma_f32_32x32x16_bf16 a[80:95], a[212:215], v[108:111], a[80:95]
    ds_read_b64_tr_b16 a[204:205], v35 offset:8192
    ds_read_b64_tr_b16 a[206:207], v35 offset:9216
    ds_read_b64_tr_b16 a[208:209], v32 offset:12288
    v_mfma_f32_32x32x16_bf16 a[32:47], a[216:219], v[100:103], a[32:47]
    ds_read_b64_tr_b16 a[210:211], v32 offset:13312
    ds_read_b64_tr_b16 a[212:213], v33 offset:12288
    ds_read_b64_tr_b16 a[214:215], v33 offset:13312
    buffer_load_dwordx4 a[172:175], v46, s[32:35], s73 offen offset:3072
    v_mfma_f32_32x32x16_bf16 a[96:111], a[216:219], v[108:111], a[96:111]
    ds_read_b64_tr_b16 a[216:217], v34 offset:12288
    s_lshl_b32 s73, s2, 2
    ds_read_b64_tr_b16 a[218:219], v34 offset:13312
    s_add_u32 s73, s73, s62
    s_mov_b32 s32, s54
    s_and_b32 s33, s55, 0xffff
    v_mfma_f32_32x32x16_bf16 a[48:63], a[220:223], v[100:103], a[48:63]
    s_mov_b32 s34, 0xac000
    s_mov_b32 s35, 0x20000
    s_lshl_b32 s73, s73, 10
    v_mfma_f32_32x32x16_bf16 a[112:127], a[220:223], v[108:111], a[112:127]
    s_cbranch_vccnz L_rare12
L_rare12_ret:
    v_exp_f32 v128, v128
    v_exp_f32 v129, v129
    ds_read_b64_tr_b16 a[220:221], v35 offset:12288
    v_mfma_f32_32x32x16_bf16 v[160:175], a[224:227], v[192:195], v[64:79]
    v_exp_f32 v130, v130
    v_exp_f32 v131, v131
    v_exp_f32 v132, v132
    v_mfma_f32_32x32x16_bf16 v[176:191], a[224:227], v[224:227], v[80:95]
    v_exp_f32 v133, v133
    v_exp_f32 v134, v134
    v_exp_f32 v135, v135
    v_mfma_f32_32x32x16_bf16 v[160:175], a[228:231], v[196:199], v[160:175]
    v_cvt_pk_bf16_f32 v96, v128, v129
    v_cvt_pk_bf16_f32 v97, v130, v131
    v_cvt_pk_bf16_f32 v98, v132, v133
    v_cvt_pk_bf16_f32 v99, v134, v135
    v_exp_f32 v144, v144
    v_mfma_f32_32x32x16_bf16 v[176:191], a[228:231], v[228:231], v[176:191]
    v_exp_f32 v145, v145
    v_exp_f32 v146, v146
    v_cvt_pk_bf16_f32 v104, v144, v145
    s_waitcnt lgkmcnt(1)
    v_mfma_f32_32x32x16_bf16 v[160:175], a[232:235], v[200:203], v[160:175]
    v_exp_f32 v147, v147
    v_exp_f32 v148, v148
    v_exp_f32 v149, v149
    v_mfma_f32_32x32x16_bf16 v[176:191], a[232:235], v[232:235], v[176:191]
    v_exp_f32 v150, v150
    v_exp_f32 v151, v151
    v_cvt_pk_bf16_f32 v105, v146, v147
    v_cvt_pk_bf16_f32 v106, v148, v149
    v_mfma_f32_32x32x16_bf16 v[160:175], a[236:239], v[204:207], v[160:175]
    v_cvt_pk_bf16_f32 v107, v150, v151
    v_exp_f32 v136, v136
    v_exp_f32 v137, v137
    ds_read_b64_tr_b16 a[222:223], v35 offset:13312
    v_mfma_f32_32x32x16_bf16 v[176:191], a[236:239], v[236:239], v[176:191]
    v_exp_f32 v138, v138
    v_exp_f32 v139, v139
    v_exp_f32 v140, v140
    v_mfma_f32_32x32x16_bf16 v[160:175], a[240:243], v[208:211], v[160:175]
    v_exp_f32 v141, v141
    v_exp_f32 v142, v142
    v_exp_f32 v143, v143
    v_mfma_f32_32x32x16_bf16 v[176:191], a[240:243], v[240:243], v[176:191]
    v_cvt_pk_bf16_f32 v100, v136, v137
    v_cvt_pk_bf16_f32 v101, v138, v139
    v_cvt_pk_bf16_f32 v102, v140, v141
    v_cvt_pk_bf16_f32 v103, v142, v143
    v_exp_f32 v152, v152
    v_mfma_f32_32x32x16_bf16 v[160:175], a[244:247], v[212:215], v[160:175]
    v_exp_f32 v153, v153
    v_exp_f32 v154, v154
    v_exp_f32 v155, v155
    v_mfma_f32_32x32x16_bf16 v[176:191], a[244:247], v[244:247], v[176:191]
    v_exp_f32 v156, v156
    v_exp_f32 v157, v157
    v_exp_f32 v158, v158
    v_mfma_f32_32x32x16_bf16 v[160:175], a[248:251], v[216:219], v[160:175]
    v_exp_f32 v159, v159
    v_cvt_pk_bf16_f32 v108, v152, v153
    v_cvt_pk_bf16_f32 v109, v154, v155
    v_cvt_pk_bf16_f32 v110, v156, v157
    v_cvt_pk_bf16_f32 v111, v158, v159
    v_mfma_f32_32x32x16_bf16 v[176:191], a[248:251], v[248:251], v[176:191]
    v_add_f32 v48, v48, v128
    v_add_f32 v49, v49, v129
    v_add_f32 v50, v50, v144
    v_add_f32 v51, v51, v145
    v_add_f32 v48, v48, v130
    v_add_f32 v49, v49, v131
    v_mfma_f32_32x32x16_bf16 v[160:175], a[252:255], v[220:223], v[160:175]
    v_add_f32 v50, v50, v146
    v_add_f32 v51, v51, v147
    v_add_f32 v48, v48, v132
    v_add_f32 v49, v49, v133
    v_add_f32 v50, v50, v148
    v_add_f32 v51, v51, v149
    v_mfma_f32_32x32x16_bf16 v[176:191], a[252:255], v[252:255], v[176:191]
    v_add_f32 v48, v48, v134
    v_add_f32 v49, v49, v135
    v_add_f32 v50, v50, v150
    v_add_f32 v51, v51, v151
    v_add_f32 v48, v48, v136
    v_max3_f32 v52, v160, v161, v162
    v_mfma_f32_32x32x16_bf16 a[0:15], a[192:195], v[96:99], a[0:15]
    s_barrier
    ds_read_b128 a[224:227], v24 offset:40960
    v_max3_f32 v52, v163, v164, v52
    v_mfma_f32_32x32x16_bf16 a[64:79], a[192:195], v[104:107], a[64:79]
    ds_read_b128 a[228:231], v25 offset:40960
    v_max3_f32 v52, v165, v166, v52
    v_max3_f32 v52, v167, v168, v52
    v_max3_f32 v52, v169, v170, v52
    v_max3_f32 v52, v171, v172, v52
    v_max3_f32 v52, v173, v174, v52
    v_mfma_f32_32x32x16_bf16 a[16:31], a[196:199], v[96:99], a[16:31]
    v_max3_f32 v52, v175, v176, v52
    v_max3_f32 v52, v177, v178, v52
    v_max3_f32 v52, v179, v180, v52
    v_max3_f32 v52, v181, v182, v52
    v_max3_f32 v52, v183, v184, v52
    v_max3_f32 v52, v185, v186, v52
    v_mfma_f32_32x32x16_bf16 a[80:95], a[196:199], v[104:107], a[80:95]
    v_add_f32 v49, v49, v137
    v_add_f32 v50, v50, v152
    v_add_f32 v51, v51, v153
    v_max3_f32 v52, v187, v188, v52
    v_add_f32 v48, v48, v138
    v_add_f32 v49, v49, v139
    v_mfma_f32_32x32x16_bf16 a[32:47], a[200:203], v[96:99], a[32:47]
    v_add_f32 v50, v50, v154
    v_add_f32 v51, v51, v155
    v_max3_f32 v52, v189, v190, v52
    s_waitcnt vmcnt(4)
    v_cmp_ne_u32 vcc, v59, v1
    v_add_f32 v48, v48, v140
    v_mfma_f32_32x32x16_bf16 a[96:111], a[200:203], v[104:107], a[96:111]
    s_cbranch_vccnz L_slow_z2n
L_ret_z2n:
    v_add_f32 v49, v49, v141
    v_add_f32 v50, v50, v156
    v_add_f32 v51, v51, v157
    v_max_f32 v52, v191, v52
    ds_read_b128 a[232:235], v26 offset:40960
    v_mfma_f32_32x32x16_bf16 a[48:63], a[204:207], v[96:99], a[48:63]
    v_add_f32 v48, v48, v142
    v_add_f32 v49, v49, v143
    v_add_f32 v50, v50, v158
    v_add_f32 v51, v51, v159
    v_cmp_lt_f32 vcc, v57, v52
    ds_read_b128 a[236:239], v27 offset:40960
    v_mfma_f32_32x32x16_bf16 a[112:127], a[204:207], v[104:107], a[112:127]
    buffer_load_dwordx4 a[172:175], v46, s[32:35], s73 offen
    s_mov_b32 s73, 0x2f800
    s_mov_b32 s35, 0x20000
    ds_read_b128 a[240:243], v28 offset:40960
    s_lshl_b32 s92, s62, 13
    s_add_u32 s92, s92, 0x20000
    v_mfma_f32_32x32x16_bf16 a[0:15], a[208:211], v[100:103], a[0:15]
    s_lshl_b32 s92, s63, 7
    s_add_u32 s92, s92, 0x81800
    ds_read_b128 a[244:247], v29 offset:40960
    s_mov_b32 s34, 0
    v_mfma_f32_32x32x16_bf16 a[64:79], a[208:211], v[108:111], a[64:79]
    ds_read_b128 a[248:251], v30 offset:40960
    ds_read_b128 a[252:255], v31 offset:40960
    v_mfma_f32_32x32x16_bf16 a[16:31], a[212:215], v[100:103], a[16:31]
    ds_read_b64_tr_b16 a[192:193], v32 offset:16384
    ds_read_b64_tr_b16 a[194:195], v32 offset:17408
    ds_read_b64_tr_b16 a[196:197], v33 offset:16384
    v_mfma_f32_32x32x16_bf16 a[80:95], a[212:215], v[108:111], a[80:95]
    ds_read_b64_tr_b16 a[198:199], v33 offset:17408
    ds_read_b64_tr_b16 a[200:201], v34 offset:16384
    ds_read_b64_tr_b16 a[202:203], v34 offset:17408
    v_mfma_f32_32x32x16_bf16 a[32:47], a[216:219], v[100:103], a[32:47]
    ds_read_b64_tr_b16 a[204:205], v35 offset:16384
    ds_read_b64_tr_b16 a[206:207], v35 offset:17408
    ds_read_b64_tr_b16 a[208:209], v32 offset:20480
    v_mfma_f32_32x32x16_bf16 a[96:111], a[216:219], v[108:111], a[96:111]
    ds_read_b64_tr_b16 a[210:211], v32 offset:21504
    ds_read_b64_tr_b16 a[212:213], v33 offset:20480
    ds_read_b64_tr_b16 a[214:215], v33 offset:21504
    s_waitcnt lgkmcnt(15)
    v_mfma_f32_32x32x16_bf16 a[48:63], a[220:223], v[100:103], a[48:63]
    ds_read_b64_tr_b16 a[216:217], v34 offset:20480
    ds_read_b64_tr_b16 a[218:219], v34 offset:21504
    v_mfma_f32_32x32x16_bf16 a[112:127], a[220:223], v[108:111], a[112:127]
    s_cbranch_vccnz L_rare13
L_rare13_ret:
    v_exp_f32 v160, v160
    v_exp_f32 v161, v161
    ds_read_b64_tr_b16 a[220:221], v35 offset:20480
    v_mfma_f32_32x32x16_bf16 v[128:143], a[224:227], v[192:195], v[64:79]
    v_exp_f32 v162, v162
    v_exp_f32 v163, v163
    v_exp_f32 v164, v164
    v_mfma_f32_32x32x16_bf16 v[144:159], a[224:227], v[224:227], v[80:95]
    v_exp_f32 v165, v165
    v_exp_f32 v166, v166
    v_exp_f32 v167, v167
    v_mfma_f32_32x32x16_bf16 v[128:143], a[228:231], v[196:199], v[128:143]
    v_cvt_pk_bf16_f32 v96, v160, v161
    v_cvt_pk_bf16_f32 v97, v162, v163
    v_cvt_pk_bf16_f32 v98, v164, v165
    v_cvt_pk_bf16_f32 v99, v166, v167
    v_exp_f32 v176, v176
    v_mfma_f32_32x32x16_bf16 v[144:159], a[228:231], v[228:231], v[144:159]
    v_exp_f32 v177, v177
    v_exp_f32 v178, v178
    v_exp_f32 v179, v179
    v_mfma_f32_32x32x16_bf16 v[128:143], a[232:235], v[200:203], v[128:143]
    v_exp_f32 v180, v180
    v_exp_f32 v181, v181
    v_exp_f32 v182, v182
    v_mfma_f32_32x32x16_bf16 v[144:159], a[232:235], v[232:235], v[144:159]
    v_exp_f32 v183, v183
    v_cvt_pk_bf16_f32 v104, v176, v177
    v_cvt_pk_bf16_f32 v105, v178, v179
    v_cvt_pk_bf16_f32 v106, v180, v181
    v_cvt_pk_bf16_f32 v107, v182, v183
    v_mfma_f32_32x32x16_bf16 v[128:143], a[236:239], v[204:207], v[128:143]
    ds_read_b64_tr_b16 a[222:223], v35 offset:21504
    v_exp_f32 v168, v168
    v_exp_f32 v169, v169
    v_add_f32 v48, v48, v160
    v_mfma_f32_32x32x16_bf16 v[144:159], a[236:239], v[236:239], v[144:159]
    v_exp_f32 v170, v170
    v_exp_f32 v171, v171
    v_exp_f32 v172, v172
    v_mfma_f32_32x32x16_bf16 v[128:143], a[240:243], v[208:211], v[128:143]
    v_exp_f32 v173, v173
    v_exp_f32 v174, v174
    v_exp_f32 v175, v175
    v_mfma_f32_32x32x16_bf16 v[144:159], a[240:243], v[240:243], v[144:159]
    v_cvt_pk_bf16_f32 v100, v168, v169
    v_cvt_pk_bf16_f32 v101, v170, v171
    v_cvt_pk_bf16_f32 v102, v172, v173
    v_cvt_pk_bf16_f32 v103, v174, v175
    v_add_f32 v49, v49, v161
    s_waitcnt lgkmcnt(1)
    v_mfma_f32_32x32x16_bf16 v[128:143], a[244:247], v[212:215], v[128:143]
    v_exp_f32 v184, v184
    v_exp_f32 v185, v185
    v_exp_f32 v186, v186
    v_mfma_f32_32x32x16_bf16 v[144:159], a[244:247], v[244:247], v[144:159]
    v_exp_f32 v187, v187
    v_exp_f32 v188, v188
    v_exp_f32 v189, v189
    v_mfma_f32_32x32x16_bf16 v[128:143], a[248:251], v[216:219], v[128:143]
    v_exp_f32 v190, v190
    v_exp_f32 v191, v191
    v_cvt_pk_bf16_f32 v108, v184, v185
    v_cvt_pk_bf16_f32 v109, v186, v187
    v_mfma_f32_32x32x16_bf16 v[144:159], a[248:251], v[248:251], v[144:159]
    v_cvt_pk_bf16_f32 v110, v188, v189
    v_cvt_pk_bf16_f32 v111, v190, v191
    v_add_f32 v50, v50, v176
    v_add_f32 v51, v51, v177
    v_add_f32 v48, v48, v162
    v_add_f32 v49, v49, v163
    v_mfma_f32_32x32x16_bf16 v[128:143], a[252:255], v[220:223], v[128:143]
    v_add_f32 v50, v50, v178
    v_add_f32 v51, v51, v179
    v_add_f32 v48, v48, v164
    v_add_f32 v49, v49, v165
    v_add_f32 v50, v50, v180
    v_add_f32 v51, v51, v181
    v_mfma_f32_32x32x16_bf16 v[144:159], a[252:255], v[252:255], v[144:159]
    v_add_f32 v48, v48, v166
    v_add_f32 v49, v49, v167
    v_add_f32 v50, v50, v182
    v_add_f32 v51, v51, v183
    v_add_f32 v48, v48, v168
    v_max3_f32 v52, v128, v129, v130
    v_mfma_f32_32x32x16_bf16 a[0:15], a[192:195], v[96:99], a[0:15]
    s_waitcnt lgkmcnt(0)
    s_barrier
    buffer_load_dwordx4 v2, s[12:15], 0 offen lds
    v_mfma_f32_32x32x16_bf16 a[64:79], a[192:195], v[104:107], a[64:79]
    ds_read_b128 a[224:227], v24 offset:16384
    v_max3_f32 v52, v131, v132, v52
    v_max3_f32 v52, v133, v134, v52
    v_max3_f32 v52, v135, v136, v52
    ds_read_b128 a[228:231], v25 offset:16384
    v_max3_f32 v52, v137, v138, v52
    v_mfma_f32_32x32x16_bf16 a[16:31], a[196:199], v[96:99], a[16:31]
    v_max3_f32 v52, v139, v140, v52
    v_max3_f32 v52, v141, v142, v52
    v_max3_f32 v52, v143, v144, v52
    v_max3_f32 v52, v145, v146, v52
    v_max3_f32 v52, v147, v148, v52
    buffer_load_dwordx4 v3, s[12:15], 0 offen offset:1024 lds
    v_mfma_f32_32x32x16_bf16 a[80:95], a[196:199], v[104:107], a[80:95]
    v_max3_f32 v52, v149, v150, v52
    v_max3_f32 v52, v151, v152, v52
    v_max3_f32 v52, v153, v154, v52
    v_add_f32 v49, v49, v169
    v_add_f32 v50, v50, v184
    v_add_f32 v51, v51, v185
    v_mfma_f32_32x32x16_bf16 a[32:47], a[200:203], v[96:99], a[32:47]
    v_max3_f32 v52, v155, v156, v52
    v_add_f32 v48, v48, v170
    v_add_f32 v49, v49, v171
    v_add_f32 v50, v50, v186
    v_add_f32 v51, v51, v187
    buffer_load_dwordx4 v2, s[12:15], s49 offen offset:2048 lds
    v_mfma_f32_32x32x16_bf16 a[96:111], a[200:203], v[104:107], a[96:111]
    v_max3_f32 v52, v157, v158, v52
    v_add_f32 v48, v48, v172
    v_add_f32 v49, v49, v173
    v_add_f32 v50, v50, v188
    v_add_f32 v51, v51, v189
    v_max_f32 v52, v159, v52
    v_mfma_f32_32x32x16_bf16 a[48:63], a[204:207], v[96:99], a[48:63]
    ds_read_b128 a[232:235], v26 offset:16384
    v_add_f32 v48, v48, v174
    v_add_f32 v49, v49, v175
    v_add_f32 v50, v50, v190
    v_add_f32 v51, v51, v191
    buffer_load_dwordx4 v3, s[12:15], s49 offen offset:3072 lds
    v_mfma_f32_32x32x16_bf16 a[112:127], a[204:207], v[104:107], a[112:127]
    s_add_u32 m0, s48, 0x1000
    v_cmp_lt_f32 vcc, v57, v52
    ds_read_b128 a[236:239], v27 offset:16384
    v_mfma_f32_32x32x16_bf16 a[0:15], a[208:211], v[100:103], a[0:15]
    ds_read_b128 a[240:243], v28 offset:16384
    ds_read_b128 a[244:247], v29 offset:16384
    buffer_load_dwordx4 v2, s[12:15], s61 offen lds
    v_mfma_f32_32x32x16_bf16 a[64:79], a[208:211], v[108:111], a[64:79]
    ds_read_b128 a[248:251], v30 offset:16384
    ds_read_b128 a[252:255], v31 offset:16384
    v_mfma_f32_32x32x16_bf16 a[16:31], a[212:215], v[100:103], a[16:31]
    ds_read_b64_tr_b16 a[192:193], v32 offset:32768
    ds_read_b64_tr_b16 a[194:195], v32 offset:33792
    ds_read_b64_tr_b16 a[196:197], v33 offset:32768
    buffer_load_dwordx4 v3, s[12:15], s61 offen offset:1024 lds
    v_mfma_f32_32x32x16_bf16 a[80:95], a[212:215], v[108:111], a[80:95]
    ds_read_b64_tr_b16 a[198:199], v33 offset:33792
    ds_read_b64_tr_b16 a[200:201], v34 offset:32768
    ds_read_b64_tr_b16 a[202:203], v34 offset:33792
    v_mfma_f32_32x32x16_bf16 a[32:47], a[216:219], v[100:103], a[32:47]
    ds_read_b64_tr_b16 a[204:205], v35 offset:32768
    ds_read_b64_tr_b16 a[206:207], v35 offset:33792
    ds_read_b64_tr_b16 a[208:209], v32 offset:36864
    buffer_load_dwordx4 v2, s[12:15], s73 offen offset:2048 lds
    v_mfma_f32_32x32x16_bf16 a[96:111], a[216:219], v[108:111], a[96:111]
    v_add_u32 v2, 0x80, v2
    ds_read_b64_tr_b16 a[210:211], v32 offset:37888
    ds_read_b64_tr_b16 a[212:213], v33 offset:36864
    ds_read_b64_tr_b16 a[214:215], v33 offset:37888
    v_mfma_f32_32x32x16_bf16 a[48:63], a[220:223], v[100:103], a[48:63]
    ds_read_b64_tr_b16 a[216:217], v34 offset:36864
    ds_read_b64_tr_b16 a[218:219], v34 offset:37888
    buffer_load_dwordx4 v3, s[12:15], s73 offen offset:3072 lds
    v_mfma_f32_32x32x16_bf16 a[112:127], a[220:223], v[108:111], a[112:127]
    v_add_u32 v3, 0x80, v3
    s_add_u32 m0, s48, 0x2000
    s_cbranch_vccnz L_rare14
L_rare14_ret:
    v_exp_f32 v128, v128
    s_waitcnt lgkmcnt(15)
    v_mfma_f32_32x32x16_bf16 v[160:175], a[224:227], v[192:195], v[64:79]
    v_exp_f32 v129, v129
    v_exp_f32 v130, v130
    v_exp_f32 v131, v131
    v_mfma_f32_32x32x16_bf16 v[176:191], a[224:227], v[224:227], v[80:95]
    buffer_load_dwordx4 v[192:195], v46, s[4:7], s74 offen sc1
    v_exp_f32 v132, v132
    v_exp_f32 v133, v133
    v_cvt_pk_bf16_f32 v96, v128, v129
    v_mfma_f32_32x32x16_bf16 v[160:175], a[228:231], v[196:199], v[160:175]
    v_exp_f32 v134, v134
    v_exp_f32 v135, v135
    v_cvt_pk_bf16_f32 v97, v130, v131
    v_cvt_pk_bf16_f32 v98, v132, v133
    v_mfma_f32_32x32x16_bf16 v[176:191], a[228:231], v[228:231], v[176:191]
    buffer_load_dwordx4 v[196:199], v46, s[4:7], s75 offen sc1
    v_cvt_pk_bf16_f32 v99, v134, v135
    v_exp_f32 v144, v144
    v_exp_f32 v145, v145
    v_mfma_f32_32x32x16_bf16 v[160:175], a[232:235], v[200:203], v[160:175]
    v_exp_f32 v146, v146
    v_exp_f32 v147, v147
    v_exp_f32 v148, v148
    v_mfma_f32_32x32x16_bf16 v[176:191], a[232:235], v[232:235], v[176:191]
    buffer_load_dwordx4 v[200:203], v46, s[4:7], s83 offen sc1
    v_exp_f32 v149, v149
    v_exp_f32 v150, v150
    v_cvt_pk_bf16_f32 v104, v144, v145
    v_mfma_f32_32x32x16_bf16 v[160:175], a[236:239], v[204:207], v[160:175]
    v_exp_f32 v151, v151
    v_cvt_pk_bf16_f32 v105, v146, v147
    v_cvt_pk_bf16_f32 v106, v148, v149
    v_cvt_pk_bf16_f32 v107, v150, v151
    ds_read_b64_tr_b16 a[220:221], v35 offset:36864
    v_mfma_f32_32x32x16_bf16 v[176:191], a[236:239], v[236:239], v[176:191]
    buffer_load_dwordx4 v[204:207], v46, s[4:7], s74 offen offset:1024 sc1
    v_exp_f32 v136, v136
    v_exp_f32 v137, v137
    ds_read_b64_tr_b16 a[222:223], v35 offset:37888
    v_mfma_f32_32x32x16_bf16 v[160:175], a[240:243], v[208:211], v[160:175]
    v_exp_f32 v138, v138
    v_exp_f32 v139, v139
    v_exp_f32 v140, v140
    v_mfma_f32_32x32x16_bf16 v[176:191], a[240:243], v[240:243], v[176:191]
    buffer_load_dwordx4 v[208:211], v46, s[4:7], s75 offen offset:1024 sc1
    v_exp_f32 v141, v141
    v_exp_f32 v142, v142
    v_cvt_pk_bf16_f32 v100, v136, v137
    v_mfma_f32_32x32x16_bf16 v[160:175], a[244:247], v[212:215], v[160:175]
    v_exp_f32 v143, v143
    v_cvt_pk_bf16_f32 v101, v138, v139
    v_cvt_pk_bf16_f32 v102, v140, v141
    v_cvt_pk_bf16_f32 v103, v142, v143
    v_add_f32 v48, v48, v128
    v_mfma_f32_32x32x16_bf16 v[176:191], a[244:247], v[244:247], v[176:191]
    buffer_load_dwordx4 v[212:215], v46, s[4:7], s83 offen offset:1024 sc1
    v_exp_f32 v152, v152
    v_exp_f32 v153, v153
    v_add_f32 v49, v49, v129
    v_mfma_f32_32x32x16_bf16 v[160:175], a[248:251], v[216:219], v[160:175]
    v_exp_f32 v154, v154
    v_exp_f32 v155, v155
    v_exp_f32 v156, v156
    v_mfma_f32_32x32x16_bf16 v[176:191], a[248:251], v[248:251], v[176:191]
    buffer_load_dwordx4 v[216:219], v46, s[4:7], s74 offen offset:2048 sc1
    v_exp_f32 v157, v157
    v_exp_f32 v158, v158
    s_waitcnt lgkmcnt(1)
    v_mfma_f32_32x32x16_bf16 v[160:175], a[252:255], v[220:223], v[160:175]
    v_exp_f32 v159, v159
    v_cvt_pk_bf16_f32 v108, v152, v153
    v_cvt_pk_bf16_f32 v109, v154, v155
    v_cvt_pk_bf16_f32 v110, v156, v157
    v_cvt_pk_bf16_f32 v111, v158, v159
    v_mfma_f32_32x32x16_bf16 v[176:191], a[252:255], v[252:255], v[176:191]
    buffer_load_dwordx4 v[220:223], v46, s[4:7], s75 offen offset:2048 sc1
    v_add_f32 v50, v50, v144
    v_add_f32 v51, v51, v145
    v_add_f32 v48, v48, v130
    v_add_f32 v49, v49, v131
    v_add_f32 v50, v50, v146
    v_mfma_f32_32x32x16_bf16 a[0:15], a[192:195], v[96:99], a[0:15]
    s_barrier
    ds_read_b64_tr_b16 a[224:225], v32 offset:40960
    v_max3_f32 v52, v160, v161, v162
    v_mfma_f32_32x32x16_bf16 a[64:79], a[192:195], v[104:107], a[64:79]
    buffer_load_dwordx4 v[224:227], v46, s[4:7], s83 offen offset:2048 sc1
    ds_read_b64_tr_b16 a[226:227], v32 offset:41984
    v_max3_f32 v52, v163, v164, v52
    v_max3_f32 v52, v165, v166, v52
    v_max3_f32 v52, v167, v168, v52
    ds_read_b64_tr_b16 a[228:229], v33 offset:40960
    v_mfma_f32_32x32x16_bf16 a[16:31], a[196:199], v[96:99], a[16:31]
    ds_read_b64_tr_b16 a[230:231], v33 offset:41984
    v_max3_f32 v52, v169, v170, v52
    v_max3_f32 v52, v171, v172, v52
    v_max3_f32 v52, v173, v174, v52
    v_max3_f32 v52, v175, v176, v52
    v_max3_f32 v52, v177, v178, v52
    v_mfma_f32_32x32x16_bf16 a[80:95], a[196:199], v[104:107], a[80:95]
    buffer_load_dwordx4 v[228:231], v46, s[4:7], s74 offen offset:3072 sc1
    s_add_u32 s74, s74, 0x1000
    v_max3_f32 v52, v179, v180, v52
    v_add_f32 v51, v51, v147
    v_max3_f32 v52, v181, v182, v52
    v_add_f32 v48, v48, v132
    v_mfma_f32_32x32x16_bf16 a[32:47], a[200:203], v[96:99], a[32:47]
    v_add_f32 v49, v49, v133
    v_add_f32 v50, v50, v148
    v_add_f32 v51, v51, v149
    v_max3_f32 v52, v183, v184, v52
    v_add_f32 v48, v48, v134
    v_add_f32 v49, v49, v135
    v_mfma_f32_32x32x16_bf16 a[96:111], a[200:203], v[104:107], a[96:111]
    buffer_load_dwordx4 v2, s[12:15], 0 offen lds
    v_add_f32 v50, v50, v150
    v_add_f32 v51, v51, v151
    v_max3_f32 v52, v185, v186, v52
    v_add_f32 v48, v48, v136
    v_add_f32 v49, v49, v137
    v_mfma_f32_32x32x16_bf16 a[48:63], a[204:207], v[96:99], a[48:63]
    v_add_f32 v50, v50, v152
    v_add_f32 v51, v51, v153
    v_max3_f32 v52, v187, v188, v52
    v_add_f32 v48, v48, v138
    v_add_f32 v49, v49, v139
    v_add_f32 v50, v50, v154
    v_mfma_f32_32x32x16_bf16 a[112:127], a[204:207], v[104:107], a[112:127]
    buffer_load_dwordx4 v3, s[12:15], 0 offen offset:1024 lds
    v_add_f32 v51, v51, v155
    v_max3_f32 v52, v189, v190, v52
    v_add_f32 v48, v48, v140
    v_add_f32 v49, v49, v141
    v_add_f32 v50, v50, v156
    v_mfma_f32_32x32x16_bf16 a[0:15], a[208:211], v[100:103], a[0:15]
    v_add_f32 v51, v51, v157
    v_max_f32 v52, v191, v52
    v_add_f32 v48, v48, v142
    v_add_f32 v49, v49, v143
    v_add_f32 v50, v50, v158
    v_add_f32 v51, v51, v159
    v_mfma_f32_32x32x16_bf16 a[64:79], a[208:211], v[108:111], a[64:79]
    buffer_load_dwordx4 v2, s[12:15], s49 offen offset:2048 lds
    v_cmp_lt_f32 vcc, v57, v52
    ds_read_b64_tr_b16 a[232:233], v34 offset:40960
    ds_read_b64_tr_b16 a[234:235], v34 offset:41984
    v_mfma_f32_32x32x16_bf16 a[16:31], a[212:215], v[100:103], a[16:31]
    ds_read_b64_tr_b16 a[236:237], v35 offset:40960
    ds_read_b64_tr_b16 a[238:239], v35 offset:41984
    ds_read_b64_tr_b16 a[240:241], v32 offset:45056
    v_mfma_f32_32x32x16_bf16 a[80:95], a[212:215], v[108:111], a[80:95]
    buffer_load_dwordx4 v3, s[12:15], s49 offen offset:3072 lds
    s_add_u32 m0, s48, 0x3000
    ds_read_b64_tr_b16 a[242:243], v32 offset:46080
    ds_read_b64_tr_b16 a[244:245], v33 offset:45056
    v_mfma_f32_32x32x16_bf16 a[32:47], a[216:219], v[100:103], a[32:47]
    ds_read_b64_tr_b16 a[246:247], v33 offset:46080
    ds_read_b64_tr_b16 a[248:249], v34 offset:45056
    ds_read_b64_tr_b16 a[250:251], v34 offset:46080
    v_lshlrev_b32 v34, 10, v40
    v_mfma_f32_32x32x16_bf16 a[96:111], a[216:219], v[108:111], a[96:111]
    buffer_load_dwordx4 v[232:235], v46, s[4:7], s75 offen offset:3072 sc1
    s_add_u32 s75, s75, 0x1000
    v_lshl_add_u32 v34, v41, 4, v34
    ds_read_b64_tr_b16 a[252:253], v35 offset:45056
    s_waitcnt lgkmcnt(11)
    v_mfma_f32_32x32x16_bf16 a[48:63], a[220:223], v[100:103], a[48:63]
    ds_read_b64_tr_b16 a[254:255], v35 offset:46080
    v_mfma_f32_32x32x16_bf16 a[112:127], a[220:223], v[108:111], a[112:127]
    buffer_load_dwordx4 v2, s[12:15], s61 offen lds
    s_cbranch_vccnz L_rare15
L_rare15_ret:
    v_exp_f32 v160, v160
    v_exp_f32 v161, v161
    v_exp_f32 v162, v162
    v_exp_f32 v163, v163
    v_exp_f32 v164, v164
    v_exp_f32 v165, v165
    v_exp_f32 v166, v166
    buffer_load_dwordx4 v3, s[12:15], s61 offen offset:1024 lds
    v_exp_f32 v167, v167
    v_exp_f32 v176, v176
    v_exp_f32 v177, v177
    v_exp_f32 v178, v178
    v_exp_f32 v179, v179
    v_exp_f32 v180, v180
    v_exp_f32 v181, v181
    v_exp_f32 v182, v182
    buffer_load_dwordx4 v2, s[12:15], s73 offen offset:2048 lds
    v_exp_f32 v183, v183
    v_exp_f32 v168, v168
    v_exp_f32 v169, v169
    v_exp_f32 v170, v170
    v_exp_f32 v171, v171
    v_exp_f32 v172, v172
    v_exp_f32 v173, v173
    v_exp_f32 v174, v174
    buffer_load_dwordx4 v3, s[12:15], s73 offen offset:3072 lds
    v_exp_f32 v175, v175
    v_exp_f32 v184, v184
    v_exp_f32 v185, v185
    v_exp_f32 v186, v186
    v_exp_f32 v187, v187
    v_exp_f32 v188, v188
    v_exp_f32 v189, v189
    v_exp_f32 v190, v190
    buffer_load_dwordx4 v[236:239], v46, s[4:7], s83 offen offset:3072 sc1
    s_add_u32 s83, s83, 0x1000
    v_exp_f32 v191, v191
    s_waitcnt lgkmcnt(0)
    s_barrier
    v_add_u32 v2, 0x80, v2
    v_add_u32 v3, 0x80, v3
    s_add_u32 m0, s48, 0x4000
    v_add_f32 v48, v48, v160
    v_add_f32 v49, v49, v161
    v_add_f32 v48, v48, v162
    v_add_f32 v49, v49, v163
    buffer_load_dwordx4 v[240:243], v46, s[4:7], s74 offen sc1
    v_add_f32 v48, v48, v164
    v_add_f32 v49, v49, v165
    v_add_f32 v48, v48, v166
    v_add_f32 v49, v49, v167
    v_add_f32 v48, v48, v168
    v_add_f32 v49, v49, v169
    v_add_f32 v48, v48, v170
    v_add_f32 v49, v49, v171
    v_add_f32 v48, v48, v172
    v_add_f32 v49, v49, v173
    v_add_f32 v50, v50, v176
    v_add_f32 v51, v51, v177
    v_add_f32 v48, v48, v174
    v_add_f32 v49, v49, v175
    v_add_f32 v50, v50, v178
    buffer_load_dwordx4 v[244:247], v46, s[4:7], s75 offen sc1
    v_add_f32 v51, v51, v179
    v_add_f32 v50, v50, v180
    v_add_f32 v51, v51, v181
    v_add_f32 v48, v48, v49
    v_add_f32 v50, v50, v182
    v_add_f32 v51, v51, v183
    v_mov_b32 v55, v48
    v_add_f32 v50, v50, v184
    v_add_f32 v51, v51, v185
    v_permlane32_swap_b32 v48, v55
    v_add_f32 v50, v50, v186
    v_add_f32 v51, v51, v187
    v_add_f32 v48, v48, v55
    v_add_f32 v50, v50, v188
    v_add_f32 v51, v51, v189
    buffer_load_dwordx4 v[248:251], v46, s[4:7], s83 offen sc1
    v_rcp_f32 v52, v48
    v_add_f32 v50, v50, v190
    v_add_f32 v51, v51, v191
    v_add_f32 v50, v50, v51
    v_mov_b32 v55, v50
    v_and_b32 v73, 15, v0
    v_lshrrev_b32 v72, 4, v0
    v_permlane32_swap_b32 v50, v55
    v_add_f32 v50, v50, v55
    v_rcp_f32 v53, v50
    v_and_b32 v76, 3, v73
    v_lshrrev_b32 v74, 3, v0
    v_and_b32 v75, 7, v0
    buffer_load_dwordx4 v[252:255], v46, s[4:7], s74 offen offset:1024 sc1
    v_and_b32 v55, 3, v0
    v_min_u32 v55, 2, v55
    v_and_b32 v54, 7, v0
    v_cvt_pk_bf16_f32 v96, v160, v161
    v_cvt_pk_bf16_f32 v97, v162, v163
    v_cvt_pk_bf16_f32 v98, v164, v165
    v_cvt_pk_bf16_f32 v99, v166, v167
    v_cvt_pk_bf16_f32 v104, v176, v177
    v_cvt_pk_bf16_f32 v105, v178, v179
    v_mfma_f32_32x32x16_bf16 a[0:15], a[224:227], v[96:99], a[0:15]
    v_cvt_pk_bf16_f32 v106, v180, v181
    v_cvt_pk_bf16_f32 v107, v182, v183
    v_cvt_pk_bf16_f32 v100, v168, v169
    v_cvt_pk_bf16_f32 v101, v170, v171
    buffer_load_dwordx4 v[128:131], v46, s[4:7], s75 offen offset:1024 sc1
    v_cvt_pk_bf16_f32 v102, v172, v173
    v_mfma_f32_32x32x16_bf16 a[64:79], a[224:227], v[104:107], a[64:79]
    v_cvt_pk_bf16_f32 v103, v174, v175
    v_cvt_pk_bf16_f32 v108, v184, v185
    v_cvt_pk_bf16_f32 v109, v186, v187
    v_cvt_pk_bf16_f32 v110, v188, v189
    v_cvt_pk_bf16_f32 v111, v190, v191
    v_and_b32 v68, 3, v0
    v_mfma_f32_32x32x16_bf16 a[16:31], a[228:231], v[96:99], a[16:31]
    s_waitcnt vmcnt(29)
    ds_read_b128 v[80:83], v4
    v_and_b32 v69, 1, v68
    v_lshlrev_b32 v69, 1, v69
    buffer_load_dwordx4 v[132:135], v46, s[4:7], s83 offen offset:1024 sc1
    ds_read_b128 v[88:91], v5
    v_mfma_f32_32x32x16_bf16 a[80:95], a[228:231], v[104:107], a[80:95]
    v_lshrrev_b32 v70, 1, v68
    s_waitcnt vmcnt(26)
    ds_read_b128 v[84:87], v4 offset:4096
    v_or_b32 v69, v69, v70
    v_lshrrev_b32 v70, 2, v73
    v_xor_b32 v70, v70, v72
    v_mfma_f32_32x32x16_bf16 a[32:47], a[232:235], v[96:99], a[32:47]
    v_lshlrev_b32 v70, 6, v70
    v_lshl_add_u32 v70, v76, 4, v70
    ds_read_b128 v[92:95], v5 offset:4096
    v_bfe_u32 v66, v0, 4, 1
    buffer_load_dwordx4 v[136:139], v46, s[4:7], s74 offen offset:2048 sc1
    v_lshlrev_b32 v69, 3, v69
    v_mfma_f32_32x32x16_bf16 a[96:111], a[232:235], v[104:107], a[96:111]
    v_lshl_add_u32 v71, v66, 5, v69
    v_add_u32 v69, s69, v72
    v_lshlrev_b32 v69, 10, v69
    v_add_u32 v20, v69, v70
    s_lshl_b32 s69, s79, 13
    v_lshrrev_b32 v65, 5, v0
    v_mfma_f32_32x32x16_bf16 a[48:63], a[236:239], v[96:99], a[48:63]
    v_bfe_u32 v67, v0, 2, 2
    v_add_u32 v21, s69, v46
    v_lshl_add_u32 v69, v65, 3, v67
    s_lshl_b32 s69, s80, 1
    buffer_load_dwordx4 v[140:143], v46, s[4:7], s75 offen offset:2048 sc1
    v_lshlrev_b32 v69, 8, v69
    v_mfma_f32_32x32x16_bf16 a[112:127], a[236:239], v[104:107], a[112:127]
    s_add_u32 s69, s69, 0
    v_add_u32 v69, v69, v71
    v_xor_b32 v70, s69, v67
    v_add_u32 v69, 0x4000, v69
    s_lshl_b32 s69, s80, 1
    v_lshl_add_u32 v24, v70, 6, v69
    v_mfma_f32_32x32x16_bf16 a[0:15], a[240:243], v[100:103], a[0:15]
    s_add_u32 s69, s69, 1
    v_xor_b32 v70, s69, v67
    s_lshl_b32 s69, s77, 2
    s_add_u32 s69, s69, s62
    buffer_load_dwordx4 v[144:147], v46, s[4:7], s83 offen offset:2048 sc1
    s_lshl_b32 s69, s69, 8
    v_mfma_f32_32x32x16_bf16 a[64:79], a[240:243], v[108:111], a[64:79]
    s_add_u32 s69, s69, s70
    s_lshl_b32 s69, s69, 10
    s_add_u32 s86, s69, 0x1000000
    s_mul_i32 s69, s47, 3
    s_add_u32 s69, s69, 10
    v_accvgpr_read_b32 v160, a0
    v_mfma_f32_32x32x16_bf16 a[16:31], a[244:247], v[100:103], a[16:31]
    v_accvgpr_read_b32 v161, a1
    v_accvgpr_read_b32 v162, a2
    v_accvgpr_read_b32 v163, a3
    v_accvgpr_read_b32 v164, a4
    buffer_load_dwordx4 v[148:151], v46, s[4:7], s74 offen offset:3072 sc1
    s_add_u32 s74, s74, 0x1000
    v_mfma_f32_32x32x16_bf16 a[80:95], a[244:247], v[108:111], a[80:95]
    v_accvgpr_read_b32 v165, a5
    v_accvgpr_read_b32 v166, a6
    v_accvgpr_read_b32 v167, a7
    v_accvgpr_read_b32 v168, a8
    v_accvgpr_read_b32 v169, a9
    v_accvgpr_read_b32 v170, a10
    v_mfma_f32_32x32x16_bf16 a[32:47], a[248:251], v[100:103], a[32:47]
    v_accvgpr_read_b32 v171, a11
    v_accvgpr_read_b32 v172, a12
    v_accvgpr_read_b32 v173, a13
    v_accvgpr_read_b32 v174, a14
    buffer_load_dwordx4 v2, s[12:15], 0 offen lds
    v_accvgpr_read_b32 v175, a15
    v_mfma_f32_32x32x16_bf16 a[96:111], a[248:251], v[108:111], a[96:111]
    v_accvgpr_read_b32 v176, a16
    v_accvgpr_read_b32 v177, a17
    v_accvgpr_read_b32 v178, a18
    v_accvgpr_read_b32 v179, a19
    v_accvgpr_read_b32 v180, a20
    v_accvgpr_read_b32 v181, a21
    v_mfma_f32_32x32x16_bf16 a[48:63], a[252:255], v[100:103], a[48:63]
    v_accvgpr_read_b32 v182, a22
    v_accvgpr_read_b32 v183, a23
    v_accvgpr_read_b32 v184, a24
    v_accvgpr_read_b32 v185, a25
    buffer_load_dwordx4 v3, s[12:15], 0 offen offset:1024 lds
    v_accvgpr_read_b32 v186, a26
    v_mfma_f32_32x32x16_bf16 a[112:127], a[252:255], v[108:111], a[112:127]
    v_accvgpr_read_b32 v187, a27
    v_accvgpr_read_b32 v188, a28
    v_accvgpr_read_b32 v189, a29
    v_accvgpr_read_b32 v190, a30
    v_accvgpr_read_b32 v191, a31
    s_waitcnt vmcnt(31) lgkmcnt(0)
    v_mfma_f32_32x32x16_bf16 a[128:143], v[192:195], v[80:83], 0
    v_mul_f32 v160, v160, v52
    v_mul_f32 v161, v161, v52
    v_mul_f32 v162, v162, v52
    v_mul_f32 v163, v163, v52
    buffer_load_dwordx4 v2, s[12:15], s49 offen offset:2048 lds
    v_mul_f32 v164, v164, v52
    v_mfma_f32_32x32x16_bf16 a[144:159], v[192:195], v[84:87], 0
    v_mul_f32 v165, v165, v52
    v_mul_f32 v166, v166, v52
    v_mul_f32 v167, v167, v52
    v_mul_f32 v168, v168, v52
    v_mul_f32 v169, v169, v52
    s_waitcnt vmcnt(31)
    v_mfma_f32_32x32x16_bf16 a[160:175], v[196:199], v[80:83], 0
    v_mul_f32 v170, v170, v52
    v_mul_f32 v171, v171, v52
    v_mul_f32 v172, v172, v52
    v_mul_f32 v173, v173, v52
    buffer_load_dwordx4 v3, s[12:15], s49 offen offset:3072 lds
    s_add_u32 m0, s48, 0x5000
    v_mfma_f32_32x32x16_bf16 a[176:191], v[196:199], v[84:87], 0
    v_mul_f32 v174, v174, v52
    v_mul_f32 v175, v175, v52
    v_mul_f32 v176, v176, v52
    v_mul_f32 v177, v177, v52
    v_mul_f32 v178, v178, v52
    s_waitcnt vmcnt(31)
    v_mfma_f32_32x32x16_bf16 a[192:207], v[200:203], v[80:83], 0
    v_mul_f32 v179, v179, v52
    v_mul_f32 v180, v180, v52
    v_mul_f32 v181, v181, v52
    v_mul_f32 v182, v182, v52
    buffer_load_dwordx4 v[152:155], v46, s[4:7], s75 offen offset:3072 sc1
    s_add_u32 s75, s75, 0x1000
    v_mfma_f32_32x32x16_bf16 a[208:223], v[200:203], v[84:87], 0
    v_mul_f32 v183, v183, v52
    v_mul_f32 v184, v184, v52
    v_mul_f32 v185, v185, v52
    v_mul_f32 v186, v186, v52
    v_mul_f32 v187, v187, v52
    s_waitcnt vmcnt(31)
    v_mfma_f32_32x32x16_bf16 a[128:143], v[204:207], v[88:91], a[128:143]
    v_mul_f32 v188, v188, v52
    v_mul_f32 v189, v189, v52
    v_mul_f32 v190, v190, v52
    v_mul_f32 v191, v191, v52
    buffer_load_dwordx4 v2, s[12:15], s61 offen lds
    v_cvt_pk_bf16_f32 v96, v160, v161
    v_mfma_f32_32x32x16_bf16 a[144:159], v[204:207], v[92:95], a[144:159]
    v_cvt_pk_bf16_f32 v97, v162, v163
    v_cvt_pk_bf16_f32 v98, v164, v165
    v_cvt_pk_bf16_f32 v99, v166, v167
    v_cvt_pk_bf16_f32 v100, v168, v169
    v_cvt_pk_bf16_f32 v101, v170, v171
    s_waitcnt vmcnt(31)
    v_mfma_f32_32x32x16_bf16 a[160:175], v[208:211], v[88:91], a[160:175]
    v_cvt_pk_bf16_f32 v102, v172, v173
    v_cvt_pk_bf16_f32 v103, v174, v175
    v_cvt_pk_bf16_f32 v104, v176, v177
    v_cvt_pk_bf16_f32 v105, v178, v179
    buffer_store_dwordx4 v[96:99], v46, s[4:7], s88 offen sc1
    v_cvt_pk_bf16_f32 v106, v180, v181
    v_mfma_f32_32x32x16_bf16 a[176:191], v[208:211], v[92:95], a[176:191]
    v_cvt_pk_bf16_f32 v107, v182, v183
    v_cvt_pk_bf16_f32 v108, v184, v185
    v_cvt_pk_bf16_f32 v109, v186, v187
    v_cvt_pk_bf16_f32 v110, v188, v189
    v_cvt_pk_bf16_f32 v111, v190, v191
    s_waitcnt vmcnt(31)
    v_mfma_f32_32x32x16_bf16 a[192:207], v[212:215], v[88:91], a[192:207]
    v_accvgpr_read_b32 v160, a32
    v_accvgpr_read_b32 v161, a33
    v_accvgpr_read_b32 v162, a34
    v_accvgpr_read_b32 v163, a35
    buffer_store_dwordx4 v[100:103], v46, s[4:7], s89 offen sc1
    v_accvgpr_read_b32 v164, a36
    v_mfma_f32_32x32x16_bf16 a[208:223], v[212:215], v[92:95], a[208:223]
    v_accvgpr_read_b32 v165, a37
    v_accvgpr_read_b32 v166, a38
    v_accvgpr_read_b32 v167, a39
    v_accvgpr_read_b32 v168, a40
    v_accvgpr_read_b32 v169, a41
    v_accvgpr_read_b32 v170, a42
    v_accvgpr_read_b32 v171, a43
    v_accvgpr_read_b32 v172, a44
    v_accvgpr_read_b32 v173, a45
    v_accvgpr_read_b32 v174, a46
    v_accvgpr_read_b32 v175, a47
    v_accvgpr_read_b32 v176, a48
    buffer_store_dwordx4 v[104:107], v46, s[4:7], s90 offen sc1
    v_accvgpr_read_b32 v177, a49
    v_accvgpr_read_b32 v178, a50
    v_accvgpr_read_b32 v179, a51
    v_accvgpr_read_b32 v180, a52
    v_accvgpr_read_b32 v181, a53
    v_accvgpr_read_b32 v182, a54
    v_accvgpr_read_b32 v183, a55
    v_accvgpr_read_b32 v184, a56
    v_accvgpr_read_b32 v185, a57
    v_accvgpr_read_b32 v186, a58
    v_accvgpr_read_b32 v187, a59
    v_accvgpr_read_b32 v188, a60
    v_accvgpr_read_b32 v189, a61
    v_accvgpr_read_b32 v190, a62
    v_accvgpr_read_b32 v191, a63
    buffer_store_dwordx4 v[108:111], v46, s[4:7], s91 offen sc1
    v_mul_f32 v160, v160, v52
    v_mul_f32 v161, v161, v52
    v_mul_f32 v162, v162, v52
    v_mul_f32 v163, v163, v52
    v_mul_f32 v164, v164, v52
    v_mul_f32 v165, v165, v52
    v_mul_f32 v166, v166, v52
    v_mul_f32 v167, v167, v52
    v_mul_f32 v168, v168, v52
    v_mul_f32 v169, v169, v52
    v_mul_f32 v170, v170, v52
    v_mul_f32 v171, v171, v52
    v_mul_f32 v172, v172, v52
    v_mul_f32 v173, v173, v52
    v_mul_f32 v174, v174, v52
    buffer_load_dwordx4 v3, s[12:15], s61 offen offset:1024 lds
    v_mul_f32 v175, v175, v52
    v_mul_f32 v176, v176, v52
    v_mul_f32 v177, v177, v52
    v_mul_f32 v178, v178, v52
    v_mul_f32 v179, v179, v52
    v_mul_f32 v180, v180, v52
    v_mul_f32 v181, v181, v52
    v_mul_f32 v182, v182, v52
    v_mul_f32 v183, v183, v52
    v_mul_f32 v184, v184, v52
    v_mul_f32 v185, v185, v52
    v_mul_f32 v186, v186, v52
    v_mul_f32 v187, v187, v52
    v_mul_f32 v188, v188, v52
    v_mul_f32 v189, v189, v52
    buffer_load_dwordx4 v2, s[12:15], s73 offen offset:2048 lds
    v_add_u32 v2, 0x80, v2
    v_mul_f32 v190, v190, v52
    v_mul_f32 v191, v191, v52
    v_cvt_pk_bf16_f32 v112, v160, v161
    v_cvt_pk_bf16_f32 v113, v162, v163
    v_cvt_pk_bf16_f32 v114, v164, v165
    v_cvt_pk_bf16_f32 v115, v166, v167
    v_cvt_pk_bf16_f32 v116, v168, v169
    v_cvt_pk_bf16_f32 v117, v170, v171
    v_cvt_pk_bf16_f32 v118, v172, v173
    v_cvt_pk_bf16_f32 v119, v174, v175
    v_cvt_pk_bf16_f32 v120, v176, v177
    v_cvt_pk_bf16_f32 v121, v178, v179
    v_cvt_pk_bf16_f32 v122, v180, v181
    v_cvt_pk_bf16_f32 v123, v182, v183
    buffer_load_dwordx4 v3, s[12:15], s73 offen offset:3072 lds
    v_add_u32 v3, 0x80, v3
    s_add_u32 m0, s48, 0
    v_cvt_pk_bf16_f32 v124, v184, v185
    v_cvt_pk_bf16_f32 v125, v186, v187
    v_cvt_pk_bf16_f32 v126, v188, v189
    v_cvt_pk_bf16_f32 v127, v190, v191
    v_accvgpr_read_b32 v160, a64
    v_accvgpr_read_b32 v161, a65
    v_accvgpr_read_b32 v162, a66
    v_accvgpr_read_b32 v163, a67
    v_accvgpr_read_b32 v164, a68
    v_accvgpr_read_b32 v165, a69
    v_accvgpr_read_b32 v166, a70
    v_accvgpr_read_b32 v167, a71
    v_accvgpr_read_b32 v168, a72
    buffer_load_dwordx4 v[156:159], v46, s[4:7], s83 offen offset:3072 sc1
    s_add_u32 s83, s83, 0x1000
    v_accvgpr_read_b32 v169, a73
    v_accvgpr_read_b32 v170, a74
    v_accvgpr_read_b32 v171, a75
    v_accvgpr_read_b32 v172, a76
    v_accvgpr_read_b32 v173, a77
    v_accvgpr_read_b32 v174, a78
    v_accvgpr_read_b32 v175, a79
    v_accvgpr_read_b32 v176, a80
    v_accvgpr_read_b32 v177, a81
    v_accvgpr_read_b32 v178, a82
    v_accvgpr_read_b32 v179, a83
    v_accvgpr_read_b32 v180, a84
    v_accvgpr_read_b32 v181, a85
    v_accvgpr_read_b32 v182, a86
    buffer_load_dwordx4 v[192:195], v46, s[4:7], s74 offen sc1
    v_accvgpr_read_b32 v183, a87
    v_accvgpr_read_b32 v184, a88
    v_accvgpr_read_b32 v185, a89
    v_accvgpr_read_b32 v186, a90
    v_accvgpr_read_b32 v187, a91
    v_accvgpr_read_b32 v188, a92
    v_accvgpr_read_b32 v189, a93
    v_accvgpr_read_b32 v190, a94
    v_accvgpr_read_b32 v191, a95
    s_add_u32 s88, s93, 0x1000
    s_add_u32 s89, s93, 0x1400
    s_add_u32 s90, s93, 0x1800
    s_add_u32 s91, s93, 0x1c00
    v_mul_f32 v160, v160, v53
    v_mul_f32 v161, v161, v53
    buffer_store_dwordx4 v[112:115], v46, s[4:7], s88 offen sc1
    v_mul_f32 v162, v162, v53
    v_mul_f32 v163, v163, v53
    v_mul_f32 v164, v164, v53
    v_mul_f32 v165, v165, v53
    v_mul_f32 v166, v166, v53
    v_mul_f32 v167, v167, v53
    v_mul_f32 v168, v168, v53
    v_mul_f32 v169, v169, v53
    v_mul_f32 v170, v170, v53
    v_mul_f32 v171, v171, v53
    v_mul_f32 v172, v172, v53
    v_mul_f32 v173, v173, v53
    v_mul_f32 v174, v174, v53
    v_mul_f32 v175, v175, v53
    v_mul_f32 v176, v176, v53
    buffer_store_dwordx4 v[116:119], v46, s[4:7], s89 offen sc1
    v_mul_f32 v177, v177, v53
    v_mul_f32 v178, v178, v53
    v_mul_f32 v179, v179, v53
    v_mul_f32 v180, v180, v53
    v_mul_f32 v181, v181, v53
    v_mul_f32 v182, v182, v53
    v_mul_f32 v183, v183, v53
    v_mul_f32 v184, v184, v53
    v_mul_f32 v185, v185, v53
    v_mul_f32 v186, v186, v53
    v_mul_f32 v187, v187, v53
    v_mul_f32 v188, v188, v53
    v_mul_f32 v189, v189, v53
    v_mul_f32 v190, v190, v53
    v_mul_f32 v191, v191, v53
    buffer_store_dwordx4 v[120:123], v46, s[4:7], s90 offen sc1
    v_cvt_pk_bf16_f32 v96, v160, v161
    v_cvt_pk_bf16_f32 v97, v162, v163
    v_cvt_pk_bf16_f32 v98, v164, v165
    v_cvt_pk_bf16_f32 v99, v166, v167
    v_cvt_pk_bf16_f32 v100, v168, v169
    v_cvt_pk_bf16_f32 v101, v170, v171
    v_cvt_pk_bf16_f32 v102, v172, v173
    v_cvt_pk_bf16_f32 v103, v174, v175
    v_cvt_pk_bf16_f32 v104, v176, v177
    v_cvt_pk_bf16_f32 v105, v178, v179
    v_cvt_pk_bf16_f32 v106, v180, v181
    v_cvt_pk_bf16_f32 v107, v182, v183
    v_cvt_pk_bf16_f32 v108, v184, v185
    v_cvt_pk_bf16_f32 v109, v186, v187
    v_cvt_pk_bf16_f32 v110, v188, v189
    buffer_store_dwordx4 v[124:127], v46, s[4:7], s91 offen sc1
    v_cvt_pk_bf16_f32 v111, v190, v191
    s_add_u32 s88, s93, 0x40000
    s_add_u32 s89, s93, 0x40400
    s_add_u32 s90, s93, 0x40800
    s_add_u32 s91, s93, 0x40c00
    v_accvgpr_read_b32 v160, a96
    v_accvgpr_read_b32 v161, a97
    v_accvgpr_read_b32 v162, a98
    v_accvgpr_read_b32 v163, a99
    v_accvgpr_read_b32 v164, a100
    v_accvgpr_read_b32 v165, a101
    v_accvgpr_read_b32 v166, a102
    v_accvgpr_read_b32 v167, a103
    v_accvgpr_read_b32 v168, a104
    v_accvgpr_read_b32 v169, a105
    buffer_store_dwordx4 v[96:99], v46, s[4:7], s88 offen sc1
    v_accvgpr_read_b32 v170, a106
    v_accvgpr_read_b32 v171, a107
    v_accvgpr_read_b32 v172, a108
    v_accvgpr_read_b32 v173, a109
    v_accvgpr_read_b32 v174, a110
    v_accvgpr_read_b32 v175, a111
    v_accvgpr_read_b32 v176, a112
    v_accvgpr_read_b32 v177, a113
    v_accvgpr_read_b32 v178, a114
    v_accvgpr_read_b32 v179, a115
    v_accvgpr_read_b32 v180, a116
    v_accvgpr_read_b32 v181, a117
    v_accvgpr_read_b32 v182, a118
    v_accvgpr_read_b32 v183, a119
    v_accvgpr_read_b32 v184, a120
    buffer_store_dwordx4 v[100:103], v46, s[4:7], s89 offen sc1
    v_accvgpr_read_b32 v185, a121
    v_accvgpr_read_b32 v186, a122
    v_accvgpr_read_b32 v187, a123
    v_accvgpr_read_b32 v188, a124
    v_accvgpr_read_b32 v189, a125
    v_accvgpr_read_b32 v190, a126
    v_accvgpr_read_b32 v191, a127
    v_mul_f32 v160, v160, v53
    v_mul_f32 v161, v161, v53
    v_mul_f32 v162, v162, v53
    v_mul_f32 v163, v163, v53
    v_mul_f32 v164, v164, v53
    v_mul_f32 v165, v165, v53
    v_mul_f32 v166, v166, v53
    v_mul_f32 v167, v167, v53
    buffer_store_dwordx4 v[104:107], v46, s[4:7], s90 offen sc1
    v_mul_f32 v168, v168, v53
    v_mul_f32 v169, v169, v53
    v_mul_f32 v170, v170, v53
    v_mul_f32 v171, v171, v53
    v_mul_f32 v172, v172, v53
    v_mul_f32 v173, v173, v53
    v_mul_f32 v174, v174, v53
    v_mul_f32 v175, v175, v53
    v_mul_f32 v176, v176, v53
    v_mul_f32 v177, v177, v53
    v_mul_f32 v178, v178, v53
    v_mul_f32 v179, v179, v53
    v_mul_f32 v180, v180, v53
    v_mul_f32 v181, v181, v53
    v_mul_f32 v182, v182, v53
    buffer_store_dwordx4 v[108:111], v46, s[4:7], s91 offen sc1
    v_mul_f32 v183, v183, v53
    v_mul_f32 v184, v184, v53
    v_mul_f32 v185, v185, v53
    v_mul_f32 v186, v186, v53
    v_mul_f32 v187, v187, v53
    v_mul_f32 v188, v188, v53
    v_mul_f32 v189, v189, v53
    v_mul_f32 v190, v190, v53
    v_mul_f32 v191, v191, v53
    v_cvt_pk_bf16_f32 v112, v160, v161
    v_cvt_pk_bf16_f32 v113, v162, v163
    v_cvt_pk_bf16_f32 v114, v164, v165
    v_cvt_pk_bf16_f32 v115, v166, v167
    s_add_u32 s88, s93, 0x41000
    v_cvt_pk_bf16_f32 v116, v168, v169
    buffer_store_dwordx4 v[112:115], v46, s[4:7], s88 offen sc1
    v_cvt_pk_bf16_f32 v117, v170, v171
    v_cvt_pk_bf16_f32 v118, v172, v173
    v_cvt_pk_bf16_f32 v119, v174, v175
    s_add_u32 s89, s93, 0x41400
    v_cvt_pk_bf16_f32 v120, v176, v177
    v_cvt_pk_bf16_f32 v121, v178, v179
    v_cvt_pk_bf16_f32 v122, v180, v181
    v_cvt_pk_bf16_f32 v123, v182, v183
    s_add_u32 s90, s93, 0x41800
    v_cvt_pk_bf16_f32 v124, v184, v185
    v_cvt_pk_bf16_f32 v125, v186, v187
    v_cvt_pk_bf16_f32 v126, v188, v189
    v_cvt_pk_bf16_f32 v127, v190, v191
    s_add_u32 s91, s93, 0x41c00
    v_add_u32 v55, s69, v55
    buffer_store_dwordx4 v[116:119], v46, s[4:7], s89 offen sc1
    s_lshl_b32 s89, s66, 7
    s_add_u32 s89, s89, s94
    v_min_u32 v55, 31, v55
    s_add_u32 s89, s89, 0x81800
    v_lshlrev_b32 v55, 2, v55
    s_mul_i32 s70, s99, 0x7ffffff0
    v_or_b32 v55, s70, v55
    s_add_u32 s88, s38, 0x100000
    s_lshl_b32 s94, s64, 2
    s_add_u32 s69, s67, 0x8000
    s_add_u32 s70, s67, 0x800
    s_lshl_b32 s93, s62, 14
    s_mov_b32 s38, 0x1c00
    ds_read_b128 v[80:83], v6
    v_lshl_add_u32 v25, v70, 6, v69
    buffer_store_dwordx4 v[120:123], v46, s[4:7], s90 offen sc1
    v_lshrrev_b32 v69, 2, v75
    v_bfe_u32 v70, v74, 1, 1
    v_xor_b32 v69, v69, v70
    v_lshlrev_b32 v69, 6, v69
    v_and_b32 v70, 3, v75
    v_lshl_add_u32 v69, v70, 4, v69
    v_lshl_add_u32 v31, v74, 10, v69
    s_add_u32 s90, s40, 0x100000
    s_mov_b32 s40, 0x5400
    ds_read_b128 v[84:87], v6 offset:4096
    v_lshlrev_b32 v69, 10, v65
    v_lshl_add_u32 v69, v67, 7, v69
    v_add_u32 v69, v69, v71
    ds_read_b128 v[88:91], v7
    v_add_u32 v69, s71, v69
    buffer_store_dwordx4 v[124:127], v46, s[4:7], s91 offen sc1
    s_lshl_b32 s71, s76, 3
    v_add_u32 v54, s71, v54
    v_min_u32 v54, 31, v54
    v_lshlrev_b32 v54, 2, v54
    v_or_b32 v54, s72, v54
    s_add_u32 s71, s67, 0x8800
    s_and_b32 s72, s77, 1
    s_lshl_b32 s72, s72, 4
    s_add_u32 s72, s72, s60
    s_add_u32 s72, s72, s76
    s_lshr_b32 s60, s47, 1
    s_lshl_b32 s60, s60, 2
    ds_read_b128 v[92:95], v7 offset:4096
    v_add_u32 v22, 0x18000, v21
    v_add_u32 v26, 0x18000, v24
    s_waitcnt vmcnt(50) lgkmcnt(3)
    v_mfma_f32_32x32x16_bf16 a[128:143], v[216:219], v[80:83], a[128:143]
    buffer_load_dwordx4 v[196:199], v46, s[4:7], s75 offen sc1
    v_add_u32 v27, 0x18000, v25
    v_add_u32 v48, 0xc000, v44
    v_add_u32 v49, 0xc000, v45
    v_mov_b32 v51, 0xbdd2d3e8
    v_add_u32 v23, 0x10000, v21
    v_add_u32 v28, 0x10000, v24
    v_add_u32 v29, 0x10000, v25
    v_lshrrev_b32 v70, 1, v67
    s_waitcnt lgkmcnt(2)
    v_mfma_f32_32x32x16_bf16 a[144:159], v[216:219], v[84:87], a[144:159]
    v_xor_b32 v76, 0, v70
    v_lshl_add_u32 v32, v76, 6, v69
    v_xor_b32 v76, 1, v70
    v_and_b32 v64, 31, v0
    buffer_load_dwordx4 v[200:203], v46, s[4:7], s83 offen sc1
    s_waitcnt vmcnt(51)
    v_mfma_f32_32x32x16_bf16 a[160:175], v[220:223], v[80:83], a[160:175]
    v_lshl_add_u32 v33, v76, 6, v69
    v_mfma_f32_32x32x16_bf16 a[176:191], v[220:223], v[84:87], a[176:191]
    buffer_load_dwordx4 v[204:207], v46, s[4:7], s74 offen offset:1024 sc1
    s_waitcnt vmcnt(51)
    v_mfma_f32_32x32x16_bf16 a[192:207], v[224:227], v[80:83], a[192:207]
    s_waitcnt vmcnt(46)
    ds_read_b128 v[80:83], v4 offset:8192
    v_mfma_f32_32x32x16_bf16 a[208:223], v[224:227], v[84:87], a[208:223]
    s_waitcnt vmcnt(41)
    ds_read_b128 v[84:87], v4 offset:12288
    buffer_load_dwordx4 v[208:211], v46, s[4:7], s75 offen offset:1024 sc1
    s_waitcnt lgkmcnt(2)
    v_mfma_f32_32x32x16_bf16 a[128:143], v[228:231], v[88:91], a[128:143]
    v_mfma_f32_32x32x16_bf16 a[144:159], v[228:231], v[92:95], a[144:159]
    buffer_load_dwordx4 v[212:215], v46, s[4:7], s83 offen offset:1024 sc1
    v_mfma_f32_32x32x16_bf16 a[160:175], v[232:235], v[88:91], a[160:175]
    v_mfma_f32_32x32x16_bf16 a[176:191], v[232:235], v[92:95], a[176:191]
    buffer_load_dwordx4 v[216:219], v46, s[4:7], s74 offen offset:2048 sc1
    s_waitcnt vmcnt(43)
    v_mfma_f32_32x32x16_bf16 a[192:207], v[236:239], v[88:91], a[192:207]
    ds_read_b128 v[88:91], v5 offset:8192
    v_mfma_f32_32x32x16_bf16 a[208:223], v[236:239], v[92:95], a[208:223]
    ds_read_b128 v[92:95], v5 offset:12288
    buffer_load_dwordx4 v[220:223], v46, s[4:7], s75 offen offset:2048 sc1
    s_waitcnt vmcnt(43) lgkmcnt(2)
    v_mfma_f32_32x32x16_bf16 a[128:143], v[240:243], v[80:83], a[128:143]
    v_mfma_f32_32x32x16_bf16 a[144:159], v[240:243], v[84:87], a[144:159]
    buffer_load_dwordx4 v[224:227], v46, s[4:7], s83 offen offset:2048 sc1
    s_waitcnt vmcnt(43)
    v_mfma_f32_32x32x16_bf16 a[160:175], v[244:247], v[80:83], a[160:175]
    v_mfma_f32_32x32x16_bf16 a[176:191], v[244:247], v[84:87], a[176:191]
    buffer_load_dwordx4 v[228:231], v46, s[4:7], s74 offen offset:3072 sc1
    s_waitcnt vmcnt(43)
    v_mfma_f32_32x32x16_bf16 a[192:207], v[248:251], v[80:83], a[192:207]
    s_add_u32 s74, s74, 0x1000
    ds_read_b128 v[80:83], v6 offset:8192
    v_mfma_f32_32x32x16_bf16 a[208:223], v[248:251], v[84:87], a[208:223]
    ds_read_b128 v[84:87], v6 offset:12288
    buffer_load_dwordx4 v2, s[12:15], 0 offen lds
    s_waitcnt vmcnt(43) lgkmcnt(2)
    v_mfma_f32_32x32x16_bf16 a[128:143], v[252:255], v[88:91], a[128:143]
    v_mfma_f32_32x32x16_bf16 a[144:159], v[252:255], v[92:95], a[144:159]
    buffer_load_dwordx4 v3, s[12:15], 0 offen offset:1024 lds
    s_waitcnt vmcnt(43)
    v_mfma_f32_32x32x16_bf16 a[160:175], v[128:131], v[88:91], a[160:175]
    v_mfma_f32_32x32x16_bf16 a[176:191], v[128:131], v[92:95], a[176:191]
    buffer_load_dwordx4 v2, s[12:15], s49 offen offset:2048 lds
    s_waitcnt vmcnt(43)
    v_mfma_f32_32x32x16_bf16 a[192:207], v[132:135], v[88:91], a[192:207]
    ds_read_b128 v[88:91], v7 offset:8192
    v_mfma_f32_32x32x16_bf16 a[208:223], v[132:135], v[92:95], a[208:223]
    ds_read_b128 v[92:95], v7 offset:12288
    buffer_load_dwordx4 v3, s[12:15], s49 offen offset:3072 lds
    s_waitcnt vmcnt(43) lgkmcnt(2)
    v_mfma_f32_32x32x16_bf16 a[128:143], v[136:139], v[80:83], a[128:143]
    s_add_u32 m0, s48, 0x1000
    v_mfma_f32_32x32x16_bf16 a[144:159], v[136:139], v[84:87], a[144:159]
    buffer_load_dwordx4 v[232:235], v46, s[4:7], s75 offen offset:3072 sc1
    s_waitcnt vmcnt(43)
    v_mfma_f32_32x32x16_bf16 a[160:175], v[140:143], v[80:83], a[160:175]
    s_add_u32 s75, s75, 0x1000
    v_mfma_f32_32x32x16_bf16 a[176:191], v[140:143], v[84:87], a[176:191]
    buffer_load_dwordx4 v2, s[12:15], s61 offen lds
    s_waitcnt vmcnt(43)
    v_mfma_f32_32x32x16_bf16 a[192:207], v[144:147], v[80:83], a[192:207]
    s_waitcnt vmcnt(38)
    ds_read_b128 v[80:83], v4 offset:16384
    v_mfma_f32_32x32x16_bf16 a[208:223], v[144:147], v[84:87], a[208:223]
    s_waitcnt vmcnt(29)
    ds_read_b128 v[84:87], v4 offset:20480
    buffer_load_dwordx4 v3, s[12:15], s61 offen offset:1024 lds
    s_waitcnt lgkmcnt(2)
    v_mfma_f32_32x32x16_bf16 a[128:143], v[148:151], v[88:91], a[128:143]
    v_mfma_f32_32x32x16_bf16 a[144:159], v[148:151], v[92:95], a[144:159]
    buffer_load_dwordx4 v2, s[12:15], s73 offen offset:2048 lds
    v_add_u32 v2, 0x80, v2
    v_mfma_f32_32x32x16_bf16 a[160:175], v[152:155], v[88:91], a[160:175]
    v_mfma_f32_32x32x16_bf16 a[176:191], v[152:155], v[92:95], a[176:191]
    buffer_load_dwordx4 v3, s[12:15], s73 offen offset:3072 lds
    s_waitcnt vmcnt(31)
    v_mfma_f32_32x32x16_bf16 a[192:207], v[156:159], v[88:91], a[192:207]
    v_add_u32 v3, 0x80, v3
    s_add_u32 m0, s48, 0x2000
    ds_read_b128 v[88:91], v5 offset:16384
    v_mfma_f32_32x32x16_bf16 a[208:223], v[156:159], v[92:95], a[208:223]
    ds_read_b128 v[92:95], v5 offset:20480
    buffer_load_dwordx4 v[236:239], v46, s[4:7], s83 offen offset:3072 sc1
    s_waitcnt vmcnt(31) lgkmcnt(2)
    v_mfma_f32_32x32x16_bf16 a[128:143], v[192:195], v[80:83], a[128:143]
    s_add_u32 s83, s83, 0x1000
    v_mfma_f32_32x32x16_bf16 a[144:159], v[192:195], v[84:87], a[144:159]
    buffer_load_dwordx4 v[240:243], v46, s[4:7], s74 offen sc1
    buffer_load_dwordx4 v[244:247], v46, s[4:7], s75 offen sc1
    buffer_load_dwordx4 v[248:251], v46, s[4:7], s83 offen sc1
    s_waitcnt vmcnt(21)
    v_mfma_f32_32x32x16_bf16 a[160:175], v[196:199], v[80:83], a[160:175]
    buffer_load_dwordx4 v[252:255], v46, s[4:7], s74 offen offset:1024 sc1
    v_mfma_f32_32x32x16_bf16 a[176:191], v[196:199], v[84:87], a[176:191]
    s_waitcnt vmcnt(21)
    v_mfma_f32_32x32x16_bf16 a[192:207], v[200:203], v[80:83], a[192:207]
    buffer_load_dwordx4 v[128:131], v46, s[4:7], s75 offen offset:1024 sc1
    ds_read_b128 v[80:83], v6 offset:16384
    v_mfma_f32_32x32x16_bf16 a[208:223], v[200:203], v[84:87], a[208:223]
    ds_read_b128 v[84:87], v6 offset:20480
    s_waitcnt vmcnt(21) lgkmcnt(2)
    v_mfma_f32_32x32x16_bf16 a[128:143], v[204:207], v[88:91], a[128:143]
    buffer_load_dwordx4 v[132:135], v46, s[4:7], s83 offen offset:1024 sc1
    v_mfma_f32_32x32x16_bf16 a[144:159], v[204:207], v[92:95], a[144:159]
    s_waitcnt vmcnt(21)
    v_mfma_f32_32x32x16_bf16 a[160:175], v[208:211], v[88:91], a[160:175]
    buffer_load_dwordx4 v[136:139], v46, s[4:7], s74 offen offset:2048 sc1
    v_mfma_f32_32x32x16_bf16 a[176:191], v[208:211], v[92:95], a[176:191]
    s_waitcnt vmcnt(21)
    v_mfma_f32_32x32x16_bf16 a[192:207], v[212:215], v[88:91], a[192:207]
    buffer_load_dwordx4 v[140:143], v46, s[4:7], s75 offen offset:2048 sc1
    ds_read_b128 v[88:91], v7 offset:16384
    v_mfma_f32_32x32x16_bf16 a[208:223], v[212:215], v[92:95], a[208:223]
    ds_read_b128 v[92:95], v7 offset:20480
    s_waitcnt vmcnt(21) lgkmcnt(2)
    v_mfma_f32_32x32x16_bf16 a[128:143], v[216:219], v[80:83], a[128:143]
    buffer_load_dwordx4 v[144:147], v46, s[4:7], s83 offen offset:2048 sc1
    v_mfma_f32_32x32x16_bf16 a[144:159], v[216:219], v[84:87], a[144:159]
    s_waitcnt vmcnt(21)
    v_mfma_f32_32x32x16_bf16 a[160:175], v[220:223], v[80:83], a[160:175]
    buffer_load_dwordx4 v[148:151], v46, s[4:7], s74 offen offset:3072 sc1
    s_add_u32 s74, s74, 0x1000
    v_mfma_f32_32x32x16_bf16 a[176:191], v[220:223], v[84:87], a[176:191]
    s_waitcnt vmcnt(21)
    v_mfma_f32_32x32x16_bf16 a[192:207], v[224:227], v[80:83], a[192:207]
    buffer_load_dwordx4 v2, s[12:15], 0 offen lds
    v_mfma_f32_32x32x16_bf16 a[208:223], v[224:227], v[84:87], a[208:223]
    s_barrier
    s_waitcnt vmcnt(21) lgkmcnt(0)
    v_mfma_f32_32x32x16_bf16 a[128:143], v[228:231], v[88:91], a[128:143]
    buffer_store_dword v59, v58, s[4:7], s89 offen sc1
    s_add_u32 s89, s39, 0x100000
    s_mov_b32 s39, 0x3800
    buffer_load_dwordx4 v3, s[12:15], 0 offen offset:1024 lds
    v_mfma_f32_32x32x16_bf16 a[144:159], v[228:231], v[92:95], a[144:159]
    buffer_load_dwordx4 v2, s[12:15], s49 offen offset:2048 lds
    buffer_load_dwordx4 v3, s[12:15], s49 offen offset:3072 lds
    s_add_u32 m0, s48, 0x3000
    buffer_load_dwordx4 v[152:155], v46, s[4:7], s75 offen offset:3072 sc1
    s_add_u32 s75, s75, 0x1000
    s_waitcnt vmcnt(22)
    ds_read_b128 v[80:83], v4
    buffer_load_dwordx4 v2, s[12:15], s61 offen lds
    s_waitcnt vmcnt(22)
    v_mfma_f32_32x32x16_bf16 a[160:175], v[232:235], v[88:91], a[160:175]
    v_mfma_f32_32x32x16_bf16 a[176:191], v[232:235], v[92:95], a[176:191]
    buffer_load_dwordx4 v3, s[12:15], s61 offen offset:1024 lds
    buffer_load_dwordx4 v2, s[12:15], s73 offen offset:2048 lds
    v_add_u32 v2, 0x80, v2
    buffer_load_dwordx4 v3, s[12:15], s73 offen offset:3072 lds
    v_add_u32 v3, 0x80, v3
    s_add_u32 m0, s48, 0x4000
    buffer_load_dwordx4 v[156:159], v46, s[4:7], s83 offen offset:3072 sc1
    s_add_u32 s83, s83, 0x1000
    s_waitcnt vmcnt(22)
    ds_read_b128 v[84:87], v4 offset:4096
    buffer_load_dwordx4 v[192:195], v46, s[4:7], s74 offen sc1
    s_waitcnt vmcnt(22)
    v_mfma_f32_32x32x16_bf16 a[192:207], v[236:239], v[88:91], a[192:207]
    ds_read_b128 v[88:91], v5
    v_mfma_f32_32x32x16_bf16 a[208:223], v[236:239], v[92:95], a[208:223]
    ds_read_b128 v[92:95], v5 offset:4096
    buffer_load_dwordx4 v[196:199], v46, s[4:7], s75 offen sc1
    s_waitcnt vmcnt(22) lgkmcnt(3)
    v_mfma_f32_32x32x16_bf16 a[128:143], v[240:243], v[80:83], a[128:143]
    s_waitcnt lgkmcnt(2)
    v_mfma_f32_32x32x16_bf16 a[144:159], v[240:243], v[84:87], a[144:159]
    buffer_load_dwordx4 v[200:203], v46, s[4:7], s83 offen sc1
    s_waitcnt vmcnt(22)
    v_mfma_f32_32x32x16_bf16 a[160:175], v[244:247], v[80:83], a[160:175]
    v_mfma_f32_32x32x16_bf16 a[176:191], v[244:247], v[84:87], a[176:191]
    buffer_load_dwordx4 v[204:207], v46, s[4:7], s74 offen offset:1024 sc1
    s_waitcnt vmcnt(22)
    v_mfma_f32_32x32x16_bf16 a[192:207], v[248:251], v[80:83], a[192:207]
    ds_read_b128 v[80:83], v6
    v_mfma_f32_32x32x16_bf16 a[208:223], v[248:251], v[84:87], a[208:223]
    ds_read_b128 v[84:87], v6 offset:4096
    buffer_load_dwordx4 v[208:211], v46, s[4:7], s75 offen offset:1024 sc1
    s_waitcnt vmcnt(22) lgkmcnt(2)
    v_mfma_f32_32x32x16_bf16 a[128:143], v[252:255], v[88:91], a[128:143]
    v_mfma_f32_32x32x16_bf16 a[144:159], v[252:255], v[92:95], a[144:159]
    buffer_load_dwordx4 v[212:215], v46, s[4:7], s83 offen offset:1024 sc1
    s_waitcnt vmcnt(22)
    v_mfma_f32_32x32x16_bf16 a[160:175], v[128:131], v[88:91], a[160:175]
    v_mfma_f32_32x32x16_bf16 a[176:191], v[128:131], v[92:95], a[176:191]
    buffer_load_dwordx4 v[216:219], v46, s[4:7], s74 offen offset:2048 sc1
    s_waitcnt vmcnt(22)
    v_mfma_f32_32x32x16_bf16 a[192:207], v[132:135], v[88:91], a[192:207]
    ds_read_b128 v[88:91], v7
    v_mfma_f32_32x32x16_bf16 a[208:223], v[132:135], v[92:95], a[208:223]
    buffer_load_dwordx4 v[220:223], v46, s[4:7], s75 offen offset:2048 sc1
    ds_read_b128 v[92:95], v7 offset:4096
    s_waitcnt vmcnt(22) lgkmcnt(2)
    v_mfma_f32_32x32x16_bf16 a[128:143], v[136:139], v[80:83], a[128:143]
    v_mfma_f32_32x32x16_bf16 a[144:159], v[136:139], v[84:87], a[144:159]
    buffer_load_dwordx4 v[224:227], v46, s[4:7], s83 offen offset:2048 sc1
    s_waitcnt vmcnt(22)
    v_mfma_f32_32x32x16_bf16 a[160:175], v[140:143], v[80:83], a[160:175]
    v_mfma_f32_32x32x16_bf16 a[176:191], v[140:143], v[84:87], a[176:191]
    buffer_load_dwordx4 v[228:231], v46, s[4:7], s74 offen offset:3072 sc1
    s_add_u32 s74, s74, 0x1000
    s_waitcnt vmcnt(22)
    v_mfma_f32_32x32x16_bf16 a[192:207], v[144:147], v[80:83], a[192:207]
    v_mfma_f32_32x32x16_bf16 a[208:223], v[144:147], v[84:87], a[208:223]
    buffer_load_dwordx4 v2, s[12:15], 0 offen lds
    s_waitcnt vmcnt(22) lgkmcnt(0)
    v_mfma_f32_32x32x16_bf16 a[128:143], v[148:151], v[88:91], a[128:143]
    v_mfma_f32_32x32x16_bf16 a[144:159], v[148:151], v[92:95], a[144:159]
    buffer_load_dwordx4 v3, s[12:15], 0 offen offset:1024 lds
    buffer_load_dwordx4 v2, s[12:15], s49 offen offset:2048 lds
    buffer_load_dwordx4 v3, s[12:15], s49 offen offset:3072 lds
    s_add_u32 m0, s48, 0x5000
    buffer_load_dwordx4 v[232:235], v46, s[4:7], s75 offen offset:3072 sc1
    s_add_u32 s75, s75, 0x1000
    s_waitcnt vmcnt(21)
    ds_read_b128 v[80:83], v4 offset:8192
    buffer_load_dwordx4 v2, s[12:15], s61 offen lds
    s_waitcnt vmcnt(21)
    v_mfma_f32_32x32x16_bf16 a[160:175], v[152:155], v[88:91], a[160:175]
    buffer_load_dwordx4 v3, s[12:15], s61 offen offset:1024 lds
    v_mfma_f32_32x32x16_bf16 a[176:191], v[152:155], v[92:95], a[176:191]
    buffer_load_dwordx4 v2, s[12:15], s73 offen offset:2048 lds
    v_add_u32 v2, 0x80, v2
    buffer_load_dwordx4 v3, s[12:15], s73 offen offset:3072 lds
    v_add_u32 v3, 0x80, v3
    s_add_u32 m0, s48, 0
    buffer_load_dwordx4 v[236:239], v46, s[4:7], s83 offen offset:3072 sc1
    s_add_u32 s83, s83, 0x1000
    s_waitcnt vmcnt(21)
    ds_read_b128 v[84:87], v4 offset:12288
    buffer_load_dwordx4 v[240:243], v46, s[4:7], s74 offen sc1
    s_waitcnt vmcnt(21)
    v_mfma_f32_32x32x16_bf16 a[192:207], v[156:159], v[88:91], a[192:207]
    ds_read_b128 v[88:91], v5 offset:8192
    buffer_load_dwordx4 v[244:247], v46, s[4:7], s75 offen sc1
    v_mfma_f32_32x32x16_bf16 a[208:223], v[156:159], v[92:95], a[208:223]
    ds_read_b128 v[92:95], v5 offset:12288
    s_waitcnt vmcnt(21) lgkmcnt(3)
    v_mfma_f32_32x32x16_bf16 a[128:143], v[192:195], v[80:83], a[128:143]
    buffer_load_dwordx4 v[248:251], v46, s[4:7], s83 offen sc1
    s_waitcnt lgkmcnt(2)
    v_mfma_f32_32x32x16_bf16 a[144:159], v[192:195], v[84:87], a[144:159]
    s_waitcnt vmcnt(21)
    v_mfma_f32_32x32x16_bf16 a[160:175], v[196:199], v[80:83], a[160:175]
    buffer_load_dwordx4 v[252:255], v46, s[4:7], s74 offen offset:1024 sc1
    v_mfma_f32_32x32x16_bf16 a[176:191], v[196:199], v[84:87], a[176:191]
    s_waitcnt vmcnt(21)
    v_mfma_f32_32x32x16_bf16 a[192:207], v[200:203], v[80:83], a[192:207]
    ds_read_b128 v[80:83], v6 offset:8192
    buffer_load_dwordx4 v[128:131], v46, s[4:7], s75 offen offset:1024 sc1
    v_mfma_f32_32x32x16_bf16 a[208:223], v[200:203], v[84:87], a[208:223]
    ds_read_b128 v[84:87], v6 offset:12288
    s_waitcnt vmcnt(21) lgkmcnt(2)
    v_mfma_f32_32x32x16_bf16 a[128:143], v[204:207], v[88:91], a[128:143]
    buffer_load_dwordx4 v[132:135], v46, s[4:7], s83 offen offset:1024 sc1
    v_mfma_f32_32x32x16_bf16 a[144:159], v[204:207], v[92:95], a[144:159]
    s_waitcnt vmcnt(21)
    v_mfma_f32_32x32x16_bf16 a[160:175], v[208:211], v[88:91], a[160:175]
    buffer_load_dwordx4 v[136:139], v46, s[4:7], s74 offen offset:2048 sc1
    v_mfma_f32_32x32x16_bf16 a[176:191], v[208:211], v[92:95], a[176:191]
    s_waitcnt vmcnt(21)
    v_mfma_f32_32x32x16_bf16 a[192:207], v[212:215], v[88:91], a[192:207]
    buffer_load_dwordx4 v[140:143], v46, s[4:7], s75 offen offset:2048 sc1
    ds_read_b128 v[88:91], v7 offset:8192
    v_mfma_f32_32x32x16_bf16 a[208:223], v[212:215], v[92:95], a[208:223]
    ds_read_b128 v[92:95], v7 offset:12288
    s_waitcnt vmcnt(21) lgkmcnt(2)
    v_mfma_f32_32x32x16_bf16 a[128:143], v[216:219], v[80:83], a[128:143]
    buffer_load_dwordx4 v[144:147], v46, s[4:7], s83 offen offset:2048 sc1
    v_mfma_f32_32x32x16_bf16 a[144:159], v[216:219], v[84:87], a[144:159]
    s_waitcnt vmcnt(21)
    v_mfma_f32_32x32x16_bf16 a[160:175], v[220:223], v[80:83], a[160:175]
    buffer_load_dwordx4 v[148:151], v46, s[4:7], s74 offen offset:3072 sc1
    s_add_u32 s74, s74, 0x1000
    v_mfma_f32_32x32x16_bf16 a[176:191], v[220:223], v[84:87], a[176:191]
    s_waitcnt vmcnt(21)
    v_mfma_f32_32x32x16_bf16 a[192:207], v[224:227], v[80:83], a[192:207]
    buffer_load_dwordx4 v2, s[12:15], 0 offen lds
    v_mfma_f32_32x32x16_bf16 a[208:223], v[224:227], v[84:87], a[208:223]
    s_waitcnt vmcnt(21) lgkmcnt(0)
    v_mfma_f32_32x32x16_bf16 a[128:143], v[228:231], v[88:91], a[128:143]
    buffer_load_dwordx4 v3, s[12:15], 0 offen offset:1024 lds
    v_mfma_f32_32x32x16_bf16 a[144:159], v[228:231], v[92:95], a[144:159]
    buffer_load_dwordx4 v2, s[12:15], s49 offen offset:2048 lds
    buffer_load_dwordx4 v3, s[12:15], s49 offen offset:3072 lds
    s_add_u32 m0, s48, 0x1000
    buffer_load_dwordx4 v[152:155], v46, s[4:7], s75 offen offset:3072 sc1
    s_add_u32 s75, s75, 0x1000
    s_waitcnt vmcnt(21)
    ds_read_b128 v[80:83], v4 offset:16384
    buffer_load_dwordx4 v2, s[12:15], s61 offen lds
    s_waitcnt vmcnt(21)
    v_mfma_f32_32x32x16_bf16 a[160:175], v[232:235], v[88:91], a[160:175]
    buffer_load_dwordx4 v3, s[12:15], s61 offen offset:1024 lds
    v_mfma_f32_32x32x16_bf16 a[176:191], v[232:235], v[92:95], a[176:191]
    buffer_load_dwordx4 v2, s[12:15], s73 offen offset:2048 lds
    v_add_u32 v2, 0x80, v2
    buffer_load_dwordx4 v3, s[12:15], s73 offen offset:3072 lds
    v_add_u32 v3, 0x80, v3
    s_add_u32 m0, s48, 0x2000
    buffer_load_dwordx4 v[156:159], v46, s[4:7], s83 offen offset:3072 sc1
    s_add_u32 s83, s83, 0x1000
    s_waitcnt vmcnt(21)
    ds_read_b128 v[84:87], v4 offset:20480
    buffer_load_dwordx4 v[192:195], v46, s[4:7], s74 offen sc1
    s_waitcnt vmcnt(21)
    v_mfma_f32_32x32x16_bf16 a[192:207], v[236:239], v[88:91], a[192:207]
    ds_read_b128 v[88:91], v5 offset:16384
    buffer_load_dwordx4 v[196:199], v46, s[4:7], s75 offen sc1
    v_mfma_f32_32x32x16_bf16 a[208:223], v[236:239], v[92:95], a[208:223]
    ds_read_b128 v[92:95], v5 offset:20480
    s_waitcnt vmcnt(21) lgkmcnt(3)
    v_mfma_f32_32x32x16_bf16 a[128:143], v[240:243], v[80:83], a[128:143]
    buffer_load_dwordx4 v[200:203], v46, s[4:7], s83 offen sc1
    s_waitcnt lgkmcnt(2)
    v_mfma_f32_32x32x16_bf16 a[144:159], v[240:243], v[84:87], a[144:159]
    s_waitcnt vmcnt(21)
    v_mfma_f32_32x32x16_bf16 a[160:175], v[244:247], v[80:83], a[160:175]
    buffer_load_dwordx4 v[204:207], v46, s[4:7], s74 offen offset:1024 sc1
    v_mfma_f32_32x32x16_bf16 a[176:191], v[244:247], v[84:87], a[176:191]
    s_waitcnt vmcnt(21)
    v_mfma_f32_32x32x16_bf16 a[192:207], v[248:251], v[80:83], a[192:207]
    buffer_load_dwordx4 v[208:211], v46, s[4:7], s75 offen offset:1024 sc1
    ds_read_b128 v[80:83], v6 offset:16384
    v_mfma_f32_32x32x16_bf16 a[208:223], v[248:251], v[84:87], a[208:223]
    ds_read_b128 v[84:87], v6 offset:20480
    s_waitcnt vmcnt(21) lgkmcnt(2)
    v_mfma_f32_32x32x16_bf16 a[128:143], v[252:255], v[88:91], a[128:143]
    buffer_load_dwordx4 v[212:215], v46, s[4:7], s83 offen offset:1024 sc1
    v_mfma_f32_32x32x16_bf16 a[144:159], v[252:255], v[92:95], a[144:159]
    s_waitcnt vmcnt(21)
    v_mfma_f32_32x32x16_bf16 a[160:175], v[128:131], v[88:91], a[160:175]
    buffer_load_dwordx4 v[216:219], v46, s[4:7], s74 offen offset:2048 sc1
    v_mfma_f32_32x32x16_bf16 a[176:191], v[128:131], v[92:95], a[176:191]
    s_waitcnt vmcnt(21)
    v_mfma_f32_32x32x16_bf16 a[192:207], v[132:135], v[88:91], a[192:207]
    buffer_load_dwordx4 v[220:223], v46, s[4:7], s75 offen offset:2048 sc1
    ds_read_b128 v[88:91], v7 offset:16384
    v_mfma_f32_32x32x16_bf16 a[208:223], v[132:135], v[92:95], a[208:223]
    ds_read_b128 v[92:95], v7 offset:20480
    s_waitcnt vmcnt(21) lgkmcnt(2)
    v_mfma_f32_32x32x16_bf16 a[128:143], v[136:139], v[80:83], a[128:143]
    buffer_load_dwordx4 v[224:227], v46, s[4:7], s83 offen offset:2048 sc1
    v_mfma_f32_32x32x16_bf16 a[144:159], v[136:139], v[84:87], a[144:159]
    s_waitcnt vmcnt(21)
    v_mfma_f32_32x32x16_bf16 a[160:175], v[140:143], v[80:83], a[160:175]
    buffer_load_dwordx4 v[228:231], v46, s[4:7], s74 offen offset:3072 sc1
    s_add_u32 s74, s74, 0x1000
    v_mfma_f32_32x32x16_bf16 a[176:191], v[140:143], v[84:87], a[176:191]
    s_waitcnt vmcnt(21)
    v_mfma_f32_32x32x16_bf16 a[192:207], v[144:147], v[80:83], a[192:207]
    buffer_load_dwordx4 v2, s[12:15], 0 offen lds
    v_mfma_f32_32x32x16_bf16 a[208:223], v[144:147], v[84:87], a[208:223]
    s_waitcnt vmcnt(21) lgkmcnt(0)
    v_mfma_f32_32x32x16_bf16 a[128:143], v[148:151], v[88:91], a[128:143]
    buffer_load_dwordx4 v3, s[12:15], 0 offen offset:1024 lds
    v_mfma_f32_32x32x16_bf16 a[144:159], v[148:151], v[92:95], a[144:159]
    buffer_load_dwordx4 v2, s[12:15], s49 offen offset:2048 lds
    buffer_load_dwordx4 v3, s[12:15], s49 offen offset:3072 lds
    s_add_u32 m0, s48, 0x3000
    buffer_load_dwordx4 v[232:235], v46, s[4:7], s75 offen offset:3072 sc1
    s_add_u32 s75, s75, 0x1000
    s_waitcnt vmcnt(21)
    ds_read_b128 v[80:83], v4
    buffer_load_dwordx4 v2, s[12:15], s61 offen lds
    s_waitcnt vmcnt(21)
    v_mfma_f32_32x32x16_bf16 a[160:175], v[152:155], v[88:91], a[160:175]
    v_mfma_f32_32x32x16_bf16 a[176:191], v[152:155], v[92:95], a[176:191]
    buffer_load_dword v35, v55, s[4:7], s92 offen sc1
    buffer_load_dwordx4 v3, s[12:15], s61 offen offset:1024 lds
    buffer_load_dwordx4 v2, s[12:15], s73 offen offset:2048 lds
    buffer_load_dwordx4 v3, s[12:15], s73 offen offset:3072 lds
    s_add_u32 m0, s81, 0x1c000
    buffer_load_dwordx4 v[236:239], v46, s[4:7], s83 offen offset:3072 sc1
    s_add_u32 s83, s83, 0x1000
    s_waitcnt vmcnt(22)
    ds_read_b128 v[84:87], v4 offset:4096
    s_waitcnt vmcnt(21)
    v_mfma_f32_32x32x16_bf16 a[192:207], v[156:159], v[88:91], a[192:207]
    buffer_load_dwordx4 v[240:243], v46, s[4:7], s74 offen sc1
    ds_read_b128 v[88:91], v5
    v_mfma_f32_32x32x16_bf16 a[208:223], v[156:159], v[92:95], a[208:223]
    ds_read_b128 v[92:95], v5 offset:4096
    s_waitcnt vmcnt(21) lgkmcnt(3)
    v_mfma_f32_32x32x16_bf16 a[128:143], v[192:195], v[80:83], a[128:143]
    buffer_load_dwordx4 v[244:247], v46, s[4:7], s75 offen sc1
    s_waitcnt lgkmcnt(2)
    v_mfma_f32_32x32x16_bf16 a[144:159], v[192:195], v[84:87], a[144:159]
    s_waitcnt vmcnt(21)
    v_mfma_f32_32x32x16_bf16 a[160:175], v[196:199], v[80:83], a[160:175]
    buffer_load_dwordx4 v[248:251], v46, s[4:7], s83 offen sc1
    v_mfma_f32_32x32x16_bf16 a[176:191], v[196:199], v[84:87], a[176:191]
    s_waitcnt vmcnt(21)
    v_mfma_f32_32x32x16_bf16 a[192:207], v[200:203], v[80:83], a[192:207]
    buffer_load_dwordx4 v[252:255], v46, s[4:7], s74 offen offset:1024 sc1
    ds_read_b128 v[80:83], v6
    v_mfma_f32_32x32x16_bf16 a[208:223], v[200:203], v[84:87], a[208:223]
    ds_read_b128 v[84:87], v6 offset:4096
    s_waitcnt vmcnt(21) lgkmcnt(2)
    v_mfma_f32_32x32x16_bf16 a[128:143], v[204:207], v[88:91], a[128:143]
    buffer_load_dwordx4 v[128:131], v46, s[4:7], s75 offen offset:1024 sc1
    v_mfma_f32_32x32x16_bf16 a[144:159], v[204:207], v[92:95], a[144:159]
    s_waitcnt vmcnt(21)
    v_mfma_f32_32x32x16_bf16 a[160:175], v[208:211], v[88:91], a[160:175]
    buffer_load_dwordx4 v[132:135], v46, s[4:7], s83 offen offset:1024 sc1
    v_mfma_f32_32x32x16_bf16 a[176:191], v[208:211], v[92:95], a[176:191]
    s_waitcnt vmcnt(21)
    v_mfma_f32_32x32x16_bf16 a[192:207], v[212:215], v[88:91], a[192:207]
    buffer_load_dwordx4 v[136:139], v46, s[4:7], s74 offen offset:2048 sc1
    ds_read_b128 v[88:91], v7
    v_mfma_f32_32x32x16_bf16 a[208:223], v[212:215], v[92:95], a[208:223]
    ds_read_b128 v[92:95], v7 offset:4096
    s_waitcnt vmcnt(21) lgkmcnt(2)
    v_mfma_f32_32x32x16_bf16 a[128:143], v[216:219], v[80:83], a[128:143]
    buffer_load_dword v30, v54, s[4:7], s95 offen sc1
    buffer_load_dwordx4 v[140:143], v46, s[4:7], s75 offen offset:2048 sc1
    v_mfma_f32_32x32x16_bf16 a[144:159], v[216:219], v[84:87], a[144:159]
    s_waitcnt vmcnt(22)
    v_mfma_f32_32x32x16_bf16 a[160:175], v[220:223], v[80:83], a[160:175]
    buffer_load_dwordx4 v[144:147], v46, s[4:7], s83 offen offset:2048 sc1
    v_mfma_f32_32x32x16_bf16 a[176:191], v[220:223], v[84:87], a[176:191]
    s_waitcnt vmcnt(22)
    v_mfma_f32_32x32x16_bf16 a[192:207], v[224:227], v[80:83], a[192:207]
    buffer_load_dwordx4 v[148:151], v46, s[4:7], s74 offen offset:3072 sc1
    v_mfma_f32_32x32x16_bf16 a[208:223], v[224:227], v[84:87], a[208:223]
    s_waitcnt vmcnt(22) lgkmcnt(0)
    v_mfma_f32_32x32x16_bf16 a[128:143], v[228:231], v[88:91], a[128:143]
    buffer_load_dwordx4 v[152:155], v46, s[4:7], s75 offen offset:3072 sc1
    v_mfma_f32_32x32x16_bf16 a[144:159], v[228:231], v[92:95], a[144:159]
    buffer_load_dwordx4 v[156:159], v46, s[4:7], s83 offen offset:3072 sc1
    buffer_load_dwordx4 v20, s[28:31], 0 offen lds
    buffer_load_dwordx4 v20, s[28:31], s82 offen offset:1024 lds
    s_waitcnt vmcnt(22)
    ds_read_b128 v[80:83], v4 offset:8192
    buffer_load_dwordx4 v20, s[28:31], s84 offen offset:2048 lds
    s_waitcnt vmcnt(22)
    v_mfma_f32_32x32x16_bf16 a[160:175], v[232:235], v[88:91], a[160:175]
    buffer_load_dwordx4 v20, s[28:31], s85 offen offset:3072 lds
    v_add_u32 v20, 0x10000, v20
    v_mfma_f32_32x32x16_bf16 a[176:191], v[232:235], v[92:95], a[176:191]
    s_add_u32 m0, s81, 0x24000
    s_waitcnt vmcnt(21)
    v_cmp_ne_u32 vcc, v59, v35
    buffer_load_dwordx4 v20, s[28:31], 0 offen lds
    s_cbranch_vccnz L_slow_zo
L_ret_zo:
    s_waitcnt vmcnt(19)
    ds_read_b128 v[84:87], v4 offset:12288
    buffer_load_dwordx4 v20, s[28:31], s82 offen offset:1024 lds
    s_waitcnt vmcnt(19)
    v_mfma_f32_32x32x16_bf16 a[192:207], v[236:239], v[88:91], a[192:207]
    ds_read_b128 v[88:91], v5 offset:8192
    buffer_load_dwordx4 v20, s[28:31], s84 offen offset:2048 lds
    v_mfma_f32_32x32x16_bf16 a[208:223], v[236:239], v[92:95], a[208:223]
    ds_read_b128 v[92:95], v5 offset:12288
    s_waitcnt vmcnt(19) lgkmcnt(3)
    v_mfma_f32_32x32x16_bf16 a[128:143], v[240:243], v[80:83], a[128:143]
    buffer_load_dwordx4 v20, s[28:31], s85 offen offset:3072 lds
    s_add_u32 m0, s81, 0x18000
    v_add_u32 v20, 0x10000, v20
    s_waitcnt lgkmcnt(2)
    v_mfma_f32_32x32x16_bf16 a[144:159], v[240:243], v[84:87], a[144:159]
    s_waitcnt vmcnt(19)
    v_mfma_f32_32x32x16_bf16 a[160:175], v[244:247], v[80:83], a[160:175]
    v_mfma_f32_32x32x16_bf16 a[176:191], v[244:247], v[84:87], a[176:191]
    s_waitcnt vmcnt(18)
    v_mfma_f32_32x32x16_bf16 a[192:207], v[248:251], v[80:83], a[192:207]
    ds_read_b128 v[80:83], v6 offset:8192
    v_mfma_f32_32x32x16_bf16 a[208:223], v[248:251], v[84:87], a[208:223]
    ds_read_b128 v[84:87], v6 offset:12288
    s_waitcnt vmcnt(17) lgkmcnt(2)
    v_mfma_f32_32x32x16_bf16 a[128:143], v[252:255], v[88:91], a[128:143]
    v_mfma_f32_32x32x16_bf16 a[144:159], v[252:255], v[92:95], a[144:159]
    s_waitcnt vmcnt(16)
    v_mfma_f32_32x32x16_bf16 a[160:175], v[128:131], v[88:91], a[160:175]
    v_mfma_f32_32x32x16_bf16 a[176:191], v[128:131], v[92:95], a[176:191]
    s_waitcnt vmcnt(15)
    v_mfma_f32_32x32x16_bf16 a[192:207], v[132:135], v[88:91], a[192:207]
    ds_read_b128 v[88:91], v7 offset:8192
    v_mfma_f32_32x32x16_bf16 a[208:223], v[132:135], v[92:95], a[208:223]
    ds_read_b128 v[92:95], v7 offset:12288
    s_waitcnt vmcnt(14) lgkmcnt(2)
    v_mfma_f32_32x32x16_bf16 a[128:143], v[136:139], v[80:83], a[128:143]
    v_mfma_f32_32x32x16_bf16 a[144:159], v[136:139], v[84:87], a[144:159]
    s_waitcnt vmcnt(12)
    v_mfma_f32_32x32x16_bf16 a[160:175], v[140:143], v[80:83], a[160:175]
    v_mfma_f32_32x32x16_bf16 a[176:191], v[140:143], v[84:87], a[176:191]
    s_waitcnt vmcnt(11)
    v_mfma_f32_32x32x16_bf16 a[192:207], v[144:147], v[80:83], a[192:207]
    v_cmp_ne_u32 vcc, v59, v30
    v_mfma_f32_32x32x16_bf16 a[208:223], v[144:147], v[84:87], a[208:223]
    s_cbranch_vccnz L_slow_o
L_ret_o:
    v_and_b32 v54, 7, v0
    v_lshlrev_b32 v54, 2, v54
    s_lshl_b32 s95, s63, 7
    s_add_u32 s95, s95, 0x82000
    s_waitcnt vmcnt(10) lgkmcnt(0)
    v_mfma_f32_32x32x16_bf16 a[128:143], v[148:151], v[88:91], a[128:143]
    s_barrier
    buffer_load_dwordx4 v46, s[4:7], s86 offen sc1 lds
    v_mfma_f32_32x32x16_bf16 a[144:159], v[148:151], v[92:95], a[144:159]
    s_barrier
    s_waitcnt vmcnt(10)
    v_mfma_f32_32x32x16_bf16 a[160:175], v[152:155], v[88:91], a[160:175]
    buffer_load_dwordx4 v46, s[4:7], s86 offen offset:1024 sc1 lds
    v_mfma_f32_32x32x16_bf16 a[176:191], v[152:155], v[92:95], a[176:191]
    s_waitcnt vmcnt(10)
    v_mfma_f32_32x32x16_bf16 a[192:207], v[156:159], v[88:91], a[192:207]
    buffer_load_dwordx4 v46, s[4:7], s86 offen offset:2048 sc1 lds
    v_mfma_f32_32x32x16_bf16 a[208:223], v[156:159], v[92:95], a[208:223]
    ds_write_b128 v42, a[128:131]
    buffer_load_dwordx4 v46, s[4:7], s86 offen offset:3072 sc1 lds
    s_add_u32 s86, s86, 0x1000
    s_add_u32 m0, s81, 0x20000
    ds_write_b128 v42, a[132:135] offset:1024
    ds_write_b128 v42, a[136:139] offset:2048
    buffer_load_dwordx4 v46, s[4:7], s86 offen sc1 lds
    ds_write_b128 v42, a[140:143] offset:3072
    buffer_load_dwordx4 v46, s[4:7], s86 offen offset:1024 sc1 lds
    ds_write_b128 v42, a[144:147] offset:4096
    ds_write_b128 v42, a[148:151] offset:5120
    buffer_load_dwordx4 v46, s[4:7], s86 offen offset:2048 sc1 lds
    ds_write_b128 v42, a[152:155] offset:6144
    ds_write_b128 v42, a[156:159] offset:7168
    buffer_load_dwordx4 v46, s[4:7], s86 offen offset:3072 sc1 lds
    s_add_u32 m0, s81, 0x4000
    s_add_u32 s86, s86, 0x1000
    ds_write_b128 v42, a[160:163] offset:8192
    buffer_load_dwordx4 v[8:11], v46, s[4:7], s88 offen sc1
    ds_write_b128 v42, a[164:167] offset:9216
    ds_write_b128 v42, a[168:171] offset:10240
    buffer_load_dwordx4 v[12:15], v46, s[4:7], s89 offen sc1
    s_lshl_b32 s89, s63, 7
    s_add_u32 s89, s89, s94
    s_add_u32 s89, s89, 0x82000
    s_lshl_b32 s94, s72, 2
    ds_write_b128 v42, a[172:175] offset:11264
    buffer_load_dwordx4 v[16:19], v46, s[4:7], s90 offen sc1
    ds_write_b128 v42, a[176:179] offset:12288
    ds_write_b128 v42, a[180:183] offset:13312
    ds_write_b128 v42, a[184:187] offset:14336
    ds_write_b128 v42, a[188:191] offset:15360
    ds_write_b128 v42, a[192:195] offset:16384
    ds_write_b128 v42, a[196:199] offset:17408
    ds_write_b128 v42, a[200:203] offset:18432
    ds_write_b128 v42, a[204:207] offset:19456
    ds_write_b128 v42, a[208:211] offset:20480
    ds_write_b128 v42, a[212:215] offset:21504
    ds_write_b128 v42, a[216:219] offset:22528
    ds_write_b128 v42, a[220:223] offset:23552
    s_waitcnt vmcnt(7)
    s_barrier
    s_waitcnt lgkmcnt(0)
    s_barrier
    ds_read_b128 v[96:99], v22
    ds_read_b128 v[100:103], v22 offset:4096
    ds_read_b64_tr_b16 v[224:225], v26
    ds_read_b64_tr_b16 v[226:227], v26 offset:1024
    ds_read_b64_tr_b16 v[228:229], v27
    ds_read_b64_tr_b16 v[230:231], v27 offset:1024
    ds_read_b128 v[104:107], v22 offset:1024
    ds_read_b128 v[108:111], v22 offset:5120
    ds_read_b64_tr_b16 v[232:233], v26 offset:4096
    ds_read_b64_tr_b16 v[234:235], v26 offset:5120
    ds_read_b64_tr_b16 v[236:237], v27 offset:4096
    ds_read_b64_tr_b16 v[238:239], v27 offset:5120
    ds_read_b128 v[112:115], v22 offset:2048
    ds_read_b128 v[116:119], v22 offset:6144
    ds_read_b64_tr_b16 v[240:241], v26 offset:8192
    ds_read_b64_tr_b16 v[242:243], v26 offset:9216
    s_waitcnt lgkmcnt(12)
    v_mfma_f32_32x32x16_bf16 a[0:15], v[224:227], v[96:99], 0
    ds_read_b64_tr_b16 v[244:245], v27 offset:8192
    ds_read_b64_tr_b16 v[246:247], v27 offset:9216
    ds_read_b128 v[120:123], v22 offset:3072
    v_mfma_f32_32x32x16_bf16 a[16:31], v[224:227], v[100:103], 0
    ds_read_b128 v[124:127], v22 offset:7168
    ds_read_b64_tr_b16 v[248:249], v26 offset:12288
    s_waitcnt lgkmcnt(15)
    v_mfma_f32_32x32x16_bf16 a[32:47], v[228:231], v[96:99], 0
    ds_read_b64_tr_b16 v[250:251], v26 offset:13312
    ds_read_b64_tr_b16 v[252:253], v27 offset:12288
    ds_read_b64_tr_b16 v[254:255], v27 offset:13312
    v_mfma_f32_32x32x16_bf16 a[48:63], v[228:231], v[100:103], 0
    ds_read_b128 v[128:131], v43
    ds_read_b128 v[132:135], v43 offset:1024
    s_waitcnt lgkmcnt(15)
    v_mfma_f32_32x32x16_bf16 a[0:15], v[232:235], v[104:107], a[0:15]
    ds_read_b128 v[136:139], v43 offset:24576
    ds_read_b128 v[140:143], v43 offset:25600
    v_mfma_f32_32x32x16_bf16 a[16:31], v[232:235], v[108:111], a[16:31]
    ds_read_b128 v[144:147], v47
    ds_read_b128 v[148:151], v47 offset:1024
    s_waitcnt lgkmcnt(14)
    v_mfma_f32_32x32x16_bf16 a[32:47], v[236:239], v[104:107], a[32:47]
    ds_read_b128 v[152:155], v47 offset:24576
    ds_read_b128 v[156:159], v47 offset:25600
    v_mfma_f32_32x32x16_bf16 a[48:63], v[236:239], v[108:111], a[48:63]
    ds_read_b128 v[160:163], v44
    ds_read_b128 v[164:167], v44 offset:1024
    v_mfma_f32_32x32x16_bf16 a[0:15], v[240:243], v[112:115], a[0:15]
    ds_read_b128 v[168:171], v44 offset:24576
    s_waitcnt lgkmcnt(8)
    v_add_f32 v128, v128, v136
    ds_read_b128 v[172:175], v44 offset:25600
    v_mfma_f32_32x32x16_bf16 a[16:31], v[240:243], v[116:119], a[16:31]
    v_add_f32 v129, v129, v137
    ds_read_b128 v[176:179], v48
    v_add_f32 v130, v130, v138
    v_add_f32 v131, v131, v139
    s_waitcnt lgkmcnt(9)
    v_add_f32 v132, v132, v140
    v_mfma_f32_32x32x16_bf16 a[32:47], v[244:247], v[112:115], a[32:47]
    ds_read_b128 v[180:183], v48 offset:1024
    v_add_f32 v133, v133, v141
    v_add_f32 v134, v134, v142
    s_waitcnt lgkmcnt(7)
    v_add_f32 v144, v144, v152
    ds_read_b128 v[184:187], v48 offset:24576
    v_mfma_f32_32x32x16_bf16 a[48:63], v[244:247], v[116:119], a[48:63]
    v_add_f32 v145, v145, v153
    ds_read_b128 v[188:191], v48 offset:25600
    v_add_f32 v146, v146, v154
    v_add_f32 v147, v147, v155
    s_waitcnt lgkmcnt(8)
    v_add_f32 v148, v148, v156
    v_mfma_f32_32x32x16_bf16 a[0:15], v[248:251], v[120:123], a[0:15]
    ds_read_b128 v[192:195], v45
    v_add_f32 v149, v149, v157
    v_add_f32 v150, v150, v158
    v_add_f32 v135, v135, v143
    ds_read_b128 v[196:199], v45 offset:1024
    v_add_f32 v151, v151, v159
    v_mfma_f32_32x32x16_bf16 a[16:31], v[248:251], v[124:127], a[16:31]
    ds_read_b128 v[200:203], v45 offset:24576
    s_waitcnt lgkmcnt(8)
    v_add_f32 v160, v160, v168
    v_add_f32 v161, v161, v169
    ds_read_b128 v[204:207], v45 offset:25600
    v_add_f32 v162, v162, v170
    v_mfma_f32_32x32x16_bf16 a[32:47], v[252:255], v[120:123], a[32:47]
    ds_read_b128 v[208:211], v49
    v_add_f32 v163, v163, v171
    s_waitcnt lgkmcnt(9)
    v_add_f32 v164, v164, v172
    ds_read_b128 v[212:215], v49 offset:1024
    v_add_f32 v165, v165, v173
    v_mfma_f32_32x32x16_bf16 a[48:63], v[252:255], v[124:127], a[48:63]
    ds_read_b128 v[216:219], v49 offset:24576
    s_waitcnt lgkmcnt(8)
    v_add_f32 v176, v176, v184
    v_add_f32 v177, v177, v185
    ds_read_b128 v[220:223], v49 offset:25600
    v_add_f32 v178, v178, v186
    v_add_f32 v179, v179, v187
    s_waitcnt lgkmcnt(8)
    v_add_f32 v180, v180, v188
    v_add_f32 v181, v181, v189
    v_add_f32 v166, v166, v174
    v_add_f32 v182, v182, v190
    v_add_f32 v167, v167, v175
    v_add_f32 v183, v183, v191
    v_add_f32 v128, v128, v144
    v_add_f32 v129, v129, v145
    v_add_f32 v130, v130, v146
    v_add_f32 v131, v131, v147
    v_add_f32 v132, v132, v148
    s_waitcnt lgkmcnt(5)
    v_add_f32 v192, v192, v200
    v_add_f32 v193, v193, v201
    v_add_f32 v194, v194, v202
    v_add_f32 v195, v195, v203
    s_waitcnt lgkmcnt(4)
    v_add_f32 v196, v196, v204
    v_add_f32 v197, v197, v205
    v_add_f32 v198, v198, v206
    v_add_f32 v199, v199, v207
    v_add_f32 v133, v133, v149
    v_add_f32 v134, v134, v150
    v_add_f32 v135, v135, v151
    v_add_f32 v160, v160, v176
    v_add_f32 v161, v161, v177
    v_add_f32 v162, v162, v178
    s_waitcnt lgkmcnt(1)
    v_add_f32 v208, v208, v216
    v_add_f32 v209, v209, v217
    v_add_f32 v210, v210, v218
    s_waitcnt vmcnt(3) lgkmcnt(0)
    s_barrier
    buffer_load_dwordx4 v20, s[28:31], 0 offen lds
    v_add_f32 v211, v211, v219
    v_add_f32 v212, v212, v220
    v_add_f32 v213, v213, v221
    v_add_f32 v214, v214, v222
    v_add_f32 v215, v215, v223
    v_add_f32 v163, v163, v179
    v_add_f32 v164, v164, v180
    v_add_f32 v165, v165, v181
    v_add_f32 v166, v166, v182
    v_add_f32 v167, v167, v183
    v_add_f32 v192, v192, v208
    v_add_f32 v193, v193, v209
    v_add_f32 v194, v194, v210
    v_add_f32 v195, v195, v211
    v_add_f32 v196, v196, v212
    buffer_load_dwordx4 v20, s[28:31], s82 offen offset:1024 lds
    v_add_f32 v197, v197, v213
    v_add_f32 v198, v198, v214
    v_add_f32 v199, v199, v215
    s_waitcnt vmcnt(4)
    v_lshlrev_b32 v144, 16, v8
    v_and_b32 v145, 0xffff0000, v8
    v_lshlrev_b32 v146, 16, v9
    v_and_b32 v147, 0xffff0000, v9
    v_lshlrev_b32 v148, 16, v10
    v_and_b32 v149, 0xffff0000, v10
    v_lshlrev_b32 v150, 16, v11
    v_and_b32 v151, 0xffff0000, v11
    s_waitcnt vmcnt(3)
    v_lshlrev_b32 v176, 16, v12
    v_and_b32 v177, 0xffff0000, v12
    buffer_load_dwordx4 v20, s[28:31], s84 offen offset:2048 lds
    v_lshlrev_b32 v178, 16, v13
    v_and_b32 v179, 0xffff0000, v13
    v_lshlrev_b32 v180, 16, v14
    v_and_b32 v181, 0xffff0000, v14
    v_lshlrev_b32 v182, 16, v15
    v_and_b32 v183, 0xffff0000, v15
    s_waitcnt vmcnt(3)
    v_lshlrev_b32 v208, 16, v16
    v_and_b32 v209, 0xffff0000, v16
    v_lshlrev_b32 v210, 16, v17
    v_and_b32 v211, 0xffff0000, v17
    v_lshlrev_b32 v212, 16, v18
    v_and_b32 v213, 0xffff0000, v18
    v_lshlrev_b32 v214, 16, v19
    v_and_b32 v215, 0xffff0000, v19
    buffer_load_dwordx4 v20, s[28:31], s85 offen offset:3072 lds
    s_add_u32 m0, s81, 0
    v_add_u32 v20, 0x10000, v20
    v_mul_f32 v140, v144, v144
    v_mul_f32 v156, v145, v145
    v_mul_f32 v141, v146, v146
    v_mul_f32 v157, v147, v147
    v_mul_f32 v142, v148, v148
    v_mul_f32 v158, v149, v149
    v_mul_f32 v143, v150, v150
    v_mul_f32 v159, v151, v151
    v_mul_f32 v172, v176, v176
    v_mul_f32 v188, v177, v177
    v_mul_f32 v173, v178, v178
    v_mul_f32 v189, v179, v179
    v_mul_f32 v174, v180, v180
    buffer_load_dwordx4 v46, s[4:7], s86 offen sc1 lds
    v_mul_f32 v190, v181, v181
    v_mul_f32 v175, v182, v182
    v_mul_f32 v191, v183, v183
    v_mul_f32 v204, v208, v208
    v_mul_f32 v220, v209, v209
    v_mul_f32 v205, v210, v210
    v_mul_f32 v221, v211, v211
    v_mul_f32 v206, v212, v212
    v_mul_f32 v222, v213, v213
    v_mul_f32 v207, v214, v214
    v_mul_f32 v223, v215, v215
    v_fmaak_f32 v140, v140, v51, 0xc0135761
    v_fmaak_f32 v156, v156, v51, 0xc0135761
    v_fmaak_f32 v141, v141, v51, 0xc0135761
    v_fmaak_f32 v157, v157, v51, 0xc0135761
    buffer_load_dwordx4 v46, s[4:7], s86 offen offset:1024 sc1 lds
    v_fmaak_f32 v142, v142, v51, 0xc0135761
    v_fmaak_f32 v158, v158, v51, 0xc0135761
    v_fmaak_f32 v143, v143, v51, 0xc0135761
    v_fmaak_f32 v159, v159, v51, 0xc0135761
    v_fmaak_f32 v172, v172, v51, 0xc0135761
    v_fmaak_f32 v188, v188, v51, 0xc0135761
    v_fmaak_f32 v173, v173, v51, 0xc0135761
    v_fmaak_f32 v189, v189, v51, 0xc0135761
    v_fmaak_f32 v174, v174, v51, 0xc0135761
    v_fmaak_f32 v190, v190, v51, 0xc0135761
    v_fmaak_f32 v175, v175, v51, 0xc0135761
    v_fmaak_f32 v191, v191, v51, 0xc0135761
    v_fmaak_f32 v204, v204, v51, 0xc0135761
    v_fmaak_f32 v220, v220, v51, 0xc0135761
    v_fmaak_f32 v205, v205, v51, 0xc0135761
    buffer_load_dwordx4 v46, s[4:7], s86 offen offset:2048 sc1 lds
    v_fmaak_f32 v221, v221, v51, 0xc0135761
    v_fmaak_f32 v206, v206, v51, 0xc0135761
    v_fmaak_f32 v222, v222, v51, 0xc0135761
    v_fmaak_f32 v207, v207, v51, 0xc0135761
    v_fmaak_f32 v223, v223, v51, 0xc0135761
    v_mul_f32 v140, v140, v144
    v_mul_f32 v156, v156, v145
    v_mul_f32 v141, v141, v146
    v_mul_f32 v157, v157, v147
    v_mul_f32 v142, v142, v148
    v_mul_f32 v158, v158, v149
    v_mul_f32 v143, v143, v150
    v_mul_f32 v159, v159, v151
    v_mul_f32 v172, v172, v176
    v_mul_f32 v188, v188, v177
    buffer_load_dwordx4 v46, s[4:7], s86 offen offset:3072 sc1 lds
    s_add_u32 m0, s81, 0xc000
    s_add_u32 s86, s86, 0x1000
    v_mul_f32 v173, v173, v178
    v_mul_f32 v189, v189, v179
    v_mul_f32 v174, v174, v180
    v_mul_f32 v190, v190, v181
    v_mul_f32 v175, v175, v182
    v_mul_f32 v191, v191, v183
    v_mul_f32 v204, v204, v208
    v_mul_f32 v220, v220, v209
    v_mul_f32 v205, v205, v210
    v_mul_f32 v221, v221, v211
    v_mul_f32 v206, v206, v212
    v_mul_f32 v222, v222, v213
    v_mul_f32 v207, v207, v214
    buffer_load_dwordx4 v20, s[28:31], 0 offen lds
    v_mul_f32 v223, v223, v215
    v_exp_f32 v140, v140
    v_exp_f32 v156, v156
    v_exp_f32 v141, v141
    v_exp_f32 v157, v157
    v_exp_f32 v142, v142
    v_exp_f32 v158, v158
    v_exp_f32 v143, v143
    buffer_load_dwordx4 v20, s[28:31], s82 offen offset:1024 lds
    v_exp_f32 v159, v159
    v_exp_f32 v172, v172
    v_exp_f32 v188, v188
    v_exp_f32 v173, v173
    v_exp_f32 v189, v189
    v_exp_f32 v174, v174
    v_exp_f32 v190, v190
    v_exp_f32 v175, v175
    buffer_load_dwordx4 v20, s[28:31], s84 offen offset:2048 lds
    v_exp_f32 v191, v191
    v_exp_f32 v204, v204
    v_exp_f32 v220, v220
    v_exp_f32 v205, v205
    v_exp_f32 v221, v221
    v_exp_f32 v206, v206
    v_exp_f32 v222, v222
    v_exp_f32 v207, v207
    buffer_load_dwordx4 v20, s[28:31], s85 offen offset:3072 lds
    s_add_u32 m0, s81, 0x8000
    v_add_u32 v20, 0x10000, v20
    v_exp_f32 v223, v223
    v_cvt_pk_bf16_f32 v136, v128, v129
    v_add_f32 v140, 1.0, v140
    v_add_f32 v156, 1.0, v156
    v_cvt_pk_bf16_f32 v137, v130, v131
    v_add_f32 v141, 1.0, v141
    v_add_f32 v157, 1.0, v157
    v_cvt_pk_bf16_f32 v138, v132, v133
    v_add_f32 v142, 1.0, v142
    v_add_f32 v158, 1.0, v158
    v_cvt_pk_bf16_f32 v139, v134, v135
    v_add_f32 v143, 1.0, v143
    buffer_load_dwordx4 v46, s[4:7], s86 offen sc1 lds
    v_add_f32 v159, 1.0, v159
    v_cvt_pk_bf16_f32 v168, v160, v161
    v_add_f32 v172, 1.0, v172
    v_add_f32 v188, 1.0, v188
    v_cvt_pk_bf16_f32 v169, v162, v163
    v_add_f32 v173, 1.0, v173
    v_add_f32 v189, 1.0, v189
    v_cvt_pk_bf16_f32 v170, v164, v165
    v_add_f32 v174, 1.0, v174
    v_add_f32 v190, 1.0, v190
    v_cvt_pk_bf16_f32 v171, v166, v167
    v_add_f32 v175, 1.0, v175
    v_add_f32 v191, 1.0, v191
    v_cvt_pk_bf16_f32 v200, v192, v193
    v_add_f32 v204, 1.0, v204
    buffer_load_dwordx4 v46, s[4:7], s86 offen offset:1024 sc1 lds
    v_add_f32 v220, 1.0, v220
    v_cvt_pk_bf16_f32 v201, v194, v195
    v_add_f32 v205, 1.0, v205
    v_add_f32 v221, 1.0, v221
    v_cvt_pk_bf16_f32 v202, v196, v197
    v_add_f32 v206, 1.0, v206
    v_add_f32 v222, 1.0, v222
    v_cvt_pk_bf16_f32 v203, v198, v199
    v_add_f32 v207, 1.0, v207
    v_add_f32 v223, 1.0, v223
    v_lshlrev_b32 v128, 16, v136
    v_and_b32 v129, 0xffff0000, v136
    v_rcp_f32 v140, v140
    v_rcp_f32 v156, v156
    buffer_load_dwordx4 v46, s[4:7], s86 offen offset:2048 sc1 lds
    v_lshlrev_b32 v130, 16, v137
    v_and_b32 v131, 0xffff0000, v137
    v_rcp_f32 v141, v141
    v_rcp_f32 v157, v157
    v_lshlrev_b32 v132, 16, v138
    v_and_b32 v133, 0xffff0000, v138
    v_rcp_f32 v142, v142
    v_rcp_f32 v158, v158
    v_lshlrev_b32 v134, 16, v139
    v_and_b32 v135, 0xffff0000, v139
    v_rcp_f32 v143, v143
    buffer_load_dwordx4 v46, s[4:7], s86 offen offset:3072 sc1 lds
    s_add_u32 m0, s81, 0x14000
    s_add_u32 s86, s86, 0x1000
    v_rcp_f32 v159, v159
    v_lshlrev_b32 v160, 16, v168
    v_and_b32 v161, 0xffff0000, v168
    v_rcp_f32 v172, v172
    v_rcp_f32 v188, v188
    v_lshlrev_b32 v162, 16, v169
    v_and_b32 v163, 0xffff0000, v169
    v_rcp_f32 v173, v173
    v_rcp_f32 v189, v189
    buffer_load_dwordx4 v20, s[28:31], 0 offen lds
    v_lshlrev_b32 v164, 16, v170
    v_and_b32 v165, 0xffff0000, v170
    v_rcp_f32 v174, v174
    v_rcp_f32 v190, v190
    v_lshlrev_b32 v166, 16, v171
    v_and_b32 v167, 0xffff0000, v171
    v_rcp_f32 v175, v175
    v_rcp_f32 v191, v191
    v_lshlrev_b32 v192, 16, v200
    v_and_b32 v193, 0xffff0000, v200
    v_rcp_f32 v204, v204
    buffer_load_dwordx4 v20, s[28:31], s82 offen offset:1024 lds
    v_rcp_f32 v220, v220
    v_lshlrev_b32 v194, 16, v201
    v_and_b32 v195, 0xffff0000, v201
    v_rcp_f32 v205, v205
    v_rcp_f32 v221, v221
    v_lshlrev_b32 v196, 16, v202
    v_and_b32 v197, 0xffff0000, v202
    v_rcp_f32 v206, v206
    v_rcp_f32 v222, v222
    v_lshlrev_b32 v198, 16, v203
    buffer_load_dwordx4 v20, s[28:31], s84 offen offset:2048 lds
    v_and_b32 v199, 0xffff0000, v203
    v_rcp_f32 v207, v207
    v_rcp_f32 v223, v223
    v_add_f32 v128, v128, v36
    v_add_f32 v129, v129, v36
    v_add_f32 v130, v130, v36
    v_add_f32 v131, v131, v36
    v_add_f32 v132, v132, v36
    v_add_f32 v133, v133, v36
    v_add_f32 v134, v134, v36
    v_add_f32 v135, v135, v36
    v_add_f32 v160, v160, v37
    v_add_f32 v161, v161, v37
    buffer_load_dwordx4 v20, s[28:31], s85 offen offset:3072 lds
    s_add_u32 m0, s81, 0x10000
    v_add_u32 v20, 0x10000, v20
    v_add_f32 v162, v162, v37
    v_add_f32 v163, v163, v37
    v_add_f32 v164, v164, v37
    v_add_f32 v165, v165, v37
    v_add_f32 v166, v166, v37
    v_add_f32 v167, v167, v37
    v_add_f32 v192, v192, v38
    v_add_f32 v193, v193, v38
    v_add_f32 v194, v194, v38
    v_add_f32 v195, v195, v38
    v_add_f32 v196, v196, v38
    v_add_f32 v197, v197, v38
    v_add_f32 v198, v198, v38
    buffer_load_dwordx4 v46, s[4:7], s86 offen sc1 lds
    v_add_f32 v199, v199, v38
    v_cvt_pk_bf16_f32 v136, v128, v129
    v_cvt_pk_bf16_f32 v137, v130, v131
    v_cvt_pk_bf16_f32 v138, v132, v133
    v_cvt_pk_bf16_f32 v139, v134, v135
    v_cvt_pk_bf16_f32 v168, v160, v161
    v_cvt_pk_bf16_f32 v169, v162, v163
    v_cvt_pk_bf16_f32 v170, v164, v165
    v_cvt_pk_bf16_f32 v171, v166, v167
    v_cvt_pk_bf16_f32 v200, v192, v193
    v_cvt_pk_bf16_f32 v201, v194, v195
    v_cvt_pk_bf16_f32 v202, v196, v197
    v_cvt_pk_bf16_f32 v203, v198, v199
    v_lshlrev_b32 v128, 16, v136
    v_and_b32 v129, 0xffff0000, v136
    buffer_load_dwordx4 v46, s[4:7], s86 offen offset:1024 sc1 lds
    v_mul_f32 v144, v144, v140
    v_mul_f32 v145, v145, v156
    v_lshlrev_b32 v130, 16, v137
    v_and_b32 v131, 0xffff0000, v137
    v_mul_f32 v146, v146, v141
    v_mul_f32 v147, v147, v157
    v_lshlrev_b32 v132, 16, v138
    v_and_b32 v133, 0xffff0000, v138
    v_mul_f32 v148, v148, v142
    v_mul_f32 v149, v149, v158
    v_lshlrev_b32 v134, 16, v139
    v_and_b32 v135, 0xffff0000, v139
    v_mul_f32 v150, v150, v143
    v_mul_f32 v151, v151, v159
    v_lshlrev_b32 v160, 16, v168
    buffer_load_dwordx4 v46, s[4:7], s86 offen offset:2048 sc1 lds
    v_and_b32 v161, 0xffff0000, v168
    v_mul_f32 v176, v176, v172
    v_mul_f32 v177, v177, v188
    v_lshlrev_b32 v162, 16, v169
    v_and_b32 v163, 0xffff0000, v169
    v_mul_f32 v178, v178, v173
    v_mul_f32 v179, v179, v189
    v_lshlrev_b32 v164, 16, v170
    v_and_b32 v165, 0xffff0000, v170
    v_mul_f32 v180, v180, v174
    v_mul_f32 v181, v181, v190
    v_lshlrev_b32 v166, 16, v171
    v_and_b32 v167, 0xffff0000, v171
    v_mul_f32 v182, v182, v175
    v_mul_f32 v183, v183, v191
    buffer_load_dwordx4 v46, s[4:7], s86 offen offset:3072 sc1 lds
    s_add_u32 m0, s81, 0x1c000
    s_add_u32 s86, s86, 0x1000
    v_lshlrev_b32 v192, 16, v200
    v_and_b32 v193, 0xffff0000, v200
    v_mul_f32 v208, v208, v204
    v_mul_f32 v209, v209, v220
    v_lshlrev_b32 v194, 16, v201
    v_and_b32 v195, 0xffff0000, v201
    v_mul_f32 v210, v210, v205
    v_mul_f32 v211, v211, v221
    v_lshlrev_b32 v196, 16, v202
    v_and_b32 v197, 0xffff0000, v202
    v_mul_f32 v212, v212, v206
    v_mul_f32 v213, v213, v222
    v_lshlrev_b32 v198, 16, v203
    buffer_load_dwordx4 v20, s[28:31], 0 offen lds
    v_and_b32 v199, 0xffff0000, v203
    v_mul_f32 v214, v214, v207
    v_mul_f32 v215, v215, v223
    v_cvt_pk_bf16_f32 v136, v144, v145
    v_cvt_pk_bf16_f32 v137, v146, v147
    v_cvt_pk_bf16_f32 v138, v148, v149
    v_cvt_pk_bf16_f32 v139, v150, v151
    v_cvt_pk_bf16_f32 v168, v176, v177
    v_cvt_pk_bf16_f32 v169, v178, v179
    v_cvt_pk_bf16_f32 v170, v180, v181
    v_cvt_pk_bf16_f32 v171, v182, v183
    v_cvt_pk_bf16_f32 v200, v208, v209
    v_cvt_pk_bf16_f32 v201, v210, v211
    v_cvt_pk_bf16_f32 v202, v212, v213
    v_cvt_pk_bf16_f32 v203, v214, v215
    buffer_load_dwordx4 v20, s[28:31], s82 offen offset:1024 lds
    v_lshlrev_b32 v144, 16, v136
    v_and_b32 v145, 0xffff0000, v136
    v_lshlrev_b32 v146, 16, v137
    v_and_b32 v147, 0xffff0000, v137
    v_lshlrev_b32 v148, 16, v138
    v_and_b32 v149, 0xffff0000, v138
    v_lshlrev_b32 v150, 16, v139
    v_and_b32 v151, 0xffff0000, v139
    v_lshlrev_b32 v176, 16, v168
    v_and_b32 v177, 0xffff0000, v168
    v_lshlrev_b32 v178, 16, v169
    v_and_b32 v179, 0xffff0000, v169
    v_lshlrev_b32 v180, 16, v170
    v_and_b32 v181, 0xffff0000, v170
    v_lshlrev_b32 v182, 16, v171
    buffer_load_dwordx4 v20, s[28:31], s84 offen offset:2048 lds
    v_and_b32 v183, 0xffff0000, v171
    v_lshlrev_b32 v208, 16, v200
    v_and_b32 v209, 0xffff0000, v200
    v_lshlrev_b32 v210, 16, v201
    v_and_b32 v211, 0xffff0000, v201
    v_lshlrev_b32 v212, 16, v202
    v_and_b32 v213, 0xffff0000, v202
    v_lshlrev_b32 v214, 16, v203
    v_and_b32 v215, 0xffff0000, v203
    v_mul_f32 v128, v128, v144
    v_mul_f32 v129, v129, v145
    v_mul_f32 v130, v130, v146
    v_mul_f32 v131, v131, v147
    v_mul_f32 v132, v132, v148
    v_mul_f32 v133, v133, v149
    buffer_load_dwordx4 v20, s[28:31], s85 offen offset:3072 lds
    s_add_u32 m0, s81, 0x18000
    v_add_u32 v20, 0x10000, v20
    v_mul_f32 v134, v134, v150
    v_mul_f32 v135, v135, v151
    v_mul_f32 v160, v160, v176
    v_mul_f32 v161, v161, v177
    v_mul_f32 v162, v162, v178
    v_mul_f32 v163, v163, v179
    v_mul_f32 v164, v164, v180
    v_mul_f32 v165, v165, v181
    v_mul_f32 v166, v166, v182
    v_mul_f32 v167, v167, v183
    v_mul_f32 v192, v192, v208
    v_mul_f32 v193, v193, v209
    v_mul_f32 v194, v194, v210
    buffer_load_dwordx4 v46, s[4:7], s86 offen sc1 lds
    v_mul_f32 v195, v195, v211
    v_mul_f32 v196, v196, v212
    v_mul_f32 v197, v197, v213
    v_mul_f32 v198, v198, v214
    v_mul_f32 v199, v199, v215
    v_cvt_pk_bf16_f32 v152, v128, v129
    v_cvt_pk_bf16_f32 v153, v130, v131
    v_cvt_pk_bf16_f32 v154, v132, v133
    v_cvt_pk_bf16_f32 v155, v134, v135
    v_cvt_pk_bf16_f32 v184, v160, v161
    v_cvt_pk_bf16_f32 v185, v162, v163
    v_cvt_pk_bf16_f32 v186, v164, v165
    v_cvt_pk_bf16_f32 v187, v166, v167
    v_cvt_pk_bf16_f32 v216, v192, v193
    v_cvt_pk_bf16_f32 v217, v194, v195
    buffer_load_dwordx4 v46, s[4:7], s86 offen offset:1024 sc1 lds
    v_cvt_pk_bf16_f32 v218, v196, v197
    v_cvt_pk_bf16_f32 v219, v198, v199
    ds_read_b128 v[96:99], v22 offset:32768
    ds_read_b64_tr_b16 v[224:225], v26 offset:32768
    ds_read_b64_tr_b16 v[226:227], v26 offset:33792
    ds_read_b128 v[100:103], v22 offset:36864
    ds_read_b64_tr_b16 v[228:229], v27 offset:32768
    buffer_load_dwordx4 v46, s[4:7], s86 offen offset:2048 sc1 lds
    ds_read_b64_tr_b16 v[230:231], v27 offset:33792
    ds_read_b128 v[104:107], v22 offset:33792
    ds_read_b64_tr_b16 v[232:233], v26 offset:36864
    ds_read_b64_tr_b16 v[234:235], v26 offset:37888
    ds_read_b128 v[108:111], v22 offset:37888
    ds_read_b64_tr_b16 v[236:237], v27 offset:36864
    buffer_load_dwordx4 v46, s[4:7], s86 offen offset:3072 sc1 lds
    s_add_u32 m0, s81, 0x24000
    s_add_u32 s86, s86, 0x1000
    ds_read_b64_tr_b16 v[238:239], v27 offset:37888
    ds_read_b128 v[112:115], v22 offset:34816
    ds_read_b64_tr_b16 v[240:241], v26 offset:40960
    s_waitcnt lgkmcnt(11)
    v_mfma_f32_32x32x16_bf16 a[0:15], v[224:227], v[96:99], a[0:15]
    ds_read_b64_tr_b16 v[242:243], v26 offset:41984
    buffer_store_dwordx4 v[152:155], v46, s[4:7], s0 offen sc1
    s_lshl_b32 s0, s47, 7
    s_add_u32 s58, s58, s0
    s_waitcnt lgkmcnt(11)
    v_mfma_f32_32x32x16_bf16 a[16:31], v[224:227], v[100:103], a[16:31]
    s_add_u32 s59, s59, s0
    s_add_u32 s32, s54, s58
    s_addc_u32 s33, s55, 0
    s_lshl_b32 s0, s46, 1
    s_sub_u32 s34, 0xac000, s58
    s_waitcnt lgkmcnt(9)
    v_mfma_f32_32x32x16_bf16 a[32:47], v[228:231], v[96:99], a[32:47]
    s_add_u32 s0, s0, 0
    s_mul_i32 s0, s0, 44
    s_mul_i32 s58, s62, 11
    s_add_u32 s0, s0, s58
    s_lshl_b32 s0, s0, 10
    s_add_u32 s41, s0, 0xa00000
    v_mfma_f32_32x32x16_bf16 a[48:63], v[228:231], v[100:103], a[48:63]
    s_lshl_b32 s0, s46, 1
    s_add_u32 s0, s0, 1
    s_mul_i32 s0, s0, 44
    s_mul_i32 s58, s62, 11
    s_add_u32 s0, s0, s58
    s_waitcnt lgkmcnt(6)
    v_mfma_f32_32x32x16_bf16 a[0:15], v[232:235], v[104:107], a[0:15]
    s_lshl_b32 s0, s0, 10
    s_add_u32 s42, s0, 0xa00000
    s_add_u32 s20, s36, s59
    s_addc_u32 s21, s37, 0
    s_and_b32 s0, s62, 1
    s_waitcnt lgkmcnt(4)
    v_mfma_f32_32x32x16_bf16 a[16:31], v[232:235], v[108:111], a[16:31]
    s_lshl_b32 s0, s0, 15
    s_and_b32 s21, s21, 0xffff
    s_add_u32 s43, s43, s0
    s_and_b32 s33, s33, 0xffff
    s_lshl_b32 s0, s62, 14
    s_waitcnt lgkmcnt(1)
    v_mfma_f32_32x32x16_bf16 a[32:47], v[236:239], v[104:107], a[32:47]
    s_add_u32 s0, s0, 0x18000
    v_add_u32 v17, s0, v46
    s_and_b32 s58, s62, 1
    buffer_store_dwordx4 v[184:187], v46, s[4:7], s1 offen sc1
    s_and_b32 s1, s64, 3
    v_add_u32 v54, s1, v54
    v_mfma_f32_32x32x16_bf16 a[48:63], v[236:239], v[108:111], a[48:63]
    v_min_u32 v54, 31, v54
    v_lshlrev_b32 v54, 2, v54
    ds_read_b128 v[116:119], v22 offset:38912
    s_add_u32 s24, s56, s59
    s_addc_u32 s25, s57, 0
    s_waitcnt lgkmcnt(1)
    v_mfma_f32_32x32x16_bf16 a[0:15], v[240:243], v[112:115], a[0:15]
    ds_read_b64_tr_b16 v[244:245], v27 offset:40960
    s_sub_u32 s26, 0x200000, s59
    s_lshr_b32 s59, s46, 1
    s_and_b32 s59, s59, 1
    s_lshl_b32 s59, s59, 4
    s_add_u32 s59, s59, s60
    s_mul_i32 s60, s99, 0x7ffffff0
    buffer_store_dwordx4 v[216:219], v46, s[4:7], s3 offen sc1
    s_mul_i32 s3, s99, 0x7ffffff0
    v_or_b32 v54, s3, v54
    s_lshl_b32 s3, s46, 1
    s_add_u32 s3, s3, s58
    s_lshl_b32 s3, s3, 4
    s_lshl_b32 s58, s47, 1
    s_add_u32 s3, s3, s58
    s_lshr_b32 s58, s62, 1
    s_add_u32 s3, s3, s58
    s_lshl_b32 s3, s3, 11
    s_add_u32 s3, s3, 0x2000000
    s_add_u32 s88, s3, 0
    s_add_u32 s90, s3, 0x400000
    s_add_u32 s91, s3, 0x600000
    ds_read_b64_tr_b16 v[246:247], v27 offset:41984
    s_lshl_b32 s1, s62, 12
    ds_read_b128 v[120:123], v22 offset:35840
    s_add_u32 s1, s1, 0x18000
    v_add_u32 v18, s1, v46
    s_and_b32 s25, s25, 0xffff
    s_waitcnt lgkmcnt(3)
    v_mfma_f32_32x32x16_bf16 a[16:31], v[240:243], v[116:119], a[16:31]
    ds_read_b128 v[124:127], v22 offset:39936
    ds_read_b64_tr_b16 v[248:249], v26 offset:45056
    ds_read_b64_tr_b16 v[250:251], v26 offset:46080
    ds_read_b64_tr_b16 v[252:253], v27 offset:45056
    ds_read_b64_tr_b16 v[254:255], v27 offset:46080
    s_waitcnt lgkmcnt(6)
    v_mfma_f32_32x32x16_bf16 a[32:47], v[244:247], v[112:115], a[32:47]
    v_mfma_f32_32x32x16_bf16 a[48:63], v[244:247], v[116:119], a[48:63]
    s_waitcnt lgkmcnt(2)
    v_mfma_f32_32x32x16_bf16 a[0:15], v[248:251], v[120:123], a[0:15]
    s_waitcnt vmcnt(27) lgkmcnt(0)
    s_barrier
    buffer_load_dwordx4 v20, s[28:31], 0 offen lds
    v_mfma_f32_32x32x16_bf16 a[16:31], v[248:251], v[124:127], a[16:31]
    ds_read_b128 v[96:99], v21
    ds_read_b64_tr_b16 v[224:225], v24
    v_mfma_f32_32x32x16_bf16 a[32:47], v[252:255], v[120:123], a[32:47]
    ds_read_b64_tr_b16 v[226:227], v24 offset:1024
    ds_read_b128 v[100:103], v21 offset:4096
    buffer_load_dwordx4 v20, s[28:31], s82 offen offset:1024 lds
    v_mfma_f32_32x32x16_bf16 a[48:63], v[252:255], v[124:127], a[48:63]
    ds_read_b64_tr_b16 v[228:229], v25
    ds_read_b64_tr_b16 v[230:231], v25 offset:1024
    ds_read_b128 v[104:107], v21 offset:1024
    ds_read_b64_tr_b16 v[232:233], v24 offset:4096
    ds_read_b64_tr_b16 v[234:235], v24 offset:5120
    ds_read_b128 v[108:111], v21 offset:5120
    buffer_load_dwordx4 v20, s[28:31], s84 offen offset:2048 lds
    ds_read_b64_tr_b16 v[236:237], v25 offset:4096
    ds_read_b64_tr_b16 v[238:239], v25 offset:5120
    ds_read_b128 v[112:115], v21 offset:2048
    ds_read_b64_tr_b16 v[240:241], v24 offset:8192
    s_waitcnt lgkmcnt(11)
    v_mfma_f32_32x32x16_bf16 a[0:15], v[224:227], v[96:99], a[0:15]
    buffer_load_dwordx4 v20, s[28:31], s85 offen offset:3072 lds
    s_add_u32 m0, s81, 0x20000
    v_add_u32 v20, 0x10000, v20
    ds_read_b64_tr_b16 v[242:243], v24 offset:9216
    s_waitcnt lgkmcnt(11)
    v_mfma_f32_32x32x16_bf16 a[16:31], v[224:227], v[100:103], a[16:31]
    ds_read_b128 v[116:119], v21 offset:6144
    ds_read_b64_tr_b16 v[244:245], v25 offset:8192
    s_waitcnt lgkmcnt(11)
    v_mfma_f32_32x32x16_bf16 a[32:47], v[228:231], v[96:99], a[32:47]
    buffer_load_dwordx4 v46, s[4:7], s86 offen sc1 lds
    ds_read_b64_tr_b16 v[246:247], v25 offset:9216
    ds_read_b128 v[120:123], v21 offset:3072
    v_mfma_f32_32x32x16_bf16 a[48:63], v[228:231], v[100:103], a[48:63]
    ds_read_b128 v[124:127], v21 offset:7168
    ds_read_b64_tr_b16 v[248:249], v24 offset:12288
    s_waitcnt lgkmcnt(12)
    v_mfma_f32_32x32x16_bf16 a[0:15], v[232:235], v[104:107], a[0:15]
    buffer_load_dwordx4 v46, s[4:7], s86 offen offset:1024 sc1 lds
    ds_read_b64_tr_b16 v[250:251], v24 offset:13312
    ds_read_b64_tr_b16 v[252:253], v25 offset:12288
    s_waitcnt lgkmcnt(12)
    v_mfma_f32_32x32x16_bf16 a[16:31], v[232:235], v[108:111], a[16:31]
    ds_read_b64_tr_b16 v[254:255], v25 offset:13312
    s_waitcnt lgkmcnt(10)
    v_mfma_f32_32x32x16_bf16 a[32:47], v[236:239], v[104:107], a[32:47]
    buffer_load_dwordx4 v46, s[4:7], s86 offen offset:2048 sc1 lds
    v_mfma_f32_32x32x16_bf16 a[48:63], v[236:239], v[108:111], a[48:63]
    s_waitcnt lgkmcnt(7)
    v_mfma_f32_32x32x16_bf16 a[0:15], v[240:243], v[112:115], a[0:15]
    buffer_load_dwordx4 v46, s[4:7], s86 offen offset:3072 sc1 lds
    s_add_u32 m0, s81, 0x4000
    s_add_u32 s86, s86, 0x1000
    v_mfma_f32_32x32x16_bf16 a[16:31], v[240:243], v[116:119], a[16:31]
    s_waitcnt lgkmcnt(3)
    v_mfma_f32_32x32x16_bf16 a[32:47], v[244:247], v[112:115], a[32:47]
    s_waitcnt vmcnt(27) lgkmcnt(0)
    s_barrier
    buffer_load_dwordx4 v20, s[28:31], 0 offen lds
    v_mfma_f32_32x32x16_bf16 a[48:63], v[244:247], v[116:119], a[48:63]
    ds_read_b128 v[96:99], v21 offset:32768
    ds_read_b64_tr_b16 v[224:225], v24 offset:32768
    v_mfma_f32_32x32x16_bf16 a[0:15], v[248:251], v[120:123], a[0:15]
    ds_read_b64_tr_b16 v[226:227], v24 offset:33792
    ds_read_b128 v[100:103], v21 offset:36864
    buffer_load_dwordx4 v20, s[28:31], s82 offen offset:1024 lds
    v_mfma_f32_32x32x16_bf16 a[16:31], v[248:251], v[124:127], a[16:31]
    ds_read_b64_tr_b16 v[228:229], v25 offset:32768
    ds_read_b64_tr_b16 v[230:231], v25 offset:33792
    ds_read_b128 v[104:107], v21 offset:33792
    v_mfma_f32_32x32x16_bf16 a[32:47], v[252:255], v[120:123], a[32:47]
    ds_read_b64_tr_b16 v[232:233], v24 offset:36864
    ds_read_b64_tr_b16 v[234:235], v24 offset:37888
    ds_read_b128 v[108:111], v21 offset:37888
    buffer_load_dwordx4 v20, s[28:31], s84 offen offset:2048 lds
    v_mfma_f32_32x32x16_bf16 a[48:63], v[252:255], v[124:127], a[48:63]
    ds_read_b64_tr_b16 v[236:237], v25 offset:36864
    ds_read_b64_tr_b16 v[238:239], v25 offset:37888
    ds_read_b128 v[112:115], v21 offset:34816
    ds_read_b64_tr_b16 v[240:241], v24 offset:40960
    s_waitcnt lgkmcnt(11)
    v_mfma_f32_32x32x16_bf16 a[0:15], v[224:227], v[96:99], a[0:15]
    buffer_load_dwordx4 v20, s[28:31], s85 offen offset:3072 lds
    s_add_u32 m0, s81, 0
    v_add_u32 v20, 0x10000, v20
    ds_read_b64_tr_b16 v[242:243], v24 offset:41984
    s_waitcnt lgkmcnt(11)
    v_mfma_f32_32x32x16_bf16 a[16:31], v[224:227], v[100:103], a[16:31]
    ds_read_b128 v[116:119], v21 offset:38912
    ds_read_b64_tr_b16 v[244:245], v25 offset:40960
    s_waitcnt lgkmcnt(11)
    v_mfma_f32_32x32x16_bf16 a[32:47], v[228:231], v[96:99], a[32:47]
    buffer_load_dwordx4 v46, s[4:7], s86 offen sc1 lds
    ds_read_b64_tr_b16 v[246:247], v25 offset:41984
    ds_read_b128 v[120:123], v21 offset:35840
    v_mfma_f32_32x32x16_bf16 a[48:63], v[228:231], v[100:103], a[48:63]
    ds_read_b128 v[124:127], v21 offset:39936
    ds_read_b64_tr_b16 v[248:249], v24 offset:45056
    s_waitcnt lgkmcnt(12)
    v_mfma_f32_32x32x16_bf16 a[0:15], v[232:235], v[104:107], a[0:15]
    buffer_load_dwordx4 v46, s[4:7], s86 offen offset:1024 sc1 lds
    ds_read_b64_tr_b16 v[250:251], v24 offset:46080
    ds_read_b64_tr_b16 v[252:253], v25 offset:45056
    s_waitcnt lgkmcnt(12)
    v_mfma_f32_32x32x16_bf16 a[16:31], v[232:235], v[108:111], a[16:31]
    ds_read_b64_tr_b16 v[254:255], v25 offset:46080
    s_waitcnt lgkmcnt(10)
    v_mfma_f32_32x32x16_bf16 a[32:47], v[236:239], v[104:107], a[32:47]
    buffer_load_dwordx4 v46, s[4:7], s86 offen offset:2048 sc1 lds
    v_mfma_f32_32x32x16_bf16 a[48:63], v[236:239], v[108:111], a[48:63]
    s_waitcnt lgkmcnt(7)
    v_mfma_f32_32x32x16_bf16 a[0:15], v[240:243], v[112:115], a[0:15]
    buffer_load_dwordx4 v46, s[4:7], s86 offen offset:3072 sc1 lds
    s_add_u32 m0, s81, 0xc000
    s_add_u32 s86, s86, 0x1000
    v_mfma_f32_32x32x16_bf16 a[16:31], v[240:243], v[116:119], a[16:31]
    s_waitcnt lgkmcnt(3)
    v_mfma_f32_32x32x16_bf16 a[32:47], v[244:247], v[112:115], a[32:47]
    v_mfma_f32_32x32x16_bf16 a[48:63], v[244:247], v[116:119], a[48:63]
    s_waitcnt lgkmcnt(0)
    v_mfma_f32_32x32x16_bf16 a[0:15], v[248:251], v[120:123], a[0:15]
    v_mfma_f32_32x32x16_bf16 a[16:31], v[248:251], v[124:127], a[16:31]
    v_mfma_f32_32x32x16_bf16 a[32:47], v[252:255], v[120:123], a[32:47]
    v_mfma_f32_32x32x16_bf16 a[48:63], v[252:255], v[124:127], a[48:63]
    s_waitcnt vmcnt(16)
    s_barrier
    buffer_store_dword v59, v58, s[4:7], s89 offen sc1
    s_lshl_b32 s89, s87, 7
    s_add_u32 s89, s89, s94
    s_add_u32 s89, s89, 0x82800
    buffer_load_dwordx4 v20, s[28:31], 0 offen lds
    ds_read_b128 v[96:99], v23
    ds_read_b64_tr_b16 v[224:225], v28
    ds_read_b64_tr_b16 v[226:227], v28 offset:1024
    ds_read_b128 v[100:103], v23 offset:4096
    ds_read_b64_tr_b16 v[228:229], v29
    ds_read_b64_tr_b16 v[230:231], v29 offset:1024
    buffer_load_dwordx4 v20, s[28:31], s82 offen offset:1024 lds
    ds_read_b128 v[104:107], v23 offset:1024
    ds_read_b64_tr_b16 v[232:233], v28 offset:4096
    ds_read_b64_tr_b16 v[234:235], v28 offset:5120
    ds_read_b128 v[108:111], v23 offset:5120
    ds_read_b64_tr_b16 v[236:237], v29 offset:4096
    ds_read_b64_tr_b16 v[238:239], v29 offset:5120
    buffer_load_dwordx4 v20, s[28:31], s84 offen offset:2048 lds
    ds_read_b128 v[112:115], v23 offset:2048
    ds_read_b64_tr_b16 v[240:241], v28 offset:8192
    ds_read_b64_tr_b16 v[242:243], v28 offset:9216
    s_waitcnt lgkmcnt(12)
    v_mfma_f32_32x32x16_bf16 a[0:15], v[224:227], v[96:99], a[0:15]
    ds_read_b128 v[116:119], v23 offset:6144
    buffer_load_dwordx4 v20, s[28:31], s85 offen offset:3072 lds
    s_waitcnt lgkmcnt(12)
    v_mfma_f32_32x32x16_bf16 a[16:31], v[224:227], v[100:103], a[16:31]
    s_add_u32 m0, s81, 0x8000
    v_add_u32 v20, 0x10000, v20
    ds_read_b64_tr_b16 v[244:245], v29 offset:8192
    ds_read_b64_tr_b16 v[246:247], v29 offset:9216
    s_waitcnt lgkmcnt(12)
    v_mfma_f32_32x32x16_bf16 a[32:47], v[228:231], v[96:99], a[32:47]
    ds_read_b128 v[120:123], v23 offset:3072
    buffer_load_dwordx4 v46, s[4:7], s86 offen sc1 lds
    ds_read_b128 v[124:127], v23 offset:7168
    v_mfma_f32_32x32x16_bf16 a[48:63], v[228:231], v[100:103], a[48:63]
    ds_read_b64_tr_b16 v[248:249], v28 offset:12288
    ds_read_b64_tr_b16 v[250:251], v28 offset:13312
    s_waitcnt lgkmcnt(13)
    v_mfma_f32_32x32x16_bf16 a[0:15], v[232:235], v[104:107], a[0:15]
    ds_read_b64_tr_b16 v[252:253], v29 offset:12288
    ds_read_b64_tr_b16 v[254:255], v29 offset:13312
    buffer_load_dwordx4 v46, s[4:7], s86 offen offset:1024 sc1 lds
    s_waitcnt lgkmcnt(12)
    v_mfma_f32_32x32x16_bf16 a[16:31], v[232:235], v[108:111], a[16:31]
    v_mfma_f32_32x32x16_bf16 a[32:47], v[236:239], v[104:107], a[32:47]
    buffer_load_dwordx4 v46, s[4:7], s86 offen offset:2048 sc1 lds
    v_mfma_f32_32x32x16_bf16 a[48:63], v[236:239], v[108:111], a[48:63]
    s_waitcnt lgkmcnt(6)
    v_mfma_f32_32x32x16_bf16 a[0:15], v[240:243], v[112:115], a[0:15]
    buffer_load_dwordx4 v46, s[4:7], s86 offen offset:3072 sc1 lds
    s_add_u32 m0, s81, 0x14000
    s_add_u32 s86, s86, 0x1000
    v_mfma_f32_32x32x16_bf16 a[16:31], v[240:243], v[116:119], a[16:31]
    s_waitcnt lgkmcnt(0)
    s_barrier
    ds_read_b128 v[96:99], v22
    v_mfma_f32_32x32x16_bf16 a[32:47], v[244:247], v[112:115], a[32:47]
    ds_read_b64_tr_b16 v[224:225], v26
    buffer_load_dwordx4 v20, s[28:31], 0 offen lds
    ds_read_b64_tr_b16 v[226:227], v26 offset:1024
    v_mfma_f32_32x32x16_bf16 a[48:63], v[244:247], v[116:119], a[48:63]
    ds_read_b128 v[100:103], v22 offset:4096
    ds_read_b64_tr_b16 v[228:229], v27
    v_mfma_f32_32x32x16_bf16 a[0:15], v[248:251], v[120:123], a[0:15]
    ds_read_b64_tr_b16 v[230:231], v27 offset:1024
    ds_read_b128 v[104:107], v22 offset:1024
    buffer_load_dwordx4 v20, s[28:31], s82 offen offset:1024 lds
    v_mfma_f32_32x32x16_bf16 a[16:31], v[248:251], v[124:127], a[16:31]
    ds_read_b64_tr_b16 v[232:233], v26 offset:4096
    ds_read_b64_tr_b16 v[234:235], v26 offset:5120
    ds_read_b128 v[108:111], v22 offset:5120
    v_mfma_f32_32x32x16_bf16 a[32:47], v[252:255], v[120:123], a[32:47]
    ds_read_b64_tr_b16 v[236:237], v27 offset:4096
    ds_read_b64_tr_b16 v[238:239], v27 offset:5120
    buffer_load_dwordx4 v20, s[28:31], s84 offen offset:2048 lds
    ds_read_b128 v[112:115], v22 offset:2048
    v_mfma_f32_32x32x16_bf16 a[48:63], v[252:255], v[124:127], a[48:63]
    ds_read_b64_tr_b16 v[240:241], v26 offset:8192
    ds_read_b64_tr_b16 v[242:243], v26 offset:9216
    ds_read_b128 v[116:119], v22 offset:6144
    s_waitcnt lgkmcnt(13)
    v_mfma_f32_32x32x16_bf16 a[0:15], v[224:227], v[96:99], a[0:15]
    ds_read_b64_tr_b16 v[244:245], v27 offset:8192
    ds_read_b64_tr_b16 v[246:247], v27 offset:9216
    buffer_load_dwordx4 v20, s[28:31], s85 offen offset:3072 lds
    s_add_u32 m0, s81, 0x10000
    s_waitcnt lgkmcnt(14)
    v_mfma_f32_32x32x16_bf16 a[16:31], v[224:227], v[100:103], a[16:31]
    v_add_u32 v20, 0x10000, v20
    ds_read_b128 v[120:123], v22 offset:3072
    s_waitcnt lgkmcnt(13)
    v_mfma_f32_32x32x16_bf16 a[32:47], v[228:231], v[96:99], a[32:47]
    ds_read_b128 v[124:127], v22 offset:7168
    buffer_load_dwordx4 v46, s[4:7], s86 offen sc1 lds
    ds_read_b64_tr_b16 v[248:249], v26 offset:12288
    v_mfma_f32_32x32x16_bf16 a[48:63], v[228:231], v[100:103], a[48:63]
    ds_read_b64_tr_b16 v[250:251], v26 offset:13312
    ds_read_b64_tr_b16 v[252:253], v27 offset:12288
    ds_read_b64_tr_b16 v[254:255], v27 offset:13312
    s_waitcnt lgkmcnt(15)
    v_mfma_f32_32x32x16_bf16 a[0:15], v[232:235], v[104:107], a[0:15]
    buffer_load_dwordx4 v46, s[4:7], s86 offen offset:1024 sc1 lds
    s_waitcnt lgkmcnt(11)
    v_mfma_f32_32x32x16_bf16 a[16:31], v[232:235], v[108:111], a[16:31]
    v_mfma_f32_32x32x16_bf16 a[32:47], v[236:239], v[104:107], a[32:47]
    buffer_load_dwordx4 v46, s[4:7], s86 offen offset:2048 sc1 lds
    v_mfma_f32_32x32x16_bf16 a[48:63], v[236:239], v[108:111], a[48:63]
    s_waitcnt lgkmcnt(5)
    v_mfma_f32_32x32x16_bf16 a[0:15], v[240:243], v[112:115], a[0:15]
    s_waitcnt vmcnt(24) lgkmcnt(0)
    s_barrier
    buffer_load_dwordx4 v46, s[4:7], s86 offen offset:3072 sc1 lds
    v_mfma_f32_32x32x16_bf16 a[16:31], v[240:243], v[116:119], a[16:31]
    s_add_u32 m0, s81, 0x1c000
    s_add_u32 s86, s86, 0x1000
    ds_read_b128 v[96:99], v22 offset:32768
    v_mfma_f32_32x32x16_bf16 a[32:47], v[244:247], v[112:115], a[32:47]
    ds_read_b64_tr_b16 v[224:225], v26 offset:32768
    ds_read_b64_tr_b16 v[226:227], v26 offset:33792
    ds_read_b128 v[100:103], v22 offset:36864
    buffer_load_dwordx4 v20, s[28:31], 0 offen lds
    v_mfma_f32_32x32x16_bf16 a[48:63], v[244:247], v[116:119], a[48:63]
    ds_read_b64_tr_b16 v[228:229], v27 offset:32768
    ds_read_b64_tr_b16 v[230:231], v27 offset:33792
    ds_read_b128 v[104:107], v22 offset:33792
    v_mfma_f32_32x32x16_bf16 a[0:15], v[248:251], v[120:123], a[0:15]
    ds_read_b64_tr_b16 v[232:233], v26 offset:36864
    ds_read_b64_tr_b16 v[234:235], v26 offset:37888
    ds_read_b128 v[108:111], v22 offset:37888
    buffer_load_dwordx4 v20, s[28:31], s82 offen offset:1024 lds
    v_mfma_f32_32x32x16_bf16 a[16:31], v[248:251], v[124:127], a[16:31]
    ds_read_b64_tr_b16 v[236:237], v27 offset:36864
    ds_read_b64_tr_b16 v[238:239], v27 offset:37888
    ds_read_b128 v[112:115], v22 offset:34816
    v_mfma_f32_32x32x16_bf16 a[32:47], v[252:255], v[120:123], a[32:47]
    ds_read_b64_tr_b16 v[240:241], v26 offset:40960
    ds_read_b64_tr_b16 v[242:243], v26 offset:41984
    ds_read_b128 v[116:119], v22 offset:38912
    buffer_load_dwordx4 v20, s[28:31], s84 offen offset:2048 lds
    v_mfma_f32_32x32x16_bf16 a[48:63], v[252:255], v[124:127], a[48:63]
    ds_read_b64_tr_b16 v[244:245], v27 offset:40960
    ds_read_b64_tr_b16 v[246:247], v27 offset:41984
    ds_read_b128 v[120:123], v22 offset:35840
    s_waitcnt lgkmcnt(15)
    v_mfma_f32_32x32x16_bf16 a[0:15], v[224:227], v[96:99], a[0:15]
    ds_read_b128 v[124:127], v22 offset:39936
    ds_read_b64_tr_b16 v[248:249], v26 offset:45056
    buffer_load_dwordx4 v20, s[28:31], s85 offen offset:3072 lds
    v_mfma_f32_32x32x16_bf16 a[16:31], v[224:227], v[100:103], a[16:31]
    s_add_u32 m0, s81, 0x18000
    v_add_u32 v20, 0x10000, v20
    ds_read_b64_tr_b16 v[250:251], v26 offset:46080
    ds_read_b64_tr_b16 v[252:253], v27 offset:45056
    s_waitcnt lgkmcnt(15)
    v_mfma_f32_32x32x16_bf16 a[32:47], v[228:231], v[96:99], a[32:47]
    ds_read_b64_tr_b16 v[254:255], v27 offset:46080
    buffer_load_dwordx4 v46, s[4:7], s86 offen sc1 lds
    v_mfma_f32_32x32x16_bf16 a[48:63], v[228:231], v[100:103], a[48:63]
    s_waitcnt lgkmcnt(11)
    v_mfma_f32_32x32x16_bf16 a[0:15], v[232:235], v[104:107], a[0:15]
    buffer_load_dwordx4 v46, s[4:7], s86 offen offset:1024 sc1 lds
    v_mfma_f32_32x32x16_bf16 a[16:31], v[232:235], v[108:111], a[16:31]
    v_mfma_f32_32x32x16_bf16 a[32:47], v[236:239], v[104:107], a[32:47]
    buffer_load_dwordx4 v46, s[4:7], s86 offen offset:2048 sc1 lds
    v_mfma_f32_32x32x16_bf16 a[48:63], v[236:239], v[108:111], a[48:63]
    s_waitcnt vmcnt(24) lgkmcnt(0)
    s_barrier
    ds_read_b128 v[96:99], v21
    v_mfma_f32_32x32x16_bf16 a[0:15], v[240:243], v[112:115], a[0:15]
    ds_read_b64_tr_b16 v[224:225], v24
    ds_read_b64_tr_b16 v[226:227], v24 offset:1024
    buffer_load_dwordx4 v46, s[4:7], s86 offen offset:3072 sc1 lds
    s_add_u32 m0, s81, 0x24000
    v_mfma_f32_32x32x16_bf16 a[16:31], v[240:243], v[116:119], a[16:31]
    s_add_u32 s86, s86, 0x1000
    ds_read_b128 v[100:103], v21 offset:4096
    ds_read_b64_tr_b16 v[228:229], v25
    v_mfma_f32_32x32x16_bf16 a[32:47], v[244:247], v[112:115], a[32:47]
    ds_read_b64_tr_b16 v[230:231], v25 offset:1024
    ds_read_b128 v[104:107], v21 offset:1024
    buffer_load_dwordx4 v20, s[28:31], 0 offen lds
    v_mfma_f32_32x32x16_bf16 a[48:63], v[244:247], v[116:119], a[48:63]
    ds_read_b64_tr_b16 v[232:233], v24 offset:4096
    ds_read_b64_tr_b16 v[234:235], v24 offset:5120
    ds_read_b128 v[108:111], v21 offset:5120
    v_mfma_f32_32x32x16_bf16 a[0:15], v[248:251], v[120:123], a[0:15]
    ds_read_b64_tr_b16 v[236:237], v25 offset:4096
    ds_read_b64_tr_b16 v[238:239], v25 offset:5120
    buffer_load_dwordx4 v20, s[28:31], s82 offen offset:1024 lds
    ds_read_b128 v[112:115], v21 offset:2048
    v_mfma_f32_32x32x16_bf16 a[16:31], v[248:251], v[124:127], a[16:31]
    ds_read_b64_tr_b16 v[240:241], v24 offset:8192
    ds_read_b64_tr_b16 v[242:243], v24 offset:9216
    ds_read_b128 v[116:119], v21 offset:6144
    v_mfma_f32_32x32x16_bf16 a[32:47], v[252:255], v[120:123], a[32:47]
    ds_read_b64_tr_b16 v[244:245], v25 offset:8192
    ds_read_b64_tr_b16 v[246:247], v25 offset:9216
    buffer_load_dwordx4 v20, s[28:31], s84 offen offset:2048 lds
    ds_read_b128 v[120:123], v21 offset:3072
    v_mfma_f32_32x32x16_bf16 a[48:63], v[252:255], v[124:127], a[48:63]
    ds_read_b128 v[124:127], v21 offset:7168
    s_waitcnt lgkmcnt(15)
    v_mfma_f32_32x32x16_bf16 a[0:15], v[224:227], v[96:99], a[0:15]
    ds_read_b64_tr_b16 v[248:249], v24 offset:12288
    ds_read_b64_tr_b16 v[250:251], v24 offset:13312
    buffer_load_dwordx4 v20, s[28:31], s85 offen offset:3072 lds
    s_add_u32 m0, s81, 0x20000
    v_mfma_f32_32x32x16_bf16 a[16:31], v[224:227], v[100:103], a[16:31]
    v_add_u32 v20, 0x10000, v20
    ds_read_b64_tr_b16 v[252:253], v25 offset:12288
    ds_read_b64_tr_b16 v[254:255], v25 offset:13312
    s_waitcnt lgkmcnt(14)
    v_mfma_f32_32x32x16_bf16 a[32:47], v[228:231], v[96:99], a[32:47]
    buffer_load_dwordx4 v46, s[4:7], s86 offen sc1 lds
    v_mfma_f32_32x32x16_bf16 a[48:63], v[228:231], v[100:103], a[48:63]
    v_mfma_f32_32x32x16_bf16 a[0:15], v[232:235], v[104:107], a[0:15]
    buffer_load_dwordx4 v46, s[4:7], s86 offen offset:1024 sc1 lds
    v_mfma_f32_32x32x16_bf16 a[16:31], v[232:235], v[108:111], a[16:31]
    s_waitcnt lgkmcnt(4)
    v_mfma_f32_32x32x16_bf16 a[32:47], v[236:239], v[104:107], a[32:47]
    s_waitcnt vmcnt(22) lgkmcnt(0)
    s_barrier
    buffer_load_dwordx4 v46, s[4:7], s86 offen offset:2048 sc1 lds
    v_mfma_f32_32x32x16_bf16 a[48:63], v[236:239], v[108:111], a[48:63]
    ds_read_b128 v[96:99], v21 offset:32768
    ds_read_b64_tr_b16 v[224:225], v24 offset:32768
    v_mfma_f32_32x32x16_bf16 a[0:15], v[240:243], v[112:115], a[0:15]
    ds_read_b64_tr_b16 v[226:227], v24 offset:33792
    ds_read_b128 v[100:103], v21 offset:36864
    buffer_load_dwordx4 v46, s[4:7], s86 offen offset:3072 sc1 lds
    v_mfma_f32_32x32x16_bf16 a[16:31], v[240:243], v[116:119], a[16:31]
    s_add_u32 m0, s81, 0x4000
    s_add_u32 s86, s86, 0x1000
    ds_read_b64_tr_b16 v[228:229], v25 offset:32768
    ds_read_b64_tr_b16 v[230:231], v25 offset:33792
    v_mfma_f32_32x32x16_bf16 a[32:47], v[244:247], v[112:115], a[32:47]
    ds_read_b128 v[104:107], v21 offset:33792
    ds_read_b64_tr_b16 v[232:233], v24 offset:36864
    buffer_load_dwordx4 v20, s[28:31], 0 offen lds
    v_mfma_f32_32x32x16_bf16 a[48:63], v[244:247], v[116:119], a[48:63]
    ds_read_b64_tr_b16 v[234:235], v24 offset:37888
    ds_read_b128 v[108:111], v21 offset:37888
    v_mfma_f32_32x32x16_bf16 a[0:15], v[248:251], v[120:123], a[0:15]
    ds_read_b64_tr_b16 v[236:237], v25 offset:36864
    ds_read_b64_tr_b16 v[238:239], v25 offset:37888
    ds_read_b128 v[112:115], v21 offset:34816
    buffer_load_dwordx4 v20, s[28:31], s82 offen offset:1024 lds
    v_mfma_f32_32x32x16_bf16 a[16:31], v[248:251], v[124:127], a[16:31]
    ds_read_b64_tr_b16 v[240:241], v24 offset:40960
    ds_read_b64_tr_b16 v[242:243], v24 offset:41984
    ds_read_b128 v[116:119], v21 offset:38912
    v_mfma_f32_32x32x16_bf16 a[32:47], v[252:255], v[120:123], a[32:47]
    ds_read_b64_tr_b16 v[244:245], v25 offset:40960
    ds_read_b64_tr_b16 v[246:247], v25 offset:41984
    ds_read_b128 v[120:123], v21 offset:35840
    buffer_load_dwordx4 v20, s[28:31], s84 offen offset:2048 lds
    v_mfma_f32_32x32x16_bf16 a[48:63], v[252:255], v[124:127], a[48:63]
    ds_read_b128 v[124:127], v21 offset:39936
    ds_read_b64_tr_b16 v[248:249], v24 offset:45056
    s_waitcnt lgkmcnt(15)
    v_mfma_f32_32x32x16_bf16 a[0:15], v[224:227], v[96:99], a[0:15]
    ds_read_b64_tr_b16 v[250:251], v24 offset:46080
    ds_read_b64_tr_b16 v[252:253], v25 offset:45056
    ds_read_b64_tr_b16 v[254:255], v25 offset:46080
    buffer_load_dwordx4 v20, s[28:31], s85 offen offset:3072 lds
    v_mfma_f32_32x32x16_bf16 a[16:31], v[224:227], v[100:103], a[16:31]
    s_add_u32 m0, s81, 0
    v_add_u32 v20, 0x10000, v20
    v_mfma_f32_32x32x16_bf16 a[32:47], v[228:231], v[96:99], a[32:47]
    buffer_load_dwordx4 v46, s[4:7], s86 offen sc1 lds
    v_mfma_f32_32x32x16_bf16 a[48:63], v[228:231], v[100:103], a[48:63]
    s_waitcnt lgkmcnt(8)
    v_mfma_f32_32x32x16_bf16 a[0:15], v[232:235], v[104:107], a[0:15]
    buffer_load_dwordx4 v46, s[4:7], s86 offen offset:1024 sc1 lds
    v_mfma_f32_32x32x16_bf16 a[16:31], v[232:235], v[108:111], a[16:31]
    s_waitcnt vmcnt(22) lgkmcnt(0)
    s_barrier
    ds_read_b128 v[96:99], v23
    v_mfma_f32_32x32x16_bf16 a[32:47], v[236:239], v[104:107], a[32:47]
    ds_read_b64_tr_b16 v[224:225], v28
    ds_read_b64_tr_b16 v[226:227], v28 offset:1024
    buffer_load_dwordx4 v46, s[4:7], s86 offen offset:2048 sc1 lds
    ds_read_b128 v[100:103], v23 offset:4096
    v_mfma_f32_32x32x16_bf16 a[48:63], v[236:239], v[108:111], a[48:63]
    ds_read_b64_tr_b16 v[228:229], v29
    ds_read_b64_tr_b16 v[230:231], v29 offset:1024
    ds_read_b128 v[104:107], v23 offset:1024
    v_mfma_f32_32x32x16_bf16 a[0:15], v[240:243], v[112:115], a[0:15]
    ds_read_b64_tr_b16 v[232:233], v28 offset:4096
    ds_read_b64_tr_b16 v[234:235], v28 offset:5120
    buffer_load_dwordx4 v46, s[4:7], s86 offen offset:3072 sc1 lds
    s_add_u32 m0, s81, 0xc000
    v_mfma_f32_32x32x16_bf16 a[16:31], v[240:243], v[116:119], a[16:31]
    s_add_u32 s86, s86, 0x1000
    ds_read_b128 v[108:111], v23 offset:5120
    ds_read_b64_tr_b16 v[236:237], v29 offset:4096
    v_mfma_f32_32x32x16_bf16 a[32:47], v[244:247], v[112:115], a[32:47]
    ds_read_b64_tr_b16 v[238:239], v29 offset:5120
    ds_read_b128 v[112:115], v23 offset:2048
    buffer_load_dwordx4 v20, s[28:31], 0 offen lds
    v_mfma_f32_32x32x16_bf16 a[48:63], v[244:247], v[116:119], a[48:63]
    ds_read_b64_tr_b16 v[240:241], v28 offset:8192
    ds_read_b64_tr_b16 v[242:243], v28 offset:9216
    ds_read_b128 v[116:119], v23 offset:6144
    v_mfma_f32_32x32x16_bf16 a[0:15], v[248:251], v[120:123], a[0:15]
    ds_read_b64_tr_b16 v[244:245], v29 offset:8192
    ds_read_b64_tr_b16 v[246:247], v29 offset:9216
    buffer_load_dwordx4 v20, s[28:31], s82 offen offset:1024 lds
    v_mfma_f32_32x32x16_bf16 a[16:31], v[248:251], v[124:127], a[16:31]
    ds_read_b64_tr_b16 v[248:249], v28 offset:12288
    ds_read_b64_tr_b16 v[250:251], v28 offset:13312
    v_mfma_f32_32x32x16_bf16 a[32:47], v[252:255], v[120:123], a[32:47]
    ds_read_b128 v[120:123], v23 offset:3072
    buffer_load_dwordx4 v20, s[28:31], s84 offen offset:2048 lds
    v_mfma_f32_32x32x16_bf16 a[48:63], v[252:255], v[124:127], a[48:63]
    ds_read_b128 v[124:127], v23 offset:7168
    ds_read_b64_tr_b16 v[252:253], v29 offset:12288
    s_waitcnt lgkmcnt(13)
    v_mfma_f32_32x32x16_bf16 a[0:15], v[224:227], v[96:99], a[0:15]
    ds_read_b64_tr_b16 v[254:255], v29 offset:13312
    buffer_load_dwordx4 v20, s[28:31], s85 offen offset:3072 lds
    s_add_u32 m0, s81, 0x8000
    v_mfma_f32_32x32x16_bf16 a[16:31], v[224:227], v[100:103], a[16:31]
    v_add_u32 v20, 0x10000, v20
    v_mfma_f32_32x32x16_bf16 a[32:47], v[228:231], v[96:99], a[32:47]
    buffer_load_dwordx4 v46, s[4:7], s86 offen sc1 lds
    v_mfma_f32_32x32x16_bf16 a[48:63], v[228:231], v[100:103], a[48:63]
    v_mfma_f32_32x32x16_bf16 a[0:15], v[232:235], v[104:107], a[0:15]
    buffer_load_dwordx4 v46, s[4:7], s86 offen offset:1024 sc1 lds
    v_mfma_f32_32x32x16_bf16 a[16:31], v[232:235], v[108:111], a[16:31]
    s_waitcnt vmcnt(22) lgkmcnt(0)
    s_barrier
    ds_read_b128 v[96:99], v22
    v_mfma_f32_32x32x16_bf16 a[32:47], v[236:239], v[104:107], a[32:47]
    ds_read_b128 v[100:103], v22 offset:4096
    buffer_load_dwordx4 v46, s[4:7], s86 offen offset:2048 sc1 lds
    ds_read_b64_tr_b16 v[224:225], v26
    v_mfma_f32_32x32x16_bf16 a[48:63], v[236:239], v[108:111], a[48:63]
    ds_read_b64_tr_b16 v[226:227], v26 offset:1024
    ds_read_b64_tr_b16 v[228:229], v27
    ds_read_b64_tr_b16 v[230:231], v27 offset:1024
    v_mfma_f32_32x32x16_bf16 a[0:15], v[240:243], v[112:115], a[0:15]
    ds_read_b128 v[104:107], v22 offset:1024
    buffer_load_dwordx4 v46, s[4:7], s86 offen offset:3072 sc1 lds
    s_add_u32 m0, s81, 0x14000
    v_mfma_f32_32x32x16_bf16 a[16:31], v[240:243], v[116:119], a[16:31]
    s_add_u32 s86, s86, 0x1000
    ds_read_b128 v[108:111], v22 offset:5120
    ds_read_b64_tr_b16 v[232:233], v26 offset:4096
    v_mfma_f32_32x32x16_bf16 a[32:47], v[244:247], v[112:115], a[32:47]
    ds_read_b64_tr_b16 v[234:235], v26 offset:5120
    ds_read_b64_tr_b16 v[236:237], v27 offset:4096
    buffer_load_dwordx4 v20, s[28:31], 0 offen lds
    ds_read_b64_tr_b16 v[238:239], v27 offset:5120
    v_mfma_f32_32x32x16_bf16 a[48:63], v[244:247], v[116:119], a[48:63]
    ds_read_b128 v[112:115], v22 offset:2048
    ds_read_b128 v[116:119], v22 offset:6144
    v_mfma_f32_32x32x16_bf16 a[0:15], v[248:251], v[120:123], a[0:15]
    ds_read_b64_tr_b16 v[240:241], v26 offset:8192
    ds_read_b64_tr_b16 v[242:243], v26 offset:9216
    buffer_load_dwordx4 v20, s[28:31], s82 offen offset:1024 lds
    ds_read_b64_tr_b16 v[244:245], v27 offset:8192
    v_mfma_f32_32x32x16_bf16 a[16:31], v[248:251], v[124:127], a[16:31]
    ds_read_b64_tr_b16 v[246:247], v27 offset:9216
    ds_read_b64_tr_b16 v[248:249], v26 offset:12288
    ds_read_b64_tr_b16 v[250:251], v26 offset:13312
    v_mfma_f32_32x32x16_bf16 a[32:47], v[252:255], v[120:123], a[32:47]
    ds_read_b128 v[120:123], v22 offset:3072
    buffer_load_dwordx4 v20, s[28:31], s84 offen offset:2048 lds
    v_mfma_f32_32x32x16_bf16 a[48:63], v[252:255], v[124:127], a[48:63]
    ds_read_b128 v[124:127], v22 offset:7168
    ds_read_b64_tr_b16 v[252:253], v27 offset:12288
    s_waitcnt lgkmcnt(15)
    v_mfma_f32_32x32x16_bf16 a[0:15], v[224:227], v[96:99], a[0:15]
    ds_read_b64_tr_b16 v[254:255], v27 offset:13312
    buffer_load_dwordx4 v20, s[28:31], s85 offen offset:3072 lds
    s_add_u32 m0, s81, 0x10000
    v_mfma_f32_32x32x16_bf16 a[16:31], v[224:227], v[100:103], a[16:31]
    v_add_u32 v20, 0x10000, v20
    v_mfma_f32_32x32x16_bf16 a[32:47], v[228:231], v[96:99], a[32:47]
    buffer_load_dwordx4 v46, s[4:7], s86 offen sc1 lds
    v_mfma_f32_32x32x16_bf16 a[48:63], v[228:231], v[100:103], a[48:63]
    s_waitcnt lgkmcnt(4)
    v_mfma_f32_32x32x16_bf16 a[0:15], v[232:235], v[104:107], a[0:15]
    buffer_load_dwordx4 v46, s[4:7], s86 offen offset:1024 sc1 lds
    v_mfma_f32_32x32x16_bf16 a[16:31], v[232:235], v[108:111], a[16:31]
    s_waitcnt vmcnt(22) lgkmcnt(0)
    s_barrier
    ds_read_b128 v[96:99], v22 offset:32768
    v_mfma_f32_32x32x16_bf16 a[32:47], v[236:239], v[104:107], a[32:47]
    ds_read_b64_tr_b16 v[224:225], v26 offset:32768
    buffer_load_dword v30, v54, s[4:7], s95 offen sc1
    ds_read_b64_tr_b16 v[226:227], v26 offset:33792
    v_mfma_f32_32x32x16_bf16 a[48:63], v[236:239], v[108:111], a[48:63]
    buffer_load_dwordx4 v46, s[4:7], s86 offen offset:2048 sc1 lds
    ds_read_b128 v[100:103], v22 offset:36864
    ds_read_b64_tr_b16 v[228:229], v27 offset:32768
    v_mfma_f32_32x32x16_bf16 a[0:15], v[240:243], v[112:115], a[0:15]
    ds_read_b64_tr_b16 v[230:231], v27 offset:33792
    ds_read_b128 v[104:107], v22 offset:33792
    v_mfma_f32_32x32x16_bf16 a[16:31], v[240:243], v[116:119], a[16:31]
    buffer_load_dwordx4 v46, s[4:7], s86 offen offset:3072 sc1 lds
    s_add_u32 m0, s81, 0x1c000
    s_add_u32 s86, s86, 0x1000
    ds_read_b64_tr_b16 v[232:233], v26 offset:36864
    ds_read_b64_tr_b16 v[234:235], v26 offset:37888
    v_mfma_f32_32x32x16_bf16 a[32:47], v[244:247], v[112:115], a[32:47]
    ds_read_b128 v[108:111], v22 offset:37888
    ds_read_b64_tr_b16 v[236:237], v27 offset:36864
    v_mfma_f32_32x32x16_bf16 a[48:63], v[244:247], v[116:119], a[48:63]
    buffer_load_dwordx4 v20, s[28:31], 0 offen lds
    ds_read_b64_tr_b16 v[238:239], v27 offset:37888
    ds_read_b128 v[112:115], v22 offset:34816
    v_mfma_f32_32x32x16_bf16 a[0:15], v[248:251], v[120:123], a[0:15]
    ds_read_b64_tr_b16 v[240:241], v26 offset:40960
    ds_read_b64_tr_b16 v[242:243], v26 offset:41984
    ds_read_b128 v[116:119], v22 offset:38912
    v_mfma_f32_32x32x16_bf16 a[16:31], v[248:251], v[124:127], a[16:31]
    buffer_load_dwordx4 v20, s[28:31], s82 offen offset:1024 lds
    ds_read_b64_tr_b16 v[244:245], v27 offset:40960
    ds_read_b64_tr_b16 v[246:247], v27 offset:41984
    ds_read_b64_tr_b16 v[248:249], v26 offset:45056
    v_mfma_f32_32x32x16_bf16 a[32:47], v[252:255], v[120:123], a[32:47]
    ds_read_b128 v[120:123], v22 offset:35840
    ds_read_b64_tr_b16 v[250:251], v26 offset:46080
    v_mfma_f32_32x32x16_bf16 a[48:63], v[252:255], v[124:127], a[48:63]
    buffer_load_dwordx4 v20, s[28:31], s84 offen offset:2048 lds
    ds_read_b128 v[124:127], v22 offset:39936
    s_waitcnt lgkmcnt(14)
    v_mfma_f32_32x32x16_bf16 a[0:15], v[224:227], v[96:99], a[0:15]
    ds_read_b64_tr_b16 v[252:253], v27 offset:45056
    ds_read_b64_tr_b16 v[254:255], v27 offset:46080
    v_mfma_f32_32x32x16_bf16 a[16:31], v[224:227], v[100:103], a[16:31]
    buffer_load_dwordx4 v20, s[28:31], s85 offen offset:3072 lds
    s_add_u32 m0, s81, 0x18000
    v_mfma_f32_32x32x16_bf16 a[32:47], v[228:231], v[96:99], a[32:47]
    v_mfma_f32_32x32x16_bf16 a[48:63], v[228:231], v[100:103], a[48:63]
    buffer_load_dwordx4 v46, s[4:7], s86 offen sc1 lds
    s_waitcnt lgkmcnt(6)
    v_mfma_f32_32x32x16_bf16 a[0:15], v[232:235], v[104:107], a[0:15]
    v_mfma_f32_32x32x16_bf16 a[16:31], v[232:235], v[108:111], a[16:31]
    buffer_load_dwordx4 v46, s[4:7], s86 offen offset:1024 sc1 lds
    v_mfma_f32_32x32x16_bf16 a[32:47], v[236:239], v[104:107], a[32:47]
    s_waitcnt vmcnt(23) lgkmcnt(0)
    s_barrier
    ds_read_b128 v[96:99], v21
    v_mfma_f32_32x32x16_bf16 a[48:63], v[236:239], v[108:111], a[48:63]
    buffer_load_dwordx4 v46, s[4:7], s86 offen offset:2048 sc1 lds
    ds_read_b64_tr_b16 v[224:225], v24
    ds_read_b64_tr_b16 v[226:227], v24 offset:1024
    ds_read_b128 v[100:103], v21 offset:4096
    v_mfma_f32_32x32x16_bf16 a[0:15], v[240:243], v[112:115], a[0:15]
    ds_read_b64_tr_b16 v[228:229], v25
    ds_read_b64_tr_b16 v[230:231], v25 offset:1024
    ds_read_b128 v[104:107], v21 offset:1024
    v_mfma_f32_32x32x16_bf16 a[16:31], v[240:243], v[116:119], a[16:31]
    buffer_load_dwordx4 v46, s[4:7], s86 offen offset:3072 sc1 lds
    s_add_u32 m0, s93, 0
    ds_read_b64_tr_b16 v[232:233], v24 offset:4096
    ds_read_b64_tr_b16 v[234:235], v24 offset:5120
    v_mfma_f32_32x32x16_bf16 a[32:47], v[244:247], v[112:115], a[32:47]
    ds_read_b128 v[108:111], v21 offset:5120
    ds_read_b64_tr_b16 v[236:237], v25 offset:4096
    v_mfma_f32_32x32x16_bf16 a[48:63], v[244:247], v[116:119], a[48:63]
    ds_read_b64_tr_b16 v[238:239], v25 offset:5120
    ds_read_b128 v[112:115], v21 offset:2048
    v_mfma_f32_32x32x16_bf16 a[0:15], v[248:251], v[120:123], a[0:15]
    ds_read_b64_tr_b16 v[240:241], v24 offset:8192
    ds_read_b64_tr_b16 v[242:243], v24 offset:9216
    ds_read_b128 v[116:119], v21 offset:6144
    v_mfma_f32_32x32x16_bf16 a[16:31], v[248:251], v[124:127], a[16:31]
    ds_read_b64_tr_b16 v[244:245], v25 offset:8192
    ds_read_b64_tr_b16 v[246:247], v25 offset:9216
    ds_read_b64_tr_b16 v[248:249], v24 offset:12288
    v_mfma_f32_32x32x16_bf16 a[32:47], v[252:255], v[120:123], a[32:47]
    ds_read_b128 v[120:123], v21 offset:3072
    ds_read_b64_tr_b16 v[250:251], v24 offset:13312
    v_mfma_f32_32x32x16_bf16 a[48:63], v[252:255], v[124:127], a[48:63]
    ds_read_b128 v[124:127], v21 offset:7168
    ds_read_b64_tr_b16 v[252:253], v25 offset:12288
    s_waitcnt lgkmcnt(15)
    v_mfma_f32_32x32x16_bf16 a[0:15], v[224:227], v[96:99], a[0:15]
    ds_read_b64_tr_b16 v[254:255], v25 offset:13312
    v_mfma_f32_32x32x16_bf16 a[16:31], v[224:227], v[100:103], a[16:31]
    v_mfma_f32_32x32x16_bf16 a[32:47], v[228:231], v[96:99], a[32:47]
    v_mfma_f32_32x32x16_bf16 a[48:63], v[228:231], v[100:103], a[48:63]
    s_waitcnt lgkmcnt(5)
    v_mfma_f32_32x32x16_bf16 a[0:15], v[232:235], v[104:107], a[0:15]
    v_mfma_f32_32x32x16_bf16 a[16:31], v[232:235], v[108:111], a[16:31]
    v_mfma_f32_32x32x16_bf16 a[32:47], v[236:239], v[104:107], a[32:47]
    v_mfma_f32_32x32x16_bf16 a[48:63], v[236:239], v[108:111], a[48:63]
    v_mfma_f32_32x32x16_bf16 a[0:15], v[240:243], v[112:115], a[0:15]
    v_mfma_f32_32x32x16_bf16 a[16:31], v[240:243], v[116:119], a[16:31]
    v_mfma_f32_32x32x16_bf16 a[32:47], v[244:247], v[112:115], a[32:47]
    v_mfma_f32_32x32x16_bf16 a[48:63], v[244:247], v[116:119], a[48:63]
    s_waitcnt lgkmcnt(0)
    v_mfma_f32_32x32x16_bf16 a[0:15], v[248:251], v[120:123], a[0:15]
    v_mfma_f32_32x32x16_bf16 a[16:31], v[248:251], v[124:127], a[16:31]
    v_mfma_f32_32x32x16_bf16 a[32:47], v[252:255], v[120:123], a[32:47]
    v_mfma_f32_32x32x16_bf16 a[48:63], v[252:255], v[124:127], a[48:63]
    s_waitcnt vmcnt(10)
    v_cmp_ne_u32 vcc, v59, v30
    s_nop 0
    s_cbranch_vccnz L_slow_u
L_ret_u:
    v_and_b32 v54, 3, v0
    v_add_u32 v54, s59, v54
    v_min_u32 v54, 31, v54
    v_lshlrev_b32 v54, 2, v54
    s_lshl_b32 s95, s63, 7
    v_or_b32 v54, s60, v54
    s_add_u32 s95, s95, 0x82800
    s_barrier
    buffer_load_dwordx4 v[128:131], v46, s[4:7], s41 offen sc1
    ds_read_b128 v[96:99], v21 offset:32768
    ds_read_b64_tr_b16 v[224:225], v24 offset:32768
    ds_read_b64_tr_b16 v[226:227], v24 offset:33792
    ds_read_b128 v[100:103], v21 offset:36864
    ds_read_b64_tr_b16 v[228:229], v25 offset:32768
    ds_read_b64_tr_b16 v[230:231], v25 offset:33792
    buffer_load_dwordx4 v[132:135], v46, s[4:7], s42 offen sc1
    ds_read_b128 v[104:107], v21 offset:33792
    ds_read_b64_tr_b16 v[232:233], v24 offset:36864
    ds_read_b64_tr_b16 v[234:235], v24 offset:37888
    ds_read_b128 v[108:111], v21 offset:37888
    ds_read_b64_tr_b16 v[236:237], v25 offset:36864
    ds_read_b64_tr_b16 v[238:239], v25 offset:37888
    buffer_load_dwordx4 v[136:139], v46, s[4:7], s41 offen offset:1024 sc1
    ds_read_b128 v[112:115], v21 offset:34816
    ds_read_b64_tr_b16 v[240:241], v24 offset:40960
    ds_read_b64_tr_b16 v[242:243], v24 offset:41984
    s_waitcnt lgkmcnt(12)
    v_mfma_f32_32x32x16_bf16 a[0:15], v[224:227], v[96:99], a[0:15]
    ds_read_b128 v[116:119], v21 offset:38912
    buffer_load_dwordx4 v[140:143], v46, s[4:7], s42 offen offset:1024 sc1
    s_waitcnt lgkmcnt(12)
    v_mfma_f32_32x32x16_bf16 a[16:31], v[224:227], v[100:103], a[16:31]
    ds_read_b64_tr_b16 v[244:245], v25 offset:40960
    ds_read_b64_tr_b16 v[246:247], v25 offset:41984
    ds_read_b128 v[120:123], v21 offset:35840
    s_waitcnt lgkmcnt(13)
    v_mfma_f32_32x32x16_bf16 a[32:47], v[228:231], v[96:99], a[32:47]
    ds_read_b128 v[124:127], v21 offset:39936
    buffer_load_dwordx4 v[144:147], v46, s[4:7], s41 offen offset:2048 sc1
    ds_read_b64_tr_b16 v[248:249], v24 offset:45056
    v_mfma_f32_32x32x16_bf16 a[48:63], v[228:231], v[100:103], a[48:63]
    ds_read_b64_tr_b16 v[250:251], v24 offset:46080
    ds_read_b64_tr_b16 v[252:253], v25 offset:45056
    ds_read_b64_tr_b16 v[254:255], v25 offset:46080
    s_waitcnt lgkmcnt(15)
    v_mfma_f32_32x32x16_bf16 a[0:15], v[232:235], v[104:107], a[0:15]
    buffer_load_dwordx4 v[148:151], v46, s[4:7], s42 offen offset:2048 sc1
    s_waitcnt lgkmcnt(12)
    v_mfma_f32_32x32x16_bf16 a[16:31], v[232:235], v[108:111], a[16:31]
    v_mfma_f32_32x32x16_bf16 a[32:47], v[236:239], v[104:107], a[32:47]
    buffer_load_dwordx4 v[152:155], v46, s[4:7], s41 offen offset:3072 sc1
    s_add_u32 s41, s41, 0x1000
    v_mfma_f32_32x32x16_bf16 a[48:63], v[236:239], v[108:111], a[48:63]
    s_waitcnt lgkmcnt(5)
    v_mfma_f32_32x32x16_bf16 a[0:15], v[240:243], v[112:115], a[0:15]
    s_waitcnt vmcnt(15) lgkmcnt(0)
    s_barrier
    buffer_load_dwordx4 v[156:159], v46, s[4:7], s42 offen offset:3072 sc1
    v_mfma_f32_32x32x16_bf16 a[16:31], v[240:243], v[116:119], a[16:31]
    s_add_u32 s42, s42, 0x1000
    ds_read_b128 v[96:99], v23
    ds_read_b64_tr_b16 v[224:225], v28
    v_mfma_f32_32x32x16_bf16 a[32:47], v[244:247], v[112:115], a[32:47]
    ds_read_b64_tr_b16 v[226:227], v28 offset:1024
    ds_read_b128 v[100:103], v23 offset:4096
    buffer_load_dwordx4 v[160:163], v46, s[4:7], s41 offen sc1
    v_mfma_f32_32x32x16_bf16 a[48:63], v[244:247], v[116:119], a[48:63]
    ds_read_b64_tr_b16 v[228:229], v29
    ds_read_b64_tr_b16 v[230:231], v29 offset:1024
    ds_read_b128 v[104:107], v23 offset:1024
    v_mfma_f32_32x32x16_bf16 a[0:15], v[248:251], v[120:123], a[0:15]
    ds_read_b64_tr_b16 v[232:233], v28 offset:4096
    ds_read_b64_tr_b16 v[234:235], v28 offset:5120
    ds_read_b128 v[108:111], v23 offset:5120
    buffer_load_dwordx4 v[164:167], v46, s[4:7], s42 offen sc1
    v_mfma_f32_32x32x16_bf16 a[16:31], v[248:251], v[124:127], a[16:31]
    ds_read_b64_tr_b16 v[236:237], v29 offset:4096
    ds_read_b64_tr_b16 v[238:239], v29 offset:5120
    ds_read_b128 v[112:115], v23 offset:2048
    v_mfma_f32_32x32x16_bf16 a[32:47], v[252:255], v[120:123], a[32:47]
    ds_read_b64_tr_b16 v[240:241], v28 offset:8192
    ds_read_b64_tr_b16 v[242:243], v28 offset:9216
    ds_read_b128 v[116:119], v23 offset:6144
    buffer_load_dwordx4 v[168:171], v46, s[4:7], s41 offen offset:1024 sc1
    v_mfma_f32_32x32x16_bf16 a[48:63], v[252:255], v[124:127], a[48:63]
    ds_read_b64_tr_b16 v[244:245], v29 offset:8192
    ds_read_b64_tr_b16 v[246:247], v29 offset:9216
    ds_read_b128 v[120:123], v23 offset:3072
    s_waitcnt lgkmcnt(15)
    v_mfma_f32_32x32x16_bf16 a[0:15], v[224:227], v[96:99], a[0:15]
    ds_read_b128 v[124:127], v23 offset:7168
    ds_read_b64_tr_b16 v[248:249], v28 offset:12288
    buffer_load_dwordx4 v[172:175], v46, s[4:7], s42 offen offset:1024 sc1
    v_mfma_f32_32x32x16_bf16 a[16:31], v[224:227], v[100:103], a[16:31]
    ds_read_b64_tr_b16 v[250:251], v28 offset:13312
    ds_read_b64_tr_b16 v[252:253], v29 offset:12288
    ds_read_b64_tr_b16 v[254:255], v29 offset:13312
    s_waitcnt lgkmcnt(15)
    v_mfma_f32_32x32x16_bf16 a[32:47], v[228:231], v[96:99], a[32:47]
    buffer_load_dwordx4 v[176:179], v46, s[4:7], s41 offen offset:2048 sc1
    v_mfma_f32_32x32x16_bf16 a[48:63], v[228:231], v[100:103], a[48:63]
    v_mfma_f32_32x32x16_bf16 a[0:15], v[232:235], v[104:107], a[0:15]
    s_waitcnt lgkmcnt(9)
    v_mfma_f32_32x32x16_bf16 a[16:31], v[232:235], v[108:111], a[16:31]
    buffer_load_dwordx4 v[180:183], v46, s[4:7], s42 offen offset:2048 sc1
    v_mfma_f32_32x32x16_bf16 a[32:47], v[236:239], v[104:107], a[32:47]
    s_waitcnt vmcnt(14) lgkmcnt(0)
    s_barrier
    ds_read_b128 v[96:99], v22
    v_mfma_f32_32x32x16_bf16 a[48:63], v[236:239], v[108:111], a[48:63]
    buffer_load_dwordx4 v[184:187], v46, s[4:7], s41 offen offset:3072 sc1
    s_add_u32 s41, s41, 0x1000
    ds_read_b64_tr_b16 v[224:225], v26
    ds_read_b64_tr_b16 v[226:227], v26 offset:1024
    v_mfma_f32_32x32x16_bf16 a[0:15], v[240:243], v[112:115], a[0:15]
    ds_read_b128 v[100:103], v22 offset:4096
    ds_read_b64_tr_b16 v[228:229], v27
    v_mfma_f32_32x32x16_bf16 a[16:31], v[240:243], v[116:119], a[16:31]
    buffer_load_dwordx4 v[188:191], v46, s[4:7], s42 offen offset:3072 sc1
    s_add_u32 s42, s42, 0x1000
    ds_read_b64_tr_b16 v[230:231], v27 offset:1024
    ds_read_b128 v[104:107], v22 offset:1024
    v_mfma_f32_32x32x16_bf16 a[32:47], v[244:247], v[112:115], a[32:47]
    ds_read_b64_tr_b16 v[232:233], v26 offset:4096
    ds_read_b64_tr_b16 v[234:235], v26 offset:5120
    ds_read_b128 v[108:111], v22 offset:5120
    v_mfma_f32_32x32x16_bf16 a[48:63], v[244:247], v[116:119], a[48:63]
    buffer_load_dwordx4 v[192:195], v46, s[4:7], s41 offen sc1
    ds_read_b64_tr_b16 v[236:237], v27 offset:4096
    ds_read_b64_tr_b16 v[238:239], v27 offset:5120
    ds_read_b128 v[112:115], v22 offset:2048
    v_mfma_f32_32x32x16_bf16 a[0:15], v[248:251], v[120:123], a[0:15]
    ds_read_b64_tr_b16 v[240:241], v26 offset:8192
    ds_read_b64_tr_b16 v[242:243], v26 offset:9216
    ds_read_b128 v[116:119], v22 offset:6144
    v_mfma_f32_32x32x16_bf16 a[16:31], v[248:251], v[124:127], a[16:31]
    buffer_load_dwordx4 v[196:199], v46, s[4:7], s42 offen sc1
    ds_read_b64_tr_b16 v[244:245], v27 offset:8192
    ds_read_b64_tr_b16 v[246:247], v27 offset:9216
    ds_read_b64_tr_b16 v[248:249], v26 offset:12288
    v_mfma_f32_32x32x16_bf16 a[32:47], v[252:255], v[120:123], a[32:47]
    ds_read_b128 v[120:123], v22 offset:3072
    ds_read_b64_tr_b16 v[250:251], v26 offset:13312
    v_mfma_f32_32x32x16_bf16 a[48:63], v[252:255], v[124:127], a[48:63]
    buffer_load_dwordx4 v[200:203], v46, s[4:7], s41 offen offset:1024 sc1
    ds_read_b128 v[124:127], v22 offset:7168
    s_waitcnt lgkmcnt(15)
    v_mfma_f32_32x32x16_bf16 a[0:15], v[224:227], v[96:99], a[0:15]
    ds_read_b64_tr_b16 v[252:253], v27 offset:12288
    ds_read_b64_tr_b16 v[254:255], v27 offset:13312
    v_mfma_f32_32x32x16_bf16 a[16:31], v[224:227], v[100:103], a[16:31]
    buffer_load_dwordx4 v[204:207], v46, s[4:7], s42 offen offset:1024 sc1
    v_mfma_f32_32x32x16_bf16 a[32:47], v[228:231], v[96:99], a[32:47]
    v_mfma_f32_32x32x16_bf16 a[48:63], v[228:231], v[100:103], a[48:63]
    buffer_load_dwordx4 v[208:211], v46, s[4:7], s41 offen offset:2048 sc1
    s_waitcnt lgkmcnt(6)
    v_mfma_f32_32x32x16_bf16 a[0:15], v[232:235], v[104:107], a[0:15]
    v_mfma_f32_32x32x16_bf16 a[16:31], v[232:235], v[108:111], a[16:31]
    buffer_load_dwordx4 v[212:215], v46, s[4:7], s42 offen offset:2048 sc1
    v_mfma_f32_32x32x16_bf16 a[32:47], v[236:239], v[104:107], a[32:47]
    v_mfma_f32_32x32x16_bf16 a[48:63], v[236:239], v[108:111], a[48:63]
    buffer_load_dwordx4 v[8:11], v34, s[20:23], s43 offen
    v_mfma_f32_32x32x16_bf16 a[0:15], v[240:243], v[112:115], a[0:15]
    v_mfma_f32_32x32x16_bf16 a[16:31], v[240:243], v[116:119], a[16:31]
    buffer_load_dwordx4 v[12:15], v34, s[20:23], s43 offen offset:32
    v_mfma_f32_32x32x16_bf16 a[32:47], v[244:247], v[112:115], a[32:47]
    v_mfma_f32_32x32x16_bf16 a[48:63], v[244:247], v[116:119], a[48:63]
    buffer_load_dwordx4 v31, s[32:35], 0 offen lds
    s_waitcnt lgkmcnt(0)
    v_mfma_f32_32x32x16_bf16 a[0:15], v[248:251], v[120:123], a[0:15]
    v_mfma_f32_32x32x16_bf16 a[16:31], v[248:251], v[124:127], a[16:31]
    buffer_load_dwordx4 v31, s[32:35], s38 offen offset:1024 lds
    v_mfma_f32_32x32x16_bf16 a[32:47], v[252:255], v[120:123], a[32:47]
    v_mfma_f32_32x32x16_bf16 a[48:63], v[252:255], v[124:127], a[48:63]
    buffer_load_dwordx4 v31, s[32:35], s39 offen offset:2048 lds
    buffer_load_dwordx4 v31, s[32:35], s40 offen offset:3072 lds
    v_add_u32 v31, 0x8000, v31
    s_add_u32 m0, s93, 0x1000
    s_waitcnt vmcnt(2)
    ds_read_b64_tr_b16 v[96:97], v32
    buffer_load_dwordx4 v31, s[32:35], 0 offen lds
    ds_read_b64_tr_b16 v[98:99], v32 offset:512
    v_accvgpr_read_b32 v64, a0
    v_accvgpr_read_b32 v65, a1
    v_accvgpr_read_b32 v66, a2
    v_accvgpr_read_b32 v67, a3
    v_accvgpr_read_b32 v68, a4
    v_accvgpr_read_b32 v69, a5
    v_accvgpr_read_b32 v70, a6
    v_accvgpr_read_b32 v71, a7
    v_accvgpr_read_b32 v72, a8
    v_accvgpr_read_b32 v73, a9
    v_accvgpr_read_b32 v74, a10
    v_accvgpr_read_b32 v75, a11
    v_accvgpr_read_b32 v76, a12
    v_accvgpr_read_b32 v77, a13
    v_accvgpr_read_b32 v78, a14
    v_accvgpr_read_b32 v79, a15
    v_cvt_pk_bf16_f32 v80, v64, v65
    v_cvt_pk_bf16_f32 v81, v66, v67
    v_cvt_pk_bf16_f32 v82, v68, v69
    v_cvt_pk_bf16_f32 v83, v70, v71
    buffer_store_dwordx4 v[80:83], v46, s[4:7], s68 offen sc1
    v_cvt_pk_bf16_f32 v84, v72, v73
    v_cvt_pk_bf16_f32 v85, v74, v75
    v_cvt_pk_bf16_f32 v86, v76, v77
    v_cvt_pk_bf16_f32 v87, v78, v79
    v_accvgpr_read_b32 v64, a16
    v_accvgpr_read_b32 v65, a17
    v_accvgpr_read_b32 v66, a18
    v_accvgpr_read_b32 v67, a19
    v_accvgpr_read_b32 v68, a20
    v_accvgpr_read_b32 v69, a21
    v_accvgpr_read_b32 v70, a22
    v_accvgpr_read_b32 v71, a23
    s_waitcnt lgkmcnt(0)
    v_mfma_f32_32x32x16_bf16 a[64:79], v[96:99], v[128:131], 0
    buffer_store_dwordx4 v[84:87], v46, s[4:7], s68 offen offset:1024 sc1
    v_accvgpr_read_b32 v72, a24
    v_accvgpr_read_b32 v73, a25
    v_accvgpr_read_b32 v74, a26
    v_accvgpr_read_b32 v75, a27
    v_accvgpr_read_b32 v76, a28
    v_mfma_f32_32x32x16_bf16 a[80:95], v[96:99], v[132:135], 0
    v_accvgpr_read_b32 v77, a29
    v_accvgpr_read_b32 v78, a30
    v_accvgpr_read_b32 v79, a31
    v_cvt_pk_bf16_f32 v88, v64, v65
    v_cvt_pk_bf16_f32 v89, v66, v67
    v_cvt_pk_bf16_f32 v90, v68, v69
    v_cvt_pk_bf16_f32 v91, v70, v71
    v_cvt_pk_bf16_f32 v92, v72, v73
    buffer_store_dwordx4 v[88:91], v46, s[4:7], s69 offen sc1
    v_cvt_pk_bf16_f32 v93, v74, v75
    v_cvt_pk_bf16_f32 v94, v76, v77
    v_cvt_pk_bf16_f32 v95, v78, v79
    v_accvgpr_read_b32 v64, a32
    v_accvgpr_read_b32 v65, a33
    v_accvgpr_read_b32 v66, a34
    v_accvgpr_read_b32 v67, a35
    v_accvgpr_read_b32 v68, a36
    v_accvgpr_read_b32 v69, a37
    v_accvgpr_read_b32 v70, a38
    v_accvgpr_read_b32 v71, a39
    v_accvgpr_read_b32 v72, a40
    v_accvgpr_read_b32 v73, a41
    v_accvgpr_read_b32 v74, a42
    v_accvgpr_read_b32 v75, a43
    buffer_store_dwordx4 v[92:95], v46, s[4:7], s69 offen offset:1024 sc1
    v_accvgpr_read_b32 v76, a44
    v_accvgpr_read_b32 v77, a45
    v_accvgpr_read_b32 v78, a46
    v_accvgpr_read_b32 v79, a47
    v_cvt_pk_bf16_f32 v80, v64, v65
    v_cvt_pk_bf16_f32 v81, v66, v67
    v_cvt_pk_bf16_f32 v82, v68, v69
    v_cvt_pk_bf16_f32 v83, v70, v71
    v_cvt_pk_bf16_f32 v84, v72, v73
    v_cvt_pk_bf16_f32 v85, v74, v75
    v_cvt_pk_bf16_f32 v86, v76, v77
    v_cvt_pk_bf16_f32 v87, v78, v79
    v_accvgpr_read_b32 v64, a48
    v_accvgpr_read_b32 v65, a49
    v_accvgpr_read_b32 v66, a50
    buffer_store_dwordx4 v[80:83], v46, s[4:7], s70 offen sc1
    v_accvgpr_read_b32 v67, a51
    v_accvgpr_read_b32 v68, a52
    v_accvgpr_read_b32 v69, a53
    v_accvgpr_read_b32 v70, a54
    v_accvgpr_read_b32 v71, a55
    v_accvgpr_read_b32 v72, a56
    v_accvgpr_read_b32 v73, a57
    v_accvgpr_read_b32 v74, a58
    v_accvgpr_read_b32 v75, a59
    v_accvgpr_read_b32 v76, a60
    v_accvgpr_read_b32 v77, a61
    v_accvgpr_read_b32 v78, a62
    v_accvgpr_read_b32 v79, a63
    v_cvt_pk_bf16_f32 v88, v64, v65
    v_cvt_pk_bf16_f32 v89, v66, v67
    buffer_store_dwordx4 v[84:87], v46, s[4:7], s70 offen offset:1024 sc1
    v_cvt_pk_bf16_f32 v90, v68, v69
    v_cvt_pk_bf16_f32 v91, v70, v71
    v_cvt_pk_bf16_f32 v92, v72, v73
    v_cvt_pk_bf16_f32 v93, v74, v75
    v_cvt_pk_bf16_f32 v94, v76, v77
    v_cvt_pk_bf16_f32 v95, v78, v79
    ds_read_b64_tr_b16 v[100:101], v33
    ds_read_b64_tr_b16 v[102:103], v33 offset:512
    s_waitcnt vmcnt(7)
    ds_read_b64_tr_b16 v[104:105], v32 offset:2048
    ds_read_b64_tr_b16 v[106:107], v32 offset:2560
    buffer_store_dwordx4 v[88:91], v46, s[4:7], s71 offen sc1
    ds_read_b64_tr_b16 v[108:109], v33 offset:2048
    ds_read_b64_tr_b16 v[110:111], v33 offset:2560
    buffer_store_dwordx4 v[92:95], v46, s[4:7], s71 offen offset:1024 sc1
    s_waitcnt lgkmcnt(4)
    v_mfma_f32_32x32x16_bf16 a[96:111], v[100:103], v[128:131], 0
    buffer_load_dwordx4 v31, s[32:35], s38 offen offset:1024 lds
    v_mfma_f32_32x32x16_bf16 a[112:127], v[100:103], v[132:135], 0
    s_waitcnt lgkmcnt(2)
    v_mfma_f32_32x32x16_bf16 a[64:79], v[104:107], v[136:139], a[64:79]
    buffer_load_dwordx4 v31, s[32:35], s39 offen offset:2048 lds
    v_mfma_f32_32x32x16_bf16 a[80:95], v[104:107], v[140:143], a[80:95]
    s_waitcnt lgkmcnt(0)
    v_mfma_f32_32x32x16_bf16 a[96:111], v[108:111], v[136:139], a[96:111]
    buffer_load_dwordx4 v31, s[32:35], s40 offen offset:3072 lds
    v_add_u32 v31, 0x8000, v31
    s_add_u32 m0, s93, 0x2000
    v_mfma_f32_32x32x16_bf16 a[112:127], v[108:111], v[140:143], a[112:127]
    buffer_load_dwordx4 v31, s[32:35], 0 offen lds
    buffer_load_dwordx4 v31, s[32:35], s38 offen offset:1024 lds
    buffer_load_dwordx4 v31, s[32:35], s39 offen offset:2048 lds
    buffer_load_dwordx4 v31, s[32:35], s40 offen offset:3072 lds
    v_add_u32 v31, 0x8000, v31
    s_add_u32 m0, s93, 0x3000
    s_waitcnt vmcnt(6)
    ds_read_b64_tr_b16 v[112:113], v32 offset:4096
    buffer_load_dwordx4 v31, s[32:35], 0 offen lds
    ds_read_b64_tr_b16 v[114:115], v32 offset:4608
    ds_read_b64_tr_b16 v[116:117], v33 offset:4096
    ds_read_b64_tr_b16 v[118:119], v33 offset:4608
    buffer_load_dwordx4 v31, s[32:35], s38 offen offset:1024 lds
    s_waitcnt vmcnt(6)
    ds_read_b64_tr_b16 v[120:121], v32 offset:6144
    buffer_load_dwordx4 v31, s[32:35], s39 offen offset:2048 lds
    ds_read_b64_tr_b16 v[122:123], v32 offset:6656
    s_waitcnt lgkmcnt(4)
    v_mfma_f32_32x32x16_bf16 a[64:79], v[112:115], v[144:147], a[64:79]
    ds_read_b64_tr_b16 v[124:125], v33 offset:6144
    ds_read_b64_tr_b16 v[126:127], v33 offset:6656
    v_mfma_f32_32x32x16_bf16 a[80:95], v[112:115], v[148:151], a[80:95]
    buffer_load_dwordx4 v31, s[32:35], s40 offen offset:3072 lds
    v_add_u32 v31, 0x8000, v31
    s_waitcnt lgkmcnt(4)
    v_mfma_f32_32x32x16_bf16 a[96:111], v[116:119], v[144:147], a[96:111]
    s_add_u32 m0, s93, 0
    v_mfma_f32_32x32x16_bf16 a[112:127], v[116:119], v[148:151], a[112:127]
    s_waitcnt vmcnt(6)
    ds_read_b64_tr_b16 v[96:97], v32 offset:8192
    ds_read_b64_tr_b16 v[98:99], v32 offset:8704
    s_waitcnt lgkmcnt(4)
    v_mfma_f32_32x32x16_bf16 a[64:79], v[120:123], v[152:155], a[64:79]
    ds_read_b64_tr_b16 v[100:101], v33 offset:8192
    ds_read_b64_tr_b16 v[102:103], v33 offset:8704
    v_mfma_f32_32x32x16_bf16 a[80:95], v[120:123], v[156:159], a[80:95]
    s_waitcnt lgkmcnt(4)
    v_mfma_f32_32x32x16_bf16 a[96:111], v[124:127], v[152:155], a[96:111]
    v_mfma_f32_32x32x16_bf16 a[112:127], v[124:127], v[156:159], a[112:127]
    s_waitcnt vmcnt(4)
    ds_read_b64_tr_b16 v[104:105], v32 offset:10240
    ds_read_b64_tr_b16 v[106:107], v32 offset:10752
    s_waitcnt lgkmcnt(4)
    v_mfma_f32_32x32x16_bf16 a[64:79], v[96:99], v[160:163], a[64:79]
    ds_read_b64_tr_b16 v[108:109], v33 offset:10240
    ds_read_b64_tr_b16 v[110:111], v33 offset:10752
    v_mfma_f32_32x32x16_bf16 a[80:95], v[96:99], v[164:167], a[80:95]
    s_waitcnt lgkmcnt(4)
    v_mfma_f32_32x32x16_bf16 a[96:111], v[100:103], v[160:163], a[96:111]
    v_mfma_f32_32x32x16_bf16 a[112:127], v[100:103], v[164:167], a[112:127]
    s_waitcnt lgkmcnt(2)
    v_mfma_f32_32x32x16_bf16 a[64:79], v[104:107], v[168:171], a[64:79]
    s_barrier
    buffer_store_dword v59, v58, s[4:7], s89 offen sc1
    s_add_u32 s89, s3, 0x200000
    v_mfma_f32_32x32x16_bf16 a[80:95], v[104:107], v[172:175], a[80:95]
    buffer_load_dwordx4 v31, s[32:35], 0 offen lds
    s_waitcnt lgkmcnt(0)
    v_mfma_f32_32x32x16_bf16 a[96:111], v[108:111], v[168:171], a[96:111]
    v_mfma_f32_32x32x16_bf16 a[112:127], v[108:111], v[172:175], a[112:127]
    buffer_load_dwordx4 v31, s[32:35], s38 offen offset:1024 lds
    buffer_load_dwordx4 v31, s[32:35], s39 offen offset:2048 lds
    buffer_load_dwordx4 v31, s[32:35], s40 offen offset:3072 lds
    v_add_u32 v31, 0x8000, v31
    s_add_u32 m0, s93, 0x1000
    s_waitcnt vmcnt(7)
    ds_read_b64_tr_b16 v[112:113], v32 offset:12288
    buffer_load_dwordx4 v31, s[32:35], 0 offen lds
    ds_read_b64_tr_b16 v[114:115], v32 offset:12800
    ds_read_b64_tr_b16 v[116:117], v33 offset:12288
    ds_read_b64_tr_b16 v[118:119], v33 offset:12800
    buffer_load_dwordx4 v31, s[32:35], s38 offen offset:1024 lds
    s_waitcnt vmcnt(7)
    ds_read_b64_tr_b16 v[120:121], v32 offset:14336
    ds_read_b64_tr_b16 v[122:123], v32 offset:14848
    s_waitcnt lgkmcnt(4)
    v_mfma_f32_32x32x16_bf16 a[64:79], v[112:115], v[176:179], a[64:79]
    ds_read_b64_tr_b16 v[124:125], v33 offset:14336
    ds_read_b64_tr_b16 v[126:127], v33 offset:14848
    v_mfma_f32_32x32x16_bf16 a[80:95], v[112:115], v[180:183], a[80:95]
    s_waitcnt lgkmcnt(4)
    v_mfma_f32_32x32x16_bf16 a[96:111], v[116:119], v[176:179], a[96:111]
    v_mfma_f32_32x32x16_bf16 a[112:127], v[116:119], v[180:183], a[112:127]
    s_waitcnt lgkmcnt(2)
    v_mfma_f32_32x32x16_bf16 a[64:79], v[120:123], v[184:187], a[64:79]
    v_mfma_f32_32x32x16_bf16 a[80:95], v[120:123], v[188:191], a[80:95]
    s_waitcnt lgkmcnt(0)
    v_mfma_f32_32x32x16_bf16 a[96:111], v[124:127], v[184:187], a[96:111]
    v_mfma_f32_32x32x16_bf16 a[112:127], v[124:127], v[188:191], a[112:127]
    s_waitcnt vmcnt(4)
    ds_read_b64_tr_b16 v[96:97], v32
    ds_read_b64_tr_b16 v[98:99], v32 offset:512
    ds_read_b64_tr_b16 v[100:101], v33
    ds_read_b64_tr_b16 v[102:103], v33 offset:512
    s_waitcnt vmcnt(2)
    ds_read_b64_tr_b16 v[104:105], v32 offset:2048
    ds_read_b64_tr_b16 v[106:107], v32 offset:2560
    s_waitcnt lgkmcnt(4)
    v_mfma_f32_32x32x16_bf16 a[64:79], v[96:99], v[192:195], a[64:79]
    ds_read_b64_tr_b16 v[108:109], v33 offset:2048
    ds_read_b64_tr_b16 v[110:111], v33 offset:2560
    v_mfma_f32_32x32x16_bf16 a[80:95], v[96:99], v[196:199], a[80:95]
    s_waitcnt lgkmcnt(4)
    v_mfma_f32_32x32x16_bf16 a[96:111], v[100:103], v[192:195], a[96:111]
    v_mfma_f32_32x32x16_bf16 a[112:127], v[100:103], v[196:199], a[112:127]
    s_waitcnt lgkmcnt(2)
    v_mfma_f32_32x32x16_bf16 a[64:79], v[104:107], v[200:203], a[64:79]
    v_mfma_f32_32x32x16_bf16 a[80:95], v[104:107], v[204:207], a[80:95]
    s_waitcnt lgkmcnt(0)
    v_mfma_f32_32x32x16_bf16 a[96:111], v[108:111], v[200:203], a[96:111]
    v_mfma_f32_32x32x16_bf16 a[112:127], v[108:111], v[204:207], a[112:127]
    s_waitcnt vmcnt(0)
    ds_read_b64_tr_b16 v[112:113], v32 offset:4096
    ds_read_b64_tr_b16 v[114:115], v32 offset:4608
    ds_read_b64_tr_b16 v[116:117], v33 offset:4096
    ds_read_b64_tr_b16 v[118:119], v33 offset:4608
    s_waitcnt lgkmcnt(2)
    v_mfma_f32_32x32x16_bf16 a[64:79], v[112:115], v[208:211], a[64:79]
    v_mfma_f32_32x32x16_bf16 a[80:95], v[112:115], v[212:215], a[80:95]
    s_waitcnt lgkmcnt(0)
    v_mfma_f32_32x32x16_bf16 a[96:111], v[116:119], v[208:211], a[96:111]
    v_mfma_f32_32x32x16_bf16 a[112:127], v[116:119], v[212:215], a[112:127]
    s_nop 0
    s_nop 0
    s_nop 0
    s_nop 0
    s_nop 0
    s_nop 0
    s_nop 0
    s_nop 0
    ds_write_b128 v17, a[64:67]
    ds_write_b128 v17, a[68:71] offset:1024
    ds_write_b128 v17, a[72:75] offset:2048
    ds_write_b128 v17, a[76:79] offset:3072
    ds_write_b128 v17, a[80:83] offset:4096
    ds_write_b128 v17, a[84:87] offset:5120
    ds_write_b128 v17, a[88:91] offset:6144
    ds_write_b128 v17, a[92:95] offset:7168
    ds_write_b128 v17, a[96:99] offset:8192
    ds_write_b128 v17, a[100:103] offset:9216
    ds_write_b128 v17, a[104:107] offset:10240
    ds_write_b128 v17, a[108:111] offset:11264
    ds_write_b128 v17, a[112:115] offset:12288
    ds_write_b128 v17, a[116:119] offset:13312
    ds_write_b128 v17, a[120:123] offset:14336
    ds_write_b128 v17, a[124:127] offset:15360
    s_waitcnt lgkmcnt(0)
    s_barrier
    buffer_load_dword v30, v54, s[4:7], s95 offen sc1
    ds_read_b128 v[128:131], v18
    ds_read_b128 v[132:135], v18 offset:1024
    ds_read_b128 v[136:139], v18 offset:2048
    ds_read_b128 v[140:143], v18 offset:3072
    ds_read_b128 v[144:147], v18 offset:16384
    ds_read_b128 v[148:151], v18 offset:17408
    ds_read_b128 v[152:155], v18 offset:18432
    ds_read_b128 v[156:159], v18 offset:19456
    ds_read_b128 v[160:163], v18 offset:32768
    ds_read_b128 v[164:167], v18 offset:33792
    ds_read_b128 v[168:171], v18 offset:34816
    ds_read_b128 v[172:175], v18 offset:35840
    ds_read_b128 v[176:179], v18 offset:49152
    s_waitcnt lgkmcnt(8)
    v_add_f32 v128, v128, v144
    ds_read_b128 v[180:183], v18 offset:50176
    v_add_f32 v129, v129, v145
    v_add_f32 v130, v130, v146
    v_add_f32 v131, v131, v147
    ds_read_b128 v[184:187], v18 offset:51200
    s_waitcnt lgkmcnt(9)
    v_add_f32 v132, v132, v148
    v_add_f32 v133, v133, v149
    ds_read_b128 v[188:191], v18 offset:52224
    v_add_f32 v134, v134, v150
    v_add_f32 v135, v135, v151
    s_waitcnt lgkmcnt(9)
    v_add_f32 v136, v136, v152
    v_add_f32 v137, v137, v153
    v_add_f32 v138, v138, v154
    v_add_f32 v139, v139, v155
    s_waitcnt lgkmcnt(8)
    v_add_f32 v140, v140, v156
    v_add_f32 v141, v141, v157
    v_add_f32 v142, v142, v158
    v_add_f32 v143, v143, v159
    s_waitcnt lgkmcnt(3)
    v_add_f32 v160, v160, v176
    v_add_f32 v161, v161, v177
    v_add_f32 v162, v162, v178
    v_add_f32 v163, v163, v179
    s_waitcnt lgkmcnt(2)
    v_add_f32 v164, v164, v180
    v_add_f32 v165, v165, v181
    v_add_f32 v166, v166, v182
    v_add_f32 v167, v167, v183
    s_waitcnt lgkmcnt(1)
    v_add_f32 v168, v168, v184
    v_add_f32 v169, v169, v185
    v_add_f32 v170, v170, v186
    v_add_f32 v171, v171, v187
    s_waitcnt lgkmcnt(0)
    v_add_f32 v172, v172, v188
    v_add_f32 v173, v173, v189
    v_add_f32 v174, v174, v190
    v_add_f32 v175, v175, v191
    v_add_f32 v128, v128, v160
    v_add_f32 v129, v129, v161
    v_add_f32 v130, v130, v162
    v_add_f32 v131, v131, v163
    v_add_f32 v132, v132, v164
    v_add_f32 v133, v133, v165
    v_add_f32 v134, v134, v166
    v_add_f32 v135, v135, v167
    v_add_f32 v136, v136, v168
    v_add_f32 v137, v137, v169
    v_add_f32 v138, v138, v170
    v_add_f32 v139, v139, v171
    v_add_f32 v140, v140, v172
    v_add_f32 v141, v141, v173
    v_add_f32 v142, v142, v174
    v_add_f32 v143, v143, v175
    v_cvt_pk_bf16_f32 v144, v128, v129
    v_cvt_pk_bf16_f32 v145, v130, v131
    v_cvt_pk_bf16_f32 v146, v132, v133
    v_cvt_pk_bf16_f32 v147, v134, v135
    v_cvt_pk_bf16_f32 v148, v136, v137
    v_cvt_pk_bf16_f32 v149, v138, v139
    v_cvt_pk_bf16_f32 v150, v140, v141
    v_cvt_pk_bf16_f32 v151, v142, v143
    v_lshlrev_b32 v128, 16, v144
    v_and_b32 v129, 0xffff0000, v144
    v_lshlrev_b32 v130, 16, v145
    v_and_b32 v131, 0xffff0000, v145
    v_lshlrev_b32 v132, 16, v146
    v_and_b32 v133, 0xffff0000, v146
    v_lshlrev_b32 v134, 16, v147
    v_and_b32 v135, 0xffff0000, v147
    v_lshlrev_b32 v136, 16, v148
    v_and_b32 v137, 0xffff0000, v148
    v_lshlrev_b32 v138, 16, v149
    v_and_b32 v139, 0xffff0000, v149
    v_lshlrev_b32 v140, 16, v150
    v_and_b32 v141, 0xffff0000, v150
    v_lshlrev_b32 v142, 16, v151
    v_and_b32 v143, 0xffff0000, v151
    v_mul_f32 v160, 0xbfb8aa3b, v128
    v_mul_f32 v161, 0xbfb8aa3b, v129
    v_mul_f32 v162, 0xbfb8aa3b, v130
    v_mul_f32 v163, 0xbfb8aa3b, v131
    v_mul_f32 v164, 0xbfb8aa3b, v132
    v_mul_f32 v165, 0xbfb8aa3b, v133
    v_mul_f32 v166, 0xbfb8aa3b, v134
    v_mul_f32 v167, 0xbfb8aa3b, v135
    v_mul_f32 v168, 0xbfb8aa3b, v136
    v_mul_f32 v169, 0xbfb8aa3b, v137
    v_mul_f32 v170, 0xbfb8aa3b, v138
    v_mul_f32 v171, 0xbfb8aa3b, v139
    v_mul_f32 v172, 0xbfb8aa3b, v140
    v_mul_f32 v173, 0xbfb8aa3b, v141
    v_mul_f32 v174, 0xbfb8aa3b, v142
    v_mul_f32 v175, 0xbfb8aa3b, v143
    v_exp_f32 v160, v160
    v_exp_f32 v161, v161
    v_exp_f32 v162, v162
    v_exp_f32 v163, v163
    v_exp_f32 v164, v164
    v_exp_f32 v165, v165
    v_exp_f32 v166, v166
    v_exp_f32 v167, v167
    v_exp_f32 v168, v168
    v_exp_f32 v169, v169
    v_exp_f32 v170, v170
    v_exp_f32 v171, v171
    v_exp_f32 v172, v172
    v_exp_f32 v173, v173
    v_exp_f32 v174, v174
    v_exp_f32 v175, v175
    v_add_f32 v160, 1.0, v160
    v_add_f32 v161, 1.0, v161
    v_add_f32 v162, 1.0, v162
    v_add_f32 v163, 1.0, v163
    v_add_f32 v164, 1.0, v164
    v_add_f32 v165, 1.0, v165
    v_add_f32 v166, 1.0, v166
    v_add_f32 v167, 1.0, v167
    v_add_f32 v168, 1.0, v168
    v_add_f32 v169, 1.0, v169
    v_add_f32 v170, 1.0, v170
    v_add_f32 v171, 1.0, v171
    v_add_f32 v172, 1.0, v172
    v_add_f32 v173, 1.0, v173
    v_add_f32 v174, 1.0, v174
    v_add_f32 v175, 1.0, v175
    v_rcp_f32 v160, v160
    v_rcp_f32 v161, v161
    v_rcp_f32 v162, v162
    v_rcp_f32 v163, v163
    v_rcp_f32 v164, v164
    v_rcp_f32 v165, v165
    v_rcp_f32 v166, v166
    v_rcp_f32 v167, v167
    v_rcp_f32 v168, v168
    v_rcp_f32 v169, v169
    v_rcp_f32 v170, v170
    v_rcp_f32 v171, v171
    v_rcp_f32 v172, v172
    v_rcp_f32 v173, v173
    v_rcp_f32 v174, v174
    v_rcp_f32 v175, v175
    v_mul_f32 v128, v128, v160
    v_mul_f32 v129, v129, v161
    v_mul_f32 v130, v130, v162
    v_mul_f32 v131, v131, v163
    v_mul_f32 v132, v132, v164
    v_mul_f32 v133, v133, v165
    v_mul_f32 v134, v134, v166
    v_mul_f32 v135, v135, v167
    v_mul_f32 v136, v136, v168
    v_mul_f32 v137, v137, v169
    v_mul_f32 v138, v138, v170
    v_mul_f32 v139, v139, v171
    v_mul_f32 v140, v140, v172
    v_mul_f32 v141, v141, v173
    v_mul_f32 v142, v142, v174
    v_mul_f32 v143, v143, v175
    v_cvt_pk_bf16_f32 v144, v128, v129
    v_cvt_pk_bf16_f32 v145, v130, v131
    v_cvt_pk_bf16_f32 v146, v132, v133
    v_cvt_pk_bf16_f32 v147, v134, v135
    v_cvt_pk_bf16_f32 v148, v136, v137
    v_cvt_pk_bf16_f32 v149, v138, v139
    v_cvt_pk_bf16_f32 v150, v140, v141
    v_cvt_pk_bf16_f32 v151, v142, v143
    v_lshlrev_b32 v176, 16, v144
    v_and_b32 v177, 0xffff0000, v144
    v_lshlrev_b32 v178, 16, v145
    v_and_b32 v179, 0xffff0000, v145
    v_lshlrev_b32 v180, 16, v146
    v_and_b32 v181, 0xffff0000, v146
    v_lshlrev_b32 v182, 16, v147
    v_and_b32 v183, 0xffff0000, v147
    v_lshlrev_b32 v184, 16, v148
    v_and_b32 v185, 0xffff0000, v148
    v_lshlrev_b32 v186, 16, v149
    v_and_b32 v187, 0xffff0000, v149
    v_lshlrev_b32 v188, 16, v150
    v_and_b32 v189, 0xffff0000, v150
    v_lshlrev_b32 v190, 16, v151
    v_and_b32 v191, 0xffff0000, v151
    v_lshlrev_b32 v160, 16, v8
    v_and_b32 v161, 0xffff0000, v8
    v_lshlrev_b32 v162, 16, v9
    v_and_b32 v163, 0xffff0000, v9
    v_lshlrev_b32 v164, 16, v10
    v_and_b32 v165, 0xffff0000, v10
    v_lshlrev_b32 v166, 16, v11
    v_and_b32 v167, 0xffff0000, v11
    v_lshlrev_b32 v168, 16, v12
    v_and_b32 v169, 0xffff0000, v12
    v_lshlrev_b32 v170, 16, v13
    v_and_b32 v171, 0xffff0000, v13
    v_lshlrev_b32 v172, 16, v14
    v_and_b32 v173, 0xffff0000, v14
    v_lshlrev_b32 v174, 16, v15
    v_and_b32 v175, 0xffff0000, v15
    s_waitcnt vmcnt(0)
    v_cmp_ne_u32 vcc, v59, v30
    s_nop 0
    s_cbranch_vccnz L_slow_part
L_ret_part:
    s_barrier
    buffer_load_dwordx4 v[224:227], v46, s[4:7], s88 offen sc1
    buffer_load_dwordx4 v[232:235], v46, s[4:7], s89 offen sc1
    buffer_load_dwordx4 v[240:243], v46, s[4:7], s90 offen sc1
    buffer_load_dwordx4 v[248:251], v46, s[4:7], s91 offen sc1
    buffer_load_dwordx4 v[228:231], v46, s[4:7], s88 offen offset:1024 sc1
    buffer_load_dwordx4 v[236:239], v46, s[4:7], s89 offen offset:1024 sc1
    buffer_load_dwordx4 v[244:247], v46, s[4:7], s90 offen offset:1024 sc1
    buffer_load_dwordx4 v[252:255], v46, s[4:7], s91 offen offset:1024 sc1
    s_waitcnt vmcnt(7)
    v_lshlrev_b32 v208, 16, v224
    v_and_b32 v209, 0xffff0000, v224
    v_mov_b32 v192, v208
    v_mov_b32 v193, v209
    v_lshlrev_b32 v208, 16, v225
    v_and_b32 v209, 0xffff0000, v225
    v_mov_b32 v194, v208
    v_mov_b32 v195, v209
    v_lshlrev_b32 v208, 16, v226
    v_and_b32 v209, 0xffff0000, v226
    v_mov_b32 v196, v208
    v_mov_b32 v197, v209
    v_lshlrev_b32 v208, 16, v227
    v_and_b32 v209, 0xffff0000, v227
    v_mov_b32 v198, v208
    s_waitcnt vmcnt(6)
    v_lshlrev_b32 v210, 16, v232
    v_and_b32 v211, 0xffff0000, v232
    v_add_f32 v192, v192, v210
    v_add_f32 v193, v193, v211
    v_lshlrev_b32 v210, 16, v233
    v_and_b32 v211, 0xffff0000, v233
    v_add_f32 v194, v194, v210
    v_add_f32 v195, v195, v211
    v_lshlrev_b32 v210, 16, v234
    v_and_b32 v211, 0xffff0000, v234
    v_add_f32 v196, v196, v210
    v_add_f32 v197, v197, v211
    v_mov_b32 v199, v209
    v_lshlrev_b32 v210, 16, v235
    v_and_b32 v211, 0xffff0000, v235
    s_waitcnt vmcnt(5)
    v_lshlrev_b32 v212, 16, v240
    v_and_b32 v213, 0xffff0000, v240
    v_add_f32 v192, v192, v212
    v_add_f32 v193, v193, v213
    v_lshlrev_b32 v212, 16, v241
    v_and_b32 v213, 0xffff0000, v241
    v_add_f32 v194, v194, v212
    v_add_f32 v195, v195, v213
    v_lshlrev_b32 v212, 16, v242
    v_and_b32 v213, 0xffff0000, v242
    v_add_f32 v196, v196, v212
    v_add_f32 v197, v197, v213
    v_add_f32 v198, v198, v210
    v_add_f32 v199, v199, v211
    v_lshlrev_b32 v212, 16, v243
    s_waitcnt vmcnt(4)
    v_lshlrev_b32 v214, 16, v248
    v_and_b32 v215, 0xffff0000, v248
    v_add_f32 v192, v192, v214
    v_add_f32 v193, v193, v215
    v_lshlrev_b32 v214, 16, v249
    v_and_b32 v215, 0xffff0000, v249
    v_add_f32 v194, v194, v214
    v_add_f32 v195, v195, v215
    v_lshlrev_b32 v214, 16, v250
    v_and_b32 v215, 0xffff0000, v250
    v_add_f32 v196, v196, v214
    v_add_f32 v197, v197, v215
    v_and_b32 v213, 0xffff0000, v243
    v_add_f32 v198, v198, v212
    v_add_f32 v199, v199, v213
    s_waitcnt vmcnt(3)
    v_lshlrev_b32 v208, 16, v228
    v_and_b32 v209, 0xffff0000, v228
    v_lshlrev_b32 v214, 16, v251
    v_and_b32 v215, 0xffff0000, v251
    v_mov_b32 v200, v208
    v_mov_b32 v201, v209
    v_add_f32 v198, v198, v214
    v_add_f32 v199, v199, v215
    v_lshlrev_b32 v208, 16, v229
    v_and_b32 v209, 0xffff0000, v229
    v_mov_b32 v202, v208
    v_mov_b32 v203, v209
    v_lshlrev_b32 v208, 16, v230
    v_and_b32 v209, 0xffff0000, v230
    v_mov_b32 v204, v208
    s_waitcnt vmcnt(2)
    v_lshlrev_b32 v210, 16, v236
    v_and_b32 v211, 0xffff0000, v236
    v_add_f32 v200, v200, v210
    v_add_f32 v201, v201, v211
    v_lshlrev_b32 v210, 16, v237
    v_and_b32 v211, 0xffff0000, v237
    v_add_f32 v202, v202, v210
    v_add_f32 v203, v203, v211
    v_mov_b32 v205, v209
    v_lshlrev_b32 v210, 16, v238
    v_and_b32 v211, 0xffff0000, v238
    v_add_f32 v204, v204, v210
    v_add_f32 v205, v205, v211
    v_lshlrev_b32 v208, 16, v231
    v_and_b32 v209, 0xffff0000, v231
    s_waitcnt vmcnt(1)
    v_lshlrev_b32 v212, 16, v244
    v_and_b32 v213, 0xffff0000, v244
    v_add_f32 v200, v200, v212
    v_add_f32 v201, v201, v213
    v_lshlrev_b32 v212, 16, v245
    v_and_b32 v213, 0xffff0000, v245
    v_add_f32 v202, v202, v212
    v_add_f32 v203, v203, v213
    v_lshlrev_b32 v212, 16, v246
    v_and_b32 v213, 0xffff0000, v246
    v_add_f32 v204, v204, v212
    v_add_f32 v205, v205, v213
    v_mov_b32 v206, v208
    v_mov_b32 v207, v209
    v_lshlrev_b32 v210, 16, v239
    s_waitcnt vmcnt(0)
    v_lshlrev_b32 v214, 16, v252
    v_and_b32 v215, 0xffff0000, v252
    v_add_f32 v200, v200, v214
    v_add_f32 v201, v201, v215
    v_lshlrev_b32 v214, 16, v253
    v_and_b32 v215, 0xffff0000, v253
    v_add_f32 v202, v202, v214
    v_add_f32 v203, v203, v215
    v_lshlrev_b32 v214, 16, v254
    v_and_b32 v215, 0xffff0000, v254
    v_and_b32 v211, 0xffff0000, v239
    v_add_f32 v204, v204, v214
    v_add_f32 v205, v205, v215
    v_add_f32 v206, v206, v210
    v_add_f32 v207, v207, v211
    v_lshlrev_b32 v212, 16, v247
    v_and_b32 v213, 0xffff0000, v247
    v_add_f32 v206, v206, v212
    v_add_f32 v207, v207, v213
    v_lshlrev_b32 v214, 16, v255
    v_and_b32 v215, 0xffff0000, v255
    v_add_f32 v206, v206, v214
    v_add_f32 v207, v207, v215
    v_cvt_pk_bf16_f32 v144, v192, v193
    v_cvt_pk_bf16_f32 v145, v194, v195
    v_cvt_pk_bf16_f32 v146, v196, v197
    v_cvt_pk_bf16_f32 v147, v198, v199
    v_cvt_pk_bf16_f32 v148, v200, v201
    v_cvt_pk_bf16_f32 v149, v202, v203
    v_cvt_pk_bf16_f32 v150, v204, v205
    v_cvt_pk_bf16_f32 v151, v206, v207
    v_lshlrev_b32 v192, 16, v144
    v_and_b32 v193, 0xffff0000, v144
    v_lshlrev_b32 v194, 16, v145
    v_and_b32 v195, 0xffff0000, v145
    v_lshlrev_b32 v196, 16, v146
    v_and_b32 v197, 0xffff0000, v146
    v_lshlrev_b32 v198, 16, v147
    v_and_b32 v199, 0xffff0000, v147
    v_lshlrev_b32 v200, 16, v148
    v_and_b32 v201, 0xffff0000, v148
    v_lshlrev_b32 v202, 16, v149
    v_and_b32 v203, 0xffff0000, v149
    v_lshlrev_b32 v204, 16, v150
    v_and_b32 v205, 0xffff0000, v150
    v_lshlrev_b32 v206, 16, v151
    v_and_b32 v207, 0xffff0000, v151
    v_mul_f32 v192, v192, v176
    v_mul_f32 v193, v193, v177
    v_mul_f32 v194, v194, v178
    v_mul_f32 v195, v195, v179
    v_mul_f32 v196, v196, v180
    v_mul_f32 v197, v197, v181
    v_mul_f32 v198, v198, v182
    v_mul_f32 v199, v199, v183
    v_mul_f32 v200, v200, v184
    v_mul_f32 v201, v201, v185
    v_mul_f32 v202, v202, v186
    v_mul_f32 v203, v203, v187
    v_mul_f32 v204, v204, v188
    v_mul_f32 v205, v205, v189
    v_mul_f32 v206, v206, v190
    v_mul_f32 v207, v207, v191
    v_cvt_pk_bf16_f32 v144, v192, v193
    v_cvt_pk_bf16_f32 v145, v194, v195
    v_cvt_pk_bf16_f32 v146, v196, v197
    v_cvt_pk_bf16_f32 v147, v198, v199
    v_cvt_pk_bf16_f32 v148, v200, v201
    v_cvt_pk_bf16_f32 v149, v202, v203
    v_cvt_pk_bf16_f32 v150, v204, v205
    v_cvt_pk_bf16_f32 v151, v206, v207
    v_lshlrev_b32 v192, 16, v144
    v_and_b32 v193, 0xffff0000, v144
    v_lshlrev_b32 v194, 16, v145
    v_and_b32 v195, 0xffff0000, v145
    v_lshlrev_b32 v196, 16, v146
    v_and_b32 v197, 0xffff0000, v146
    v_lshlrev_b32 v198, 16, v147
    v_and_b32 v199, 0xffff0000, v147
    v_lshlrev_b32 v200, 16, v148
    v_and_b32 v201, 0xffff0000, v148
    v_lshlrev_b32 v202, 16, v149
    v_and_b32 v203, 0xffff0000, v149
    v_lshlrev_b32 v204, 16, v150
    v_and_b32 v205, 0xffff0000, v150
    v_lshlrev_b32 v206, 16, v151
    v_and_b32 v207, 0xffff0000, v151
    v_add_f32 v192, v192, v160
    v_add_f32 v193, v193, v161
    v_add_f32 v194, v194, v162
    v_add_f32 v195, v195, v163
    v_add_f32 v196, v196, v164
    v_add_f32 v197, v197, v165
    v_add_f32 v198, v198, v166
    v_add_f32 v199, v199, v167
    v_add_f32 v200, v200, v168
    v_add_f32 v201, v201, v169
    v_add_f32 v202, v202, v170
    v_add_f32 v203, v203, v171
    v_add_f32 v204, v204, v172
    v_add_f32 v205, v205, v173
    v_add_f32 v206, v206, v174
    v_add_f32 v207, v207, v175
    v_cvt_pk_bf16_f32 v96, v192, v193
    v_cvt_pk_bf16_f32 v97, v194, v195
    v_cvt_pk_bf16_f32 v98, v196, v197
    v_cvt_pk_bf16_f32 v99, v198, v199
    v_cvt_pk_bf16_f32 v100, v200, v201
    v_cvt_pk_bf16_f32 v101, v202, v203
    v_cvt_pk_bf16_f32 v102, v204, v205
    v_cvt_pk_bf16_f32 v103, v206, v207
    buffer_store_dwordx4 v[96:99], v34, s[24:27], s43 offen
    buffer_store_dwordx4 v[100:103], v34, s[24:27], s43 offen offset:32
    s_endpgm
L_rare1:
    s_call_b64 s[96:97], L_rescale1
    s_branch L_rare1_ret
L_rare2:
    s_call_b64 s[96:97], L_rescale0
    s_branch L_rare2_ret
L_rare3:
    s_call_b64 s[96:97], L_rescale1
    s_branch L_rare3_ret
L_rare4:
    s_call_b64 s[96:97], L_rescale0
    s_branch L_rare4_ret
L_rare5:
    s_call_b64 s[96:97], L_rescale1
    s_branch L_rare5_ret
L_rare6:
    s_call_b64 s[96:97], L_rescale0
    s_branch L_rare6_ret
L_rare7:
    s_call_b64 s[96:97], L_rescale1
    s_branch L_rare7_ret
L_rare8:
    s_call_b64 s[96:97], L_rescale0
    s_branch L_rare8_ret
L_rare9:
    s_call_b64 s[96:97], L_rescale1
    s_branch L_rare9_ret
L_rare10:
    s_call_b64 s[96:97], L_rescale0
    s_branch L_rare10_ret
L_rare11:
    s_call_b64 s[96:97], L_rescale1
    s_branch L_rare11_ret
L_rare12:
    s_call_b64 s[96:97], L_rescale0
    s_branch L_rare12_ret
L_rare13:
    s_call_b64 s[96:97], L_rescale1
    s_branch L_rare13_ret
L_rare14:
    s_call_b64 s[96:97], L_rescale0
    s_branch L_rare14_ret
L_rare15:
    s_call_b64 s[96:97], L_rescale1
    s_branch L_rare15_ret
L_rescale0:
    s_nop 15
    v_max3_f32 v53, v128, v129, v130
    v_max3_f32 v53, v131, v132, v53
    v_max3_f32 v53, v133, v134, v53
    v_max3_f32 v53, v135, v136, v53
    v_max3_f32 v53, v137, v138, v53
    v_max3_f32 v53, v139, v140, v53
    v_max3_f32 v53, v141, v142, v53
    v_max_f32 v53, v143, v53
    v_mov_b32 v54, v53
    s_nop 1
    v_permlane32_swap_b32 v53, v54
    v_max_f32 v53, v53, v54
    v_max_f32 v53, 0, v53
    v_sub_f32 v54, 0, v53
    v_exp_f32 v54, v54
    v_sub_f32 v128, v128, v53
    v_sub_f32 v64, v64, v53
    v_sub_f32 v129, v129, v53
    v_sub_f32 v65, v65, v53
    v_sub_f32 v130, v130, v53
    v_sub_f32 v66, v66, v53
    v_sub_f32 v131, v131, v53
    v_sub_f32 v67, v67, v53
    v_sub_f32 v132, v132, v53
    v_sub_f32 v68, v68, v53
    v_sub_f32 v133, v133, v53
    v_sub_f32 v69, v69, v53
    v_sub_f32 v134, v134, v53
    v_sub_f32 v70, v70, v53
    v_sub_f32 v135, v135, v53
    v_sub_f32 v71, v71, v53
    v_sub_f32 v136, v136, v53
    v_sub_f32 v72, v72, v53
    v_sub_f32 v137, v137, v53
    v_sub_f32 v73, v73, v53
    v_sub_f32 v138, v138, v53
    v_sub_f32 v74, v74, v53
    v_sub_f32 v139, v139, v53
    v_sub_f32 v75, v75, v53
    v_sub_f32 v140, v140, v53
    v_sub_f32 v76, v76, v53
    v_sub_f32 v141, v141, v53
    v_sub_f32 v77, v77, v53
    v_sub_f32 v142, v142, v53
    v_sub_f32 v78, v78, v53
    v_sub_f32 v143, v143, v53
    v_sub_f32 v79, v79, v53
    v_mul_f32 v48, v48, v54
    v_mul_f32 v49, v49, v54
    v_accvgpr_read_b32 v55, a0
    v_mul_f32 v55, v55, v54
    v_accvgpr_write_b32 a0, v55
    v_accvgpr_read_b32 v56, a1
    v_mul_f32 v56, v56, v54
    v_accvgpr_write_b32 a1, v56
    v_accvgpr_read_b32 v55, a2
    v_mul_f32 v55, v55, v54
    v_accvgpr_write_b32 a2, v55
    v_accvgpr_read_b32 v56, a3
    v_mul_f32 v56, v56, v54
    v_accvgpr_write_b32 a3, v56
    v_accvgpr_read_b32 v55, a4
    v_mul_f32 v55, v55, v54
    v_accvgpr_write_b32 a4, v55
    v_accvgpr_read_b32 v56, a5
    v_mul_f32 v56, v56, v54
    v_accvgpr_write_b32 a5, v56
    v_accvgpr_read_b32 v55, a6
    v_mul_f32 v55, v55, v54
    v_accvgpr_write_b32 a6, v55
    v_accvgpr_read_b32 v56, a7
    v_mul_f32 v56, v56, v54
    v_accvgpr_write_b32 a7, v56
    v_accvgpr_read_b32 v55, a8
    v_mul_f32 v55, v55, v54
    v_accvgpr_write_b32 a8, v55
    v_accvgpr_read_b32 v56, a9
    v_mul_f32 v56, v56, v54
    v_accvgpr_write_b32 a9, v56
    v_accvgpr_read_b32 v55, a10
    v_mul_f32 v55, v55, v54
    v_accvgpr_write_b32 a10, v55
    v_accvgpr_read_b32 v56, a11
    v_mul_f32 v56, v56, v54
    v_accvgpr_write_b32 a11, v56
    v_accvgpr_read_b32 v55, a12
    v_mul_f32 v55, v55, v54
    v_accvgpr_write_b32 a12, v55
    v_accvgpr_read_b32 v56, a13
    v_mul_f32 v56, v56, v54
    v_accvgpr_write_b32 a13, v56
    v_accvgpr_read_b32 v55, a14
    v_mul_f32 v55, v55, v54
    v_accvgpr_write_b32 a14, v55
    v_accvgpr_read_b32 v56, a15
    v_mul_f32 v56, v56, v54
    v_accvgpr_write_b32 a15, v56
    v_accvgpr_read_b32 v55, a16
    v_mul_f32 v55, v55, v54
    v_accvgpr_write_b32 a16, v55
    v_accvgpr_read_b32 v56, a17
    v_mul_f32 v56, v56, v54
    v_accvgpr_write_b32 a17, v56
    v_accvgpr_read_b32 v55, a18
    v_mul_f32 v55, v55, v54
    v_accvgpr_write_b32 a18, v55
    v_accvgpr_read_b32 v56, a19
    v_mul_f32 v56, v56, v54
    v_accvgpr_write_b32 a19, v56
    v_accvgpr_read_b32 v55, a20
    v_mul_f32 v55, v55, v54
    v_accvgpr_write_b32 a20, v55
    v_accvgpr_read_b32 v56, a21
    v_mul_f32 v56, v56, v54
    v_accvgpr_write_b32 a21, v56
    v_accvgpr_read_b32 v55, a22
    v_mul_f32 v55, v55, v54
    v_accvgpr_write_b32 a22, v55
    v_accvgpr_read_b32 v56, a23
    v_mul_f32 v56, v56, v54
    v_accvgpr_write_b32 a23, v56
    v_accvgpr_read_b32 v55, a24
    v_mul_f32 v55, v55, v54
    v_accvgpr_write_b32 a24, v55
    v_accvgpr_read_b32 v56, a25
    v_mul_f32 v56, v56, v54
    v_accvgpr_write_b32 a25, v56
    v_accvgpr_read_b32 v55, a26
    v_mul_f32 v55, v55, v54
    v_accvgpr_write_b32 a26, v55
    v_accvgpr_read_b32 v56, a27
    v_mul_f32 v56, v56, v54
    v_accvgpr_write_b32 a27, v56
    v_accvgpr_read_b32 v55, a28
    v_mul_f32 v55, v55, v54
    v_accvgpr_write_b32 a28, v55
    v_accvgpr_read_b32 v56, a29
    v_mul_f32 v56, v56, v54
    v_accvgpr_write_b32 a29, v56
    v_accvgpr_read_b32 v55, a30
    v_mul_f32 v55, v55, v54
    v_accvgpr_write_b32 a30, v55
    v_accvgpr_read_b32 v56, a31
    v_mul_f32 v56, v56, v54
    v_accvgpr_write_b32 a31, v56
    v_accvgpr_read_b32 v55, a32
    v_mul_f32 v55, v55, v54
    v_accvgpr_write_b32 a32, v55
    v_accvgpr_read_b32 v56, a33
    v_mul_f32 v56, v56, v54
    v_accvgpr_write_b32 a33, v56
    v_accvgpr_read_b32 v55, a34
    v_mul_f32 v55, v55, v54
    v_accvgpr_write_b32 a34, v55
    v_accvgpr_read_b32 v56, a35
    v_mul_f32 v56, v56, v54
    v_accvgpr_write_b32 a35, v56
    v_accvgpr_read_b32 v55, a36
    v_mul_f32 v55, v55, v54
    v_accvgpr_write_b32 a36, v55
    v_accvgpr_read_b32 v56, a37
    v_mul_f32 v56, v56, v54
    v_accvgpr_write_b32 a37, v56
    v_accvgpr_read_b32 v55, a38
    v_mul_f32 v55, v55, v54
    v_accvgpr_write_b32 a38, v55
    v_accvgpr_read_b32 v56, a39
    v_mul_f32 v56, v56, v54
    v_accvgpr_write_b32 a39, v56
    v_accvgpr_read_b32 v55, a40
    v_mul_f32 v55, v55, v54
    v_accvgpr_write_b32 a40, v55
    v_accvgpr_read_b32 v56, a41
    v_mul_f32 v56, v56, v54
    v_accvgpr_write_b32 a41, v56
    v_accvgpr_read_b32 v55, a42
    v_mul_f32 v55, v55, v54
    v_accvgpr_write_b32 a42, v55
    v_accvgpr_read_b32 v56, a43
    v_mul_f32 v56, v56, v54
    v_accvgpr_write_b32 a43, v56
    v_accvgpr_read_b32 v55, a44
    v_mul_f32 v55, v55, v54
    v_accvgpr_write_b32 a44, v55
    v_accvgpr_read_b32 v56, a45
    v_mul_f32 v56, v56, v54
    v_accvgpr_write_b32 a45, v56
    v_accvgpr_read_b32 v55, a46
    v_mul_f32 v55, v55, v54
    v_accvgpr_write_b32 a46, v55
    v_accvgpr_read_b32 v56, a47
    v_mul_f32 v56, v56, v54
    v_accvgpr_write_b32 a47, v56
    v_accvgpr_read_b32 v55, a48
    v_mul_f32 v55, v55, v54
    v_accvgpr_write_b32 a48, v55
    v_accvgpr_read_b32 v56, a49
    v_mul_f32 v56, v56, v54
    v_accvgpr_write_b32 a49, v56
    v_accvgpr_read_b32 v55, a50
    v_mul_f32 v55, v55, v54
    v_accvgpr_write_b32 a50, v55
    v_accvgpr_read_b32 v56, a51
    v_mul_f32 v56, v56, v54
    v_accvgpr_write_b32 a51, v56
    v_accvgpr_read_b32 v55, a52
    v_mul_f32 v55, v55, v54
    v_accvgpr_write_b32 a52, v55
    v_accvgpr_read_b32 v56, a53
    v_mul_f32 v56, v56, v54
    v_accvgpr_write_b32 a53, v56
    v_accvgpr_read_b32 v55, a54
    v_mul_f32 v55, v55, v54
    v_accvgpr_write_b32 a54, v55
    v_accvgpr_read_b32 v56, a55
    v_mul_f32 v56, v56, v54
    v_accvgpr_write_b32 a55, v56
    v_accvgpr_read_b32 v55, a56
    v_mul_f32 v55, v55, v54
    v_accvgpr_write_b32 a56, v55
    v_accvgpr_read_b32 v56, a57
    v_mul_f32 v56, v56, v54
    v_accvgpr_write_b32 a57, v56
    v_accvgpr_read_b32 v55, a58
    v_mul_f32 v55, v55, v54
    v_accvgpr_write_b32 a58, v55
    v_accvgpr_read_b32 v56, a59
    v_mul_f32 v56, v56, v54
    v_accvgpr_write_b32 a59, v56
    v_accvgpr_read_b32 v55, a60
    v_mul_f32 v55, v55, v54
    v_accvgpr_write_b32 a60, v55
    v_accvgpr_read_b32 v56, a61
    v_mul_f32 v56, v56, v54
    v_accvgpr_write_b32 a61, v56
    v_accvgpr_read_b32 v55, a62
    v_mul_f32 v55, v55, v54
    v_accvgpr_write_b32 a62, v55
    v_accvgpr_read_b32 v56, a63
    v_mul_f32 v56, v56, v54
    v_accvgpr_write_b32 a63, v56
    v_max3_f32 v53, v144, v145, v146
    v_max3_f32 v53, v147, v148, v53
    v_max3_f32 v53, v149, v150, v53
    v_max3_f32 v53, v151, v152, v53
    v_max3_f32 v53, v153, v154, v53
    v_max3_f32 v53, v155, v156, v53
    v_max3_f32 v53, v157, v158, v53
    v_max_f32 v53, v159, v53
    v_mov_b32 v54, v53
    s_nop 1
    v_permlane32_swap_b32 v53, v54
    v_max_f32 v53, v53, v54
    v_max_f32 v53, 0, v53
    v_sub_f32 v54, 0, v53
    v_exp_f32 v54, v54
    v_sub_f32 v144, v144, v53
    v_sub_f32 v80, v80, v53
    v_sub_f32 v145, v145, v53
    v_sub_f32 v81, v81, v53
    v_sub_f32 v146, v146, v53
    v_sub_f32 v82, v82, v53
    v_sub_f32 v147, v147, v53
    v_sub_f32 v83, v83, v53
    v_sub_f32 v148, v148, v53
    v_sub_f32 v84, v84, v53
    v_sub_f32 v149, v149, v53
    v_sub_f32 v85, v85, v53
    v_sub_f32 v150, v150, v53
    v_sub_f32 v86, v86, v53
    v_sub_f32 v151, v151, v53
    v_sub_f32 v87, v87, v53
    v_sub_f32 v152, v152, v53
    v_sub_f32 v88, v88, v53
    v_sub_f32 v153, v153, v53
    v_sub_f32 v89, v89, v53
    v_sub_f32 v154, v154, v53
    v_sub_f32 v90, v90, v53
    v_sub_f32 v155, v155, v53
    v_sub_f32 v91, v91, v53
    v_sub_f32 v156, v156, v53
    v_sub_f32 v92, v92, v53
    v_sub_f32 v157, v157, v53
    v_sub_f32 v93, v93, v53
    v_sub_f32 v158, v158, v53
    v_sub_f32 v94, v94, v53
    v_sub_f32 v159, v159, v53
    v_sub_f32 v95, v95, v53
    v_mul_f32 v50, v50, v54
    v_mul_f32 v51, v51, v54
    v_accvgpr_read_b32 v55, a64
    v_mul_f32 v55, v55, v54
    v_accvgpr_write_b32 a64, v55
    v_accvgpr_read_b32 v56, a65
    v_mul_f32 v56, v56, v54
    v_accvgpr_write_b32 a65, v56
    v_accvgpr_read_b32 v55, a66
    v_mul_f32 v55, v55, v54
    v_accvgpr_write_b32 a66, v55
    v_accvgpr_read_b32 v56, a67
    v_mul_f32 v56, v56, v54
    v_accvgpr_write_b32 a67, v56
    v_accvgpr_read_b32 v55, a68
    v_mul_f32 v55, v55, v54
    v_accvgpr_write_b32 a68, v55
    v_accvgpr_read_b32 v56, a69
    v_mul_f32 v56, v56, v54
    v_accvgpr_write_b32 a69, v56
    v_accvgpr_read_b32 v55, a70
    v_mul_f32 v55, v55, v54
    v_accvgpr_write_b32 a70, v55
    v_accvgpr_read_b32 v56, a71
    v_mul_f32 v56, v56, v54
    v_accvgpr_write_b32 a71, v56
    v_accvgpr_read_b32 v55, a72
    v_mul_f32 v55, v55, v54
    v_accvgpr_write_b32 a72, v55
    v_accvgpr_read_b32 v56, a73
    v_mul_f32 v56, v56, v54
    v_accvgpr_write_b32 a73, v56
    v_accvgpr_read_b32 v55, a74
    v_mul_f32 v55, v55, v54
    v_accvgpr_write_b32 a74, v55
    v_accvgpr_read_b32 v56, a75
    v_mul_f32 v56, v56, v54
    v_accvgpr_write_b32 a75, v56
    v_accvgpr_read_b32 v55, a76
    v_mul_f32 v55, v55, v54
    v_accvgpr_write_b32 a76, v55
    v_accvgpr_read_b32 v56, a77
    v_mul_f32 v56, v56, v54
    v_accvgpr_write_b32 a77, v56
    v_accvgpr_read_b32 v55, a78
    v_mul_f32 v55, v55, v54
    v_accvgpr_write_b32 a78, v55
    v_accvgpr_read_b32 v56, a79
    v_mul_f32 v56, v56, v54
    v_accvgpr_write_b32 a79, v56
    v_accvgpr_read_b32 v55, a80
    v_mul_f32 v55, v55, v54
    v_accvgpr_write_b32 a80, v55
    v_accvgpr_read_b32 v56, a81
    v_mul_f32 v56, v56, v54
    v_accvgpr_write_b32 a81, v56
    v_accvgpr_read_b32 v55, a82
    v_mul_f32 v55, v55, v54
    v_accvgpr_write_b32 a82, v55
    v_accvgpr_read_b32 v56, a83
    v_mul_f32 v56, v56, v54
    v_accvgpr_write_b32 a83, v56
    v_accvgpr_read_b32 v55, a84
    v_mul_f32 v55, v55, v54
    v_accvgpr_write_b32 a84, v55
    v_accvgpr_read_b32 v56, a85
    v_mul_f32 v56, v56, v54
    v_accvgpr_write_b32 a85, v56
    v_accvgpr_read_b32 v55, a86
    v_mul_f32 v55, v55, v54
    v_accvgpr_write_b32 a86, v55
    v_accvgpr_read_b32 v56, a87
    v_mul_f32 v56, v56, v54
    v_accvgpr_write_b32 a87, v56
    v_accvgpr_read_b32 v55, a88
    v_mul_f32 v55, v55, v54
    v_accvgpr_write_b32 a88, v55
    v_accvgpr_read_b32 v56, a89
    v_mul_f32 v56, v56, v54
    v_accvgpr_write_b32 a89, v56
    v_accvgpr_read_b32 v55, a90
    v_mul_f32 v55, v55, v54
    v_accvgpr_write_b32 a90, v55
    v_accvgpr_read_b32 v56, a91
    v_mul_f32 v56, v56, v54
    v_accvgpr_write_b32 a91, v56
    v_accvgpr_read_b32 v55, a92
    v_mul_f32 v55, v55, v54
    v_accvgpr_write_b32 a92, v55
    v_accvgpr_read_b32 v56, a93
    v_mul_f32 v56, v56, v54
    v_accvgpr_write_b32 a93, v56
    v_accvgpr_read_b32 v55, a94
    v_mul_f32 v55, v55, v54
    v_accvgpr_write_b32 a94, v55
    v_accvgpr_read_b32 v56, a95
    v_mul_f32 v56, v56, v54
    v_accvgpr_write_b32 a95, v56
    v_accvgpr_read_b32 v55, a96
    v_mul_f32 v55, v55, v54
    v_accvgpr_write_b32 a96, v55
    v_accvgpr_read_b32 v56, a97
    v_mul_f32 v56, v56, v54
    v_accvgpr_write_b32 a97, v56
    v_accvgpr_read_b32 v55, a98
    v_mul_f32 v55, v55, v54
    v_accvgpr_write_b32 a98, v55
    v_accvgpr_read_b32 v56, a99
    v_mul_f32 v56, v56, v54
    v_accvgpr_write_b32 a99, v56
    v_accvgpr_read_b32 v55, a100
    v_mul_f32 v55, v55, v54
    v_accvgpr_write_b32 a100, v55
    v_accvgpr_read_b32 v56, a101
    v_mul_f32 v56, v56, v54
    v_accvgpr_write_b32 a101, v56
    v_accvgpr_read_b32 v55, a102
    v_mul_f32 v55, v55, v54
    v_accvgpr_write_b32 a102, v55
    v_accvgpr_read_b32 v56, a103
    v_mul_f32 v56, v56, v54
    v_accvgpr_write_b32 a103, v56
    v_accvgpr_read_b32 v55, a104
    v_mul_f32 v55, v55, v54
    v_accvgpr_write_b32 a104, v55
    v_accvgpr_read_b32 v56, a105
    v_mul_f32 v56, v56, v54
    v_accvgpr_write_b32 a105, v56
    v_accvgpr_read_b32 v55, a106
    v_mul_f32 v55, v55, v54
    v_accvgpr_write_b32 a106, v55
    v_accvgpr_read_b32 v56, a107
    v_mul_f32 v56, v56, v54
    v_accvgpr_write_b32 a107, v56
    v_accvgpr_read_b32 v55, a108
    v_mul_f32 v55, v55, v54
    v_accvgpr_write_b32 a108, v55
    v_accvgpr_read_b32 v56, a109
    v_mul_f32 v56, v56, v54
    v_accvgpr_write_b32 a109, v56
    v_accvgpr_read_b32 v55, a110
    v_mul_f32 v55, v55, v54
    v_accvgpr_write_b32 a110, v55
    v_accvgpr_read_b32 v56, a111
    v_mul_f32 v56, v56, v54
    v_accvgpr_write_b32 a111, v56
    v_accvgpr_read_b32 v55, a112
    v_mul_f32 v55, v55, v54
    v_accvgpr_write_b32 a112, v55
    v_accvgpr_read_b32 v56, a113
    v_mul_f32 v56, v56, v54
    v_accvgpr_write_b32 a113, v56
    v_accvgpr_read_b32 v55, a114
    v_mul_f32 v55, v55, v54
    v_accvgpr_write_b32 a114, v55
    v_accvgpr_read_b32 v56, a115
    v_mul_f32 v56, v56, v54
    v_accvgpr_write_b32 a115, v56
    v_accvgpr_read_b32 v55, a116
    v_mul_f32 v55, v55, v54
    v_accvgpr_write_b32 a116, v55
    v_accvgpr_read_b32 v56, a117
    v_mul_f32 v56, v56, v54
    v_accvgpr_write_b32 a117, v56
    v_accvgpr_read_b32 v55, a118
    v_mul_f32 v55, v55, v54
    v_accvgpr_write_b32 a118, v55
    v_accvgpr_read_b32 v56, a119
    v_mul_f32 v56, v56, v54
    v_accvgpr_write_b32 a119, v56
    v_accvgpr_read_b32 v55, a120
    v_mul_f32 v55, v55, v54
    v_accvgpr_write_b32 a120, v55
    v_accvgpr_read_b32 v56, a121
    v_mul_f32 v56, v56, v54
    v_accvgpr_write_b32 a121, v56
    v_accvgpr_read_b32 v55, a122
    v_mul_f32 v55, v55, v54
    v_accvgpr_write_b32 a122, v55
    v_accvgpr_read_b32 v56, a123
    v_mul_f32 v56, v56, v54
    v_accvgpr_write_b32 a123, v56
    v_accvgpr_read_b32 v55, a124
    v_mul_f32 v55, v55, v54
    v_accvgpr_write_b32 a124, v55
    v_accvgpr_read_b32 v56, a125
    v_mul_f32 v56, v56, v54
    v_accvgpr_write_b32 a125, v56
    v_accvgpr_read_b32 v55, a126
    v_mul_f32 v55, v55, v54
    v_accvgpr_write_b32 a126, v55
    v_accvgpr_read_b32 v56, a127
    v_mul_f32 v56, v56, v54
    v_accvgpr_write_b32 a127, v56
    s_nop 3
    s_setpc_b64 s[96:97]
L_rescale1:
    s_nop 15
    v_max3_f32 v53, v160, v161, v162
    v_max3_f32 v53, v163, v164, v53
    v_max3_f32 v53, v165, v166, v53
    v_max3_f32 v53, v167, v168, v53
    v_max3_f32 v53, v169, v170, v53
    v_max3_f32 v53, v171, v172, v53
    v_max3_f32 v53, v173, v174, v53
    v_max_f32 v53, v175, v53
    v_mov_b32 v54, v53
    s_nop 1
    v_permlane32_swap_b32 v53, v54
    v_max_f32 v53, v53, v54
    v_max_f32 v53, 0, v53
    v_sub_f32 v54, 0, v53
    v_exp_f32 v54, v54
    v_sub_f32 v160, v160, v53
    v_sub_f32 v64, v64, v53
    v_sub_f32 v161, v161, v53
    v_sub_f32 v65, v65, v53
    v_sub_f32 v162, v162, v53
    v_sub_f32 v66, v66, v53
    v_sub_f32 v163, v163, v53
    v_sub_f32 v67, v67, v53
    v_sub_f32 v164, v164, v53
    v_sub_f32 v68, v68, v53
    v_sub_f32 v165, v165, v53
    v_sub_f32 v69, v69, v53
    v_sub_f32 v166, v166, v53
    v_sub_f32 v70, v70, v53
    v_sub_f32 v167, v167, v53
    v_sub_f32 v71, v71, v53
    v_sub_f32 v168, v168, v53
    v_sub_f32 v72, v72, v53
    v_sub_f32 v169, v169, v53
    v_sub_f32 v73, v73, v53
    v_sub_f32 v170, v170, v53
    v_sub_f32 v74, v74, v53
    v_sub_f32 v171, v171, v53
    v_sub_f32 v75, v75, v53
    v_sub_f32 v172, v172, v53
    v_sub_f32 v76, v76, v53
    v_sub_f32 v173, v173, v53
    v_sub_f32 v77, v77, v53
    v_sub_f32 v174, v174, v53
    v_sub_f32 v78, v78, v53
    v_sub_f32 v175, v175, v53
    v_sub_f32 v79, v79, v53
    v_mul_f32 v48, v48, v54
    v_mul_f32 v49, v49, v54
    v_accvgpr_read_b32 v55, a0
    v_mul_f32 v55, v55, v54
    v_accvgpr_write_b32 a0, v55
    v_accvgpr_read_b32 v56, a1
    v_mul_f32 v56, v56, v54
    v_accvgpr_write_b32 a1, v56
    v_accvgpr_read_b32 v55, a2
    v_mul_f32 v55, v55, v54
    v_accvgpr_write_b32 a2, v55
    v_accvgpr_read_b32 v56, a3
    v_mul_f32 v56, v56, v54
    v_accvgpr_write_b32 a3, v56
    v_accvgpr_read_b32 v55, a4
    v_mul_f32 v55, v55, v54
    v_accvgpr_write_b32 a4, v55
    v_accvgpr_read_b32 v56, a5
    v_mul_f32 v56, v56, v54
    v_accvgpr_write_b32 a5, v56
    v_accvgpr_read_b32 v55, a6
    v_mul_f32 v55, v55, v54
    v_accvgpr_write_b32 a6, v55
    v_accvgpr_read_b32 v56, a7
    v_mul_f32 v56, v56, v54
    v_accvgpr_write_b32 a7, v56
    v_accvgpr_read_b32 v55, a8
    v_mul_f32 v55, v55, v54
    v_accvgpr_write_b32 a8, v55
    v_accvgpr_read_b32 v56, a9
    v_mul_f32 v56, v56, v54
    v_accvgpr_write_b32 a9, v56
    v_accvgpr_read_b32 v55, a10
    v_mul_f32 v55, v55, v54
    v_accvgpr_write_b32 a10, v55
    v_accvgpr_read_b32 v56, a11
    v_mul_f32 v56, v56, v54
    v_accvgpr_write_b32 a11, v56
    v_accvgpr_read_b32 v55, a12
    v_mul_f32 v55, v55, v54
    v_accvgpr_write_b32 a12, v55
    v_accvgpr_read_b32 v56, a13
    v_mul_f32 v56, v56, v54
    v_accvgpr_write_b32 a13, v56
    v_accvgpr_read_b32 v55, a14
    v_mul_f32 v55, v55, v54
    v_accvgpr_write_b32 a14, v55
    v_accvgpr_read_b32 v56, a15
    v_mul_f32 v56, v56, v54
    v_accvgpr_write_b32 a15, v56
    v_accvgpr_read_b32 v55, a16
    v_mul_f32 v55, v55, v54
    v_accvgpr_write_b32 a16, v55
    v_accvgpr_read_b32 v56, a17
    v_mul_f32 v56, v56, v54
    v_accvgpr_write_b32 a17, v56
    v_accvgpr_read_b32 v55, a18
    v_mul_f32 v55, v55, v54
    v_accvgpr_write_b32 a18, v55
    v_accvgpr_read_b32 v56, a19
    v_mul_f32 v56, v56, v54
    v_accvgpr_write_b32 a19, v56
    v_accvgpr_read_b32 v55, a20
    v_mul_f32 v55, v55, v54
    v_accvgpr_write_b32 a20, v55
    v_accvgpr_read_b32 v56, a21
    v_mul_f32 v56, v56, v54
    v_accvgpr_write_b32 a21, v56
    v_accvgpr_read_b32 v55, a22
    v_mul_f32 v55, v55, v54
    v_accvgpr_write_b32 a22, v55
    v_accvgpr_read_b32 v56, a23
    v_mul_f32 v56, v56, v54
    v_accvgpr_write_b32 a23, v56
    v_accvgpr_read_b32 v55, a24
    v_mul_f32 v55, v55, v54
    v_accvgpr_write_b32 a24, v55
    v_accvgpr_read_b32 v56, a25
    v_mul_f32 v56, v56, v54
    v_accvgpr_write_b32 a25, v56
    v_accvgpr_read_b32 v55, a26
    v_mul_f32 v55, v55, v54
    v_accvgpr_write_b32 a26, v55
    v_accvgpr_read_b32 v56, a27
    v_mul_f32 v56, v56, v54
    v_accvgpr_write_b32 a27, v56
    v_accvgpr_read_b32 v55, a28
    v_mul_f32 v55, v55, v54
    v_accvgpr_write_b32 a28, v55
    v_accvgpr_read_b32 v56, a29
    v_mul_f32 v56, v56, v54
    v_accvgpr_write_b32 a29, v56
    v_accvgpr_read_b32 v55, a30
    v_mul_f32 v55, v55, v54
    v_accvgpr_write_b32 a30, v55
    v_accvgpr_read_b32 v56, a31
    v_mul_f32 v56, v56, v54
    v_accvgpr_write_b32 a31, v56
    v_accvgpr_read_b32 v55, a32
    v_mul_f32 v55, v55, v54
    v_accvgpr_write_b32 a32, v55
    v_accvgpr_read_b32 v56, a33
    v_mul_f32 v56, v56, v54
    v_accvgpr_write_b32 a33, v56
    v_accvgpr_read_b32 v55, a34
    v_mul_f32 v55, v55, v54
    v_accvgpr_write_b32 a34, v55
    v_accvgpr_read_b32 v56, a35
    v_mul_f32 v56, v56, v54
    v_accvgpr_write_b32 a35, v56
    v_accvgpr_read_b32 v55, a36
    v_mul_f32 v55, v55, v54
    v_accvgpr_write_b32 a36, v55
    v_accvgpr_read_b32 v56, a37
    v_mul_f32 v56, v56, v54
    v_accvgpr_write_b32 a37, v56
    v_accvgpr_read_b32 v55, a38
    v_mul_f32 v55, v55, v54
    v_accvgpr_write_b32 a38, v55
    v_accvgpr_read_b32 v56, a39
    v_mul_f32 v56, v56, v54
    v_accvgpr_write_b32 a39, v56
    v_accvgpr_read_b32 v55, a40
    v_mul_f32 v55, v55, v54
    v_accvgpr_write_b32 a40, v55
    v_accvgpr_read_b32 v56, a41
    v_mul_f32 v56, v56, v54
    v_accvgpr_write_b32 a41, v56
    v_accvgpr_read_b32 v55, a42
    v_mul_f32 v55, v55, v54
    v_accvgpr_write_b32 a42, v55
    v_accvgpr_read_b32 v56, a43
    v_mul_f32 v56, v56, v54
    v_accvgpr_write_b32 a43, v56
    v_accvgpr_read_b32 v55, a44
    v_mul_f32 v55, v55, v54
    v_accvgpr_write_b32 a44, v55
    v_accvgpr_read_b32 v56, a45
    v_mul_f32 v56, v56, v54
    v_accvgpr_write_b32 a45, v56
    v_accvgpr_read_b32 v55, a46
    v_mul_f32 v55, v55, v54
    v_accvgpr_write_b32 a46, v55
    v_accvgpr_read_b32 v56, a47
    v_mul_f32 v56, v56, v54
    v_accvgpr_write_b32 a47, v56
    v_accvgpr_read_b32 v55, a48
    v_mul_f32 v55, v55, v54
    v_accvgpr_write_b32 a48, v55
    v_accvgpr_read_b32 v56, a49
    v_mul_f32 v56, v56, v54
    v_accvgpr_write_b32 a49, v56
    v_accvgpr_read_b32 v55, a50
    v_mul_f32 v55, v55, v54
    v_accvgpr_write_b32 a50, v55
    v_accvgpr_read_b32 v56, a51
    v_mul_f32 v56, v56, v54
    v_accvgpr_write_b32 a51, v56
    v_accvgpr_read_b32 v55, a52
    v_mul_f32 v55, v55, v54
    v_accvgpr_write_b32 a52, v55
    v_accvgpr_read_b32 v56, a53
    v_mul_f32 v56, v56, v54
    v_accvgpr_write_b32 a53, v56
    v_accvgpr_read_b32 v55, a54
    v_mul_f32 v55, v55, v54
    v_accvgpr_write_b32 a54, v55
    v_accvgpr_read_b32 v56, a55
    v_mul_f32 v56, v56, v54
    v_accvgpr_write_b32 a55, v56
    v_accvgpr_read_b32 v55, a56
    v_mul_f32 v55, v55, v54
    v_accvgpr_write_b32 a56, v55
    v_accvgpr_read_b32 v56, a57
    v_mul_f32 v56, v56, v54
    v_accvgpr_write_b32 a57, v56
    v_accvgpr_read_b32 v55, a58
    v_mul_f32 v55, v55, v54
    v_accvgpr_write_b32 a58, v55
    v_accvgpr_read_b32 v56, a59
    v_mul_f32 v56, v56, v54
    v_accvgpr_write_b32 a59, v56
    v_accvgpr_read_b32 v55, a60
    v_mul_f32 v55, v55, v54
    v_accvgpr_write_b32 a60, v55
    v_accvgpr_read_b32 v56, a61
    v_mul_f32 v56, v56, v54
    v_accvgpr_write_b32 a61, v56
    v_accvgpr_read_b32 v55, a62
    v_mul_f32 v55, v55, v54
    v_accvgpr_write_b32 a62, v55
    v_accvgpr_read_b32 v56, a63
    v_mul_f32 v56, v56, v54
    v_accvgpr_write_b32 a63, v56
    v_max3_f32 v53, v176, v177, v178
    v_max3_f32 v53, v179, v180, v53
    v_max3_f32 v53, v181, v182, v53
    v_max3_f32 v53, v183, v184, v53
    v_max3_f32 v53, v185, v186, v53
    v_max3_f32 v53, v187, v188, v53
    v_max3_f32 v53, v189, v190, v53
    v_max_f32 v53, v191, v53
    v_mov_b32 v54, v53
    s_nop 1
    v_permlane32_swap_b32 v53, v54
    v_max_f32 v53, v53, v54
    v_max_f32 v53, 0, v53
    v_sub_f32 v54, 0, v53
    v_exp_f32 v54, v54
    v_sub_f32 v176, v176, v53
    v_sub_f32 v80, v80, v53
    v_sub_f32 v177, v177, v53
    v_sub_f32 v81, v81, v53
    v_sub_f32 v178, v178, v53
    v_sub_f32 v82, v82, v53
    v_sub_f32 v179, v179, v53
    v_sub_f32 v83, v83, v53
    v_sub_f32 v180, v180, v53
    v_sub_f32 v84, v84, v53
    v_sub_f32 v181, v181, v53
    v_sub_f32 v85, v85, v53
    v_sub_f32 v182, v182, v53
    v_sub_f32 v86, v86, v53
    v_sub_f32 v183, v183, v53
    v_sub_f32 v87, v87, v53
    v_sub_f32 v184, v184, v53
    v_sub_f32 v88, v88, v53
    v_sub_f32 v185, v185, v53
    v_sub_f32 v89, v89, v53
    v_sub_f32 v186, v186, v53
    v_sub_f32 v90, v90, v53
    v_sub_f32 v187, v187, v53
    v_sub_f32 v91, v91, v53
    v_sub_f32 v188, v188, v53
    v_sub_f32 v92, v92, v53
    v_sub_f32 v189, v189, v53
    v_sub_f32 v93, v93, v53
    v_sub_f32 v190, v190, v53
    v_sub_f32 v94, v94, v53
    v_sub_f32 v191, v191, v53
    v_sub_f32 v95, v95, v53
    v_mul_f32 v50, v50, v54
    v_mul_f32 v51, v51, v54
    v_accvgpr_read_b32 v55, a64
    v_mul_f32 v55, v55, v54
    v_accvgpr_write_b32 a64, v55
    v_accvgpr_read_b32 v56, a65
    v_mul_f32 v56, v56, v54
    v_accvgpr_write_b32 a65, v56
    v_accvgpr_read_b32 v55, a66
    v_mul_f32 v55, v55, v54
    v_accvgpr_write_b32 a66, v55
    v_accvgpr_read_b32 v56, a67
    v_mul_f32 v56, v56, v54
    v_accvgpr_write_b32 a67, v56
    v_accvgpr_read_b32 v55, a68
    v_mul_f32 v55, v55, v54
    v_accvgpr_write_b32 a68, v55
    v_accvgpr_read_b32 v56, a69
    v_mul_f32 v56, v56, v54
    v_accvgpr_write_b32 a69, v56
    v_accvgpr_read_b32 v55, a70
    v_mul_f32 v55, v55, v54
    v_accvgpr_write_b32 a70, v55
    v_accvgpr_read_b32 v56, a71
    v_mul_f32 v56, v56, v54
    v_accvgpr_write_b32 a71, v56
    v_accvgpr_read_b32 v55, a72
    v_mul_f32 v55, v55, v54
    v_accvgpr_write_b32 a72, v55
    v_accvgpr_read_b32 v56, a73
    v_mul_f32 v56, v56, v54
    v_accvgpr_write_b32 a73, v56
    v_accvgpr_read_b32 v55, a74
    v_mul_f32 v55, v55, v54
    v_accvgpr_write_b32 a74, v55
    v_accvgpr_read_b32 v56, a75
    v_mul_f32 v56, v56, v54
    v_accvgpr_write_b32 a75, v56
    v_accvgpr_read_b32 v55, a76
    v_mul_f32 v55, v55, v54
    v_accvgpr_write_b32 a76, v55
    v_accvgpr_read_b32 v56, a77
    v_mul_f32 v56, v56, v54
    v_accvgpr_write_b32 a77, v56
    v_accvgpr_read_b32 v55, a78
    v_mul_f32 v55, v55, v54
    v_accvgpr_write_b32 a78, v55
    v_accvgpr_read_b32 v56, a79
    v_mul_f32 v56, v56, v54
    v_accvgpr_write_b32 a79, v56
    v_accvgpr_read_b32 v55, a80
    v_mul_f32 v55, v55, v54
    v_accvgpr_write_b32 a80, v55
    v_accvgpr_read_b32 v56, a81
    v_mul_f32 v56, v56, v54
    v_accvgpr_write_b32 a81, v56
    v_accvgpr_read_b32 v55, a82
    v_mul_f32 v55, v55, v54
    v_accvgpr_write_b32 a82, v55
    v_accvgpr_read_b32 v56, a83
    v_mul_f32 v56, v56, v54
    v_accvgpr_write_b32 a83, v56
    v_accvgpr_read_b32 v55, a84
    v_mul_f32 v55, v55, v54
    v_accvgpr_write_b32 a84, v55
    v_accvgpr_read_b32 v56, a85
    v_mul_f32 v56, v56, v54
    v_accvgpr_write_b32 a85, v56
    v_accvgpr_read_b32 v55, a86
    v_mul_f32 v55, v55, v54
    v_accvgpr_write_b32 a86, v55
    v_accvgpr_read_b32 v56, a87
    v_mul_f32 v56, v56, v54
    v_accvgpr_write_b32 a87, v56
    v_accvgpr_read_b32 v55, a88
    v_mul_f32 v55, v55, v54
    v_accvgpr_write_b32 a88, v55
    v_accvgpr_read_b32 v56, a89
    v_mul_f32 v56, v56, v54
    v_accvgpr_write_b32 a89, v56
    v_accvgpr_read_b32 v55, a90
    v_mul_f32 v55, v55, v54
    v_accvgpr_write_b32 a90, v55
    v_accvgpr_read_b32 v56, a91
    v_mul_f32 v56, v56, v54
    v_accvgpr_write_b32 a91, v56
    v_accvgpr_read_b32 v55, a92
    v_mul_f32 v55, v55, v54
    v_accvgpr_write_b32 a92, v55
    v_accvgpr_read_b32 v56, a93
    v_mul_f32 v56, v56, v54
    v_accvgpr_write_b32 a93, v56
    v_accvgpr_read_b32 v55, a94
    v_mul_f32 v55, v55, v54
    v_accvgpr_write_b32 a94, v55
    v_accvgpr_read_b32 v56, a95
    v_mul_f32 v56, v56, v54
    v_accvgpr_write_b32 a95, v56
    v_accvgpr_read_b32 v55, a96
    v_mul_f32 v55, v55, v54
    v_accvgpr_write_b32 a96, v55
    v_accvgpr_read_b32 v56, a97
    v_mul_f32 v56, v56, v54
    v_accvgpr_write_b32 a97, v56
    v_accvgpr_read_b32 v55, a98
    v_mul_f32 v55, v55, v54
    v_accvgpr_write_b32 a98, v55
    v_accvgpr_read_b32 v56, a99
    v_mul_f32 v56, v56, v54
    v_accvgpr_write_b32 a99, v56
    v_accvgpr_read_b32 v55, a100
    v_mul_f32 v55, v55, v54
    v_accvgpr_write_b32 a100, v55
    v_accvgpr_read_b32 v56, a101
    v_mul_f32 v56, v56, v54
    v_accvgpr_write_b32 a101, v56
    v_accvgpr_read_b32 v55, a102
    v_mul_f32 v55, v55, v54
    v_accvgpr_write_b32 a102, v55
    v_accvgpr_read_b32 v56, a103
    v_mul_f32 v56, v56, v54
    v_accvgpr_write_b32 a103, v56
    v_accvgpr_read_b32 v55, a104
    v_mul_f32 v55, v55, v54
    v_accvgpr_write_b32 a104, v55
    v_accvgpr_read_b32 v56, a105
    v_mul_f32 v56, v56, v54
    v_accvgpr_write_b32 a105, v56
    v_accvgpr_read_b32 v55, a106
    v_mul_f32 v55, v55, v54
    v_accvgpr_write_b32 a106, v55
    v_accvgpr_read_b32 v56, a107
    v_mul_f32 v56, v56, v54
    v_accvgpr_write_b32 a107, v56
    v_accvgpr_read_b32 v55, a108
    v_mul_f32 v55, v55, v54
    v_accvgpr_write_b32 a108, v55
    v_accvgpr_read_b32 v56, a109
    v_mul_f32 v56, v56, v54
    v_accvgpr_write_b32 a109, v56
    v_accvgpr_read_b32 v55, a110
    v_mul_f32 v55, v55, v54
    v_accvgpr_write_b32 a110, v55
    v_accvgpr_read_b32 v56, a111
    v_mul_f32 v56, v56, v54
    v_accvgpr_write_b32 a111, v56
    v_accvgpr_read_b32 v55, a112
    v_mul_f32 v55, v55, v54
    v_accvgpr_write_b32 a112, v55
    v_accvgpr_read_b32 v56, a113
    v_mul_f32 v56, v56, v54
    v_accvgpr_write_b32 a113, v56
    v_accvgpr_read_b32 v55, a114
    v_mul_f32 v55, v55, v54
    v_accvgpr_write_b32 a114, v55
    v_accvgpr_read_b32 v56, a115
    v_mul_f32 v56, v56, v54
    v_accvgpr_write_b32 a115, v56
    v_accvgpr_read_b32 v55, a116
    v_mul_f32 v55, v55, v54
    v_accvgpr_write_b32 a116, v55
    v_accvgpr_read_b32 v56, a117
    v_mul_f32 v56, v56, v54
    v_accvgpr_write_b32 a117, v56
    v_accvgpr_read_b32 v55, a118
    v_mul_f32 v55, v55, v54
    v_accvgpr_write_b32 a118, v55
    v_accvgpr_read_b32 v56, a119
    v_mul_f32 v56, v56, v54
    v_accvgpr_write_b32 a119, v56
    v_accvgpr_read_b32 v55, a120
    v_mul_f32 v55, v55, v54
    v_accvgpr_write_b32 a120, v55
    v_accvgpr_read_b32 v56, a121
    v_mul_f32 v56, v56, v54
    v_accvgpr_write_b32 a121, v56
    v_accvgpr_read_b32 v55, a122
    v_mul_f32 v55, v55, v54
    v_accvgpr_write_b32 a122, v55
    v_accvgpr_read_b32 v56, a123
    v_mul_f32 v56, v56, v54
    v_accvgpr_write_b32 a123, v56
    v_accvgpr_read_b32 v55, a124
    v_mul_f32 v55, v55, v54
    v_accvgpr_write_b32 a124, v55
    v_accvgpr_read_b32 v56, a125
    v_mul_f32 v56, v56, v54
    v_accvgpr_write_b32 a125, v56
    v_accvgpr_read_b32 v55, a126
    v_mul_f32 v55, v55, v54
    v_accvgpr_write_b32 a126, v55
    v_accvgpr_read_b32 v56, a127
    v_mul_f32 v56, v56, v54
    v_accvgpr_write_b32 a127, v56
    s_nop 3
    s_setpc_b64 s[96:97]
L_slow_nonce:
    s_mov_b32 s100, 0
L_spin_nonce:
    s_sleep 8
    buffer_load_dword v59, v39, s[8:11], s89 offen sc1
    s_waitcnt vmcnt(0)
    v_cmp_eq_u32 vcc, s99, v59
    s_nop 4
    s_cbranch_vccz L_ret_nonce
    s_add_u32 s100, s100, 1
    s_cmp_lt_u32 s100, 100000
    s_cbranch_scc1 L_spin_nonce
    s_branch L_ret_nonce
L_slow_xst:
    s_mov_b32 s100, 0
L_spin_xst:
    s_sleep 8
    buffer_load_dword v1, v60, s[4:7], s90 offen sc1
    s_waitcnt vmcnt(0)
    v_cmp_ne_u32 vcc, v59, v1
    s_nop 4
    s_cbranch_vccz L_ret_xst
    s_add_u32 s100, s100, 1
    s_cmp_lt_u32 s100, 100000
    s_cbranch_scc1 L_spin_xst
    s_branch L_ret_xst
L_slow_z2s:
    s_mov_b32 s100, 0
L_spin_z2s:
    s_sleep 8
    buffer_load_dword v1, v60, s[4:7], s82 offen sc1
    s_waitcnt vmcnt(0)
    v_cmp_ne_u32 vcc, v59, v1
    s_nop 4
    s_cbranch_vccz L_ret_z2s
    s_add_u32 s100, s100, 1
    s_cmp_lt_u32 s100, 100000
    s_cbranch_scc1 L_spin_z2s
    s_branch L_ret_z2s
L_slow_z2n:
    s_mov_b32 s100, 0
L_spin_z2n:
    s_sleep 8
    buffer_load_dword v1, v61, s[4:7], s92 offen sc1
    s_waitcnt vmcnt(0)
    v_cmp_ne_u32 vcc, v59, v1
    s_nop 4
    s_cbranch_vccz L_ret_z2n
    s_add_u32 s100, s100, 1
    s_cmp_lt_u32 s100, 100000
    s_cbranch_scc1 L_spin_z2n
    s_branch L_ret_z2n
L_slow_zo:
    s_mov_b32 s100, 0
L_spin_zo:
    s_sleep 8
    buffer_load_dword v35, v55, s[4:7], s92 offen sc1
    s_waitcnt vmcnt(0)
    v_cmp_ne_u32 vcc, v59, v35
    s_nop 4
    s_cbranch_vccz L_ret_zo
    s_add_u32 s100, s100, 1
    s_cmp_lt_u32 s100, 100000
    s_cbranch_scc1 L_spin_zo
    s_branch L_ret_zo
L_slow_o:
    s_mov_b32 s100, 0
L_spin_o:
    s_sleep 8
    buffer_load_dword v30, v54, s[4:7], s95 offen sc1
    s_waitcnt vmcnt(0)
    v_cmp_ne_u32 vcc, v59, v30
    s_nop 4
    s_cbranch_vccz L_ret_o
    s_add_u32 s100, s100, 1
    s_cmp_lt_u32 s100, 100000
    s_cbranch_scc1 L_spin_o
    s_branch L_ret_o
L_slow_u:
    s_mov_b32 s100, 0
L_spin_u:
    s_sleep 8
    buffer_load_dword v30, v54, s[4:7], s95 offen sc1
    s_waitcnt vmcnt(0)
    v_cmp_ne_u32 vcc, v59, v30
    s_nop 4
    s_cbranch_vccz L_ret_u
    s_add_u32 s100, s100, 1
    s_cmp_lt_u32 s100, 100000
    s_cbranch_scc1 L_spin_u
    s_branch L_ret_u
L_slow_part:
    s_mov_b32 s100, 0
L_spin_part:
    s_sleep 8
    buffer_load_dword v30, v54, s[4:7], s95 offen sc1
    s_waitcnt vmcnt(0)
    v_cmp_ne_u32 vcc, v59, v30
    s_nop 4
    s_cbranch_vccz L_ret_part
    s_add_u32 s100, s100, 1
    s_cmp_lt_u32 s100, 100000
    s_cbranch_scc1 L_spin_part
    s_branch L_ret_part
L_code_end:
L_end:
    s_endpgm

.p2align 6
.section .rodata,"a"
.p2align 6
.amdhsa_kernel recurrent_scan__sliding_block_cached__mixer_gmlp__prompt_kernel
  .amdhsa_next_free_vgpr 512
  .amdhsa_next_free_sgpr 102
  .amdhsa_accum_offset 256
  .amdhsa_group_segment_fixed_size 0
  .amdhsa_kernarg_size 104
  .amdhsa_user_sgpr_count 2
  .amdhsa_user_sgpr_kernarg_segment_ptr 1
  .amdhsa_system_sgpr_workgroup_id_x 1
  .amdhsa_float_denorm_mode_32 3
.end_amdhsa_kernel
```
